```python
import torch

def _softmax(x, axis=-1):
    return torch.softmax(x, dim=axis)

def _gelu(x):
    return torch.nn.functional.gelu(x, approximate='tanh')

def _silu(x):
    return torch.nn.functional.silu(x)

def _sigmoid(x):
    return torch.sigmoid(x)

def _layernorm(x, axis=-1, eps=1e-05):
    m = x.mean(dim=axis, keepdim=True)
    v = x.var(dim=axis, keepdim=True, unbiased=False)
    return (x - m) / torch.sqrt(v + eps)

def _scatter_add(tgt, idx, src, axis=0):
    return tgt.clone().index_add_(axis, idx, src)

def _segment_sum(src, seg, n):
    out = torch.zeros((n,) + src.shape[1:], dtype=src.dtype)
    return out.index_add_(0, seg, src)

def _pad(x, pw):
    flat = tuple((v for pair in reversed(pw) for v in pair))
    return torch.nn.functional.pad(x, flat)
kernel_name = 'adaLN_cond__memory_aug_recurrent_mem_tr__glu_gated_swiglu__prompt'

def setup_inputs():

    _w = lambda a: (lambda t: t.to(torch.bfloat16) if t.is_floating_point() else t)(torch.as_tensor(a))

    def _A_setup():
        B, S, Dm = (1, 2048, 640)
        H, Dh = (32, 128)
        M, seg = (8, 32)
        seg = min(seg, S)
        S = S // seg * seg
        return {'x': _w((lambda *s: torch.randn(*s, dtype=torch.bfloat16) * 0.05)(B, S, Dm)), 'mem0': _w((lambda *s: torch.randn(*s, dtype=torch.bfloat16) * 0.8)(B, M, Dm)), 'Wq': _w((lambda *s: torch.randn(*s, dtype=torch.bfloat16) * 0.8)(Dm, H, Dh) * Dm ** (-0.5)), 'Wk': _w((lambda *s: torch.randn(*s, dtype=torch.bfloat16) * 0.8)(Dm, H, Dh) * Dm ** (-0.5)), 'Wv': _w((lambda *s: torch.randn(*s, dtype=torch.bfloat16) * 0.8)(Dm, H, Dh) * Dm ** (-0.5)), 'Wo': _w((lambda *s: torch.randn(*s, dtype=torch.bfloat16) * 0.8)(H, Dh, Dm) * (H * Dh) ** (-0.5)), 'seg_len': seg}
    _A_in = _A_setup()

    def _B_setup():
        B, S, D, F = (1, 2048, 640, 1728)
        return {'x': _w((lambda *s: torch.randn(*s, dtype=torch.bfloat16) * 0.05)(B, S, D)), 'w1': _w((lambda *s: torch.randn(*s, dtype=torch.bfloat16) * 0.4)(D, F) * (2.0 / D) ** 0.5), 'w3': _w((lambda *s: torch.randn(*s, dtype=torch.bfloat16) * 0.4)(D, F) * (2.0 / D) ** 0.5), 'w2': _w((lambda *s: torch.randn(*s, dtype=torch.bfloat16) * 0.4)(F, D) * (2.0 / F) ** 0.5)}
    _B_in = _B_setup()
    return {'A_x': _A_in['x'], 'A_mem0': _A_in['mem0'], 'A_Wq': _A_in['Wq'], 'A_Wk': _A_in['Wk'], 'A_Wv': _A_in['Wv'], 'A_Wo': _A_in['Wo'], 'A_seg_len': _A_in['seg_len'], 'B_x': _B_in['x'], 'B_w1': _B_in['w1'], 'B_w3': _B_in['w3'], 'B_w2': _B_in['w2'], 'c': _w((lambda *s: torch.randn(*s, dtype=torch.bfloat16) * 0.1)(1, 640) * 8.0), 'w_mod': _w((lambda *s: torch.randn(*s, dtype=torch.bfloat16) * 0.1)(640, 6 * 640) * 640 ** (-0.5) * 8.0)}

def reference(A_x, A_mem0, A_Wq, A_Wk, A_Wv, A_Wo, A_seg_len, B_x, B_w1, B_w3, B_w2, c, w_mod):

    def _A_ref(x, mem0, Wq, Wk, Wv, Wo, seg_len):
        B, S, Dm = x.shape
        H, Dh = (Wq.shape[1], Wq.shape[2])
        M = mem0.shape[1]
        scale = Dh ** (-0.5)
        n_seg = S // seg_len
        L = M + seg_len
        idx = torch.arange(L)
        mask = (idx[:, None] < M) | (idx[:, None] >= idx[None, :])
        mem = mem0
        outs = []
        for s in range(n_seg):
            xs = x[:, s * seg_len:(s + 1) * seg_len, :].clone()
            h = torch.concatenate([mem, xs], axis=1)
            q = torch.einsum('btd,dhe->bhte', h, Wq)
            k = torch.einsum('btd,dhe->bhte', h, Wk)
            v = torch.einsum('btd,dhe->bhte', h, Wv)
            scores = torch.einsum('bhqe,bhke->bhqk', q, k) * scale
            scores = torch.where(mask[None, None], scores, -1000000000.0)
            p = _softmax(scores, axis=-1)
            o = torch.einsum('bhqk,bhke->bhqe', p, v)
            o = torch.einsum('bhte,hed->btd', o, Wo)
            mem = o[:, :M, :].clone()
            outs.append(o[:, M:, :])
        return torch.concatenate(outs, axis=1)

    def _B_ref(x, w1, w3, w2):
        gate = torch.einsum('bsd,df->bsf', x, w1)
        up = torch.einsum('bsd,df->bsf', x, w3)
        h = _silu(gate) * up
        out = torch.einsum('bsf,fd->bsd', h, w2)
        return out
    x = A_x
    mod = (_silu(c) @ w_mod).reshape(c.shape[0], 6, 1, -1)
    sa, ca, ga, sb, cb, gb = (mod[:, 0].clone(), mod[:, 1].clone(), mod[:, 2].clone(), mod[:, 3].clone(), mod[:, 4].clone(), mod[:, 5].clone())
    h = _layernorm(x, axis=-1) * (1 + ca) + sa
    x = x + ga * _A_ref(h, A_mem0, A_Wq, A_Wk, A_Wv, A_Wo, A_seg_len)
    h = _layernorm(x, axis=-1) * (1 + cb) + sb
    x = x + gb * _B_ref(h, B_w1, B_w3, B_w2)
    return x
```

```asm
; @launch grid=(256,1,1) block=(256,1,1) lds=163840
.amdgcn_target "amdgcn-amd-amdhsa--gfx950"
.text
.globl adaLN_cond__memory_aug_recurrent_mem_tr__glu_gated_swiglu__prompt_kernel
.p2align 8
.type adaLN_cond__memory_aug_recurrent_mem_tr__glu_gated_swiglu__prompt_kernel,@function
adaLN_cond__memory_aug_recurrent_mem_tr__glu_gated_swiglu__prompt_kernel:
    s_cmp_lt_u32 s2, 256
    s_cbranch_scc1 adaLN_cond__memory_aug_recurrent_mem_tr__glu_gated_swiglu__prompt_kernel_go
    s_endpgm
adaLN_cond__memory_aug_recurrent_mem_tr__glu_gated_swiglu__prompt_kernel_go:
    s_load_dwordx4 s[48:51], s[0:1], 16
    s_load_dwordx4 s[52:55], s[0:1], 32
    s_load_dwordx4 s[56:59], s[0:1], 112
    s_getreg_b32 s37, hwreg(HW_REG_XCC_ID)
    s_and_b32 s37, s37, 15
    v_lshrrev_b32 v20, 6, v0
    v_and_b32 v16, 63, v0
    v_readfirstlane_b32 s29, v20
    s_waitcnt lgkmcnt(0)
    s_mov_b32 s12, s48
    s_and_b32 s13, s49, 0xffff
    s_mov_b32 s14, 5242880
    s_mov_b32 s15, 0x20000
    s_mov_b32 s16, s50
    s_and_b32 s17, s51, 0xffff
    s_mov_b32 s18, 5242880
    s_mov_b32 s19, 0x20000
    s_mov_b32 s20, s52
    s_and_b32 s21, s53, 0xffff
    s_mov_b32 s22, 5242880
    s_mov_b32 s23, 0x20000
    s_mov_b32 s24, s54
    s_and_b32 s25, s55, 0xffff
    s_mov_b32 s26, 5242880
    s_mov_b32 s27, 0x20000
    s_mov_b32 s8, s56
    s_and_b32 s9, s57, 0xffff
    s_mov_b32 s10, 256
    s_mov_b32 s11, 0x20000
    s_mov_b32 s4, s58
    s_and_b32 s5, s59, 0xffff
    s_mov_b32 s6, 268435456
    s_mov_b32 s7, 0x20000
    s_and_b32 s35, s2, 7
    s_lshr_b32 s28, s2, 3
    s_cmp_eq_u32 s35, 0
    s_cbranch_scc1 adaLN_cond__memory_aug_recurrent_mem_tr__glu_gated_swiglu__prompt_kernel_hasrole
    s_bitcmp1_b32 0x82, s35
    s_cbranch_scc0 adaLN_cond__memory_aug_recurrent_mem_tr__glu_gated_swiglu__prompt_kernel_work
    s_and_b32 s31, s37, 3
    s_cmp_lg_u32 s31, 0
    s_cselect_b32 s32, 1, 0
    s_cmp_eq_u32 s31, 2
    s_cselect_b32 s33, 1, 0
    s_cmp_eq_u32 s35, 1
    s_cselect_b32 s32, s32, s33
    s_cmp_lg_u32 s29, 0
    s_cbranch_scc1 adaLN_cond__memory_aug_recurrent_mem_tr__glu_gated_swiglu__prompt_kernel_elected
    s_lshl_b32 s31, 1, s28
    s_lshl_b32 s33, s32, 2
    v_mov_b32 v20, s31
    v_mov_b32 v21, 0
    s_mov_b64 exec, 1
    buffer_atomic_or v20, v21, s[8:11], s33 offen offset:144 sc0
    s_waitcnt vmcnt(0)
    ds_write_b32 v21, v20
    s_mov_b64 exec, -1
    s_waitcnt lgkmcnt(0)
adaLN_cond__memory_aug_recurrent_mem_tr__glu_gated_swiglu__prompt_kernel_elected:
    s_barrier
    v_mov_b32 v21, 0
    ds_read_b32 v20, v21
    s_waitcnt lgkmcnt(0)
    v_readfirstlane_b32 s31, v20
    s_barrier
    s_lshr_b32 s31, s31, s28
    s_and_b32 s31, s31, 1
    s_xor_b32 s32, s32, s31
    s_cbranch_scc1 adaLN_cond__memory_aug_recurrent_mem_tr__glu_gated_swiglu__prompt_kernel_hasrole
    s_mov_b32 s35, 7
adaLN_cond__memory_aug_recurrent_mem_tr__glu_gated_swiglu__prompt_kernel_work:
    s_getpc_b64 s[44:45]
Lfj1:
    s_add_u32 s44, s44, wk_entry-Lfj1
    s_addc_u32 s45, s45, 0
    s_setpc_b64 s[44:45]
adaLN_cond__memory_aug_recurrent_mem_tr__glu_gated_swiglu__prompt_kernel_hasrole:
    v_mov_b32 v28, v16
    v_lshrrev_b32 v16, 4, v28
    v_and_b32 v17, 15, v28
    v_lshrrev_b32 v18, 2, v17
    v_and_b32 v19, 3, v28
    v_and_b32 v20, 1, v16
    v_lshrrev_b32 v21, 1, v16
    v_lshl_add_u32 v22, v20, 1, v21
    v_lshlrev_b32 v0, 4, v28
    v_lshlrev_b32 v15, 6, v28
    v_lshlrev_b32 v12, 7, v17
    v_mov_b32 v14, -1
    v_and_b32 v23, 2, v28
    v_cmp_ne_u32 vcc, 0, v23
    v_mov_b32 v24, 0x4444
    v_mov_b32 v25, 0xeeee
    v_cndmask_b32 v1, v24, v25, vcc
    v_lshl_add_u32 v23, v16, 2, v18
    v_lshlrev_b32 v24, 3, v19
    v_lshl_add_u32 v2, v23, 5, v24
    v_and_b32 v25, 1, v19
    v_lshlrev_b32 v25, 3, v25
    v_lshl_add_u32 v3, v23, 4, v25
    v_add_u32 v3, 10240, v3
    s_lshl_b32 s31, s29, 5
    v_add_u32 v23, s31, v17
    v_lshlrev_b32 v25, 2, v22
    v_lshl_add_u32 v5, v23, 4, v25
    v_add_u32 v5, 10240, v5
    s_lshl_b32 s31, s29, 2
    v_add_u32 v23, s31, v16
    v_and_b32 v26, 7, v28
    v_lshl_add_u32 v23, v23, 3, v26
    v_lshlrev_b32 v6, 4, v23
    v_add_u32 v6, 14336, v6
    v_and_b32 v23, 1, v18
    v_lshrrev_b32 v25, 1, v18
    v_lshl_add_u32 v23, v23, 1, v25
    v_and_b32 v25, 1, v28
    v_lshl_add_u32 v23, v23, 1, v25
    v_lshl_add_u32 v23, v16, 3, v23
    v_lshrrev_b32 v25, 1, v19
    v_lshl_add_u32 v23, v25, 5, v23
    v_lshlrev_b32 v7, 4, v23
    v_add_u32 v7, 14336, v7
    v_lshl_add_u32 v23, v20, 2, v19
    v_lshlrev_b32 v23, 4, v23
    v_lshl_add_u32 v23, v21, 3, v23
    v_lshl_add_u32 v8, v18, 12, v23
    v_and_b32 v23, 4, v28
    v_lshl_add_u32 v23, v22, 3, v23
    v_lshl_add_u32 v23, v19, 5, v23
    v_lshlrev_b32 v24, 27, v17
    v_and_b32 v24, 0x40000000, v24
    v_or_b32 v10, v23, v24
    v_lshlrev_b32 v11, 3, v28
    v_lshlrev_b32 v23, 4, v16
    v_lshl_add_u32 v9, v17, 6, v23
    s_mul_i32 s42, s29, 32768
    s_add_u32 s42, s42, 32768
    v_add_u32 v4, s42, v0
    v_lshrrev_b32 v25, 1, v18
    v_and_b32 v26, 1, v18
    v_lshlrev_b32 v24, 3, v19
    v_lshl_add_u32 v26, v21, 2, v26
    v_lshl_add_u32 v24, v26, 8, v24
    s_lshl_b32 s31, s29, 6
    s_add_u32 s31, s31, 32768
    v_add_u32 v24, s31, v24
    v_lshl_add_u32 v27, v20, 1, v25
    v_lshl_add_u32 v30, v27, 15, v24
    v_lshl_add_u32 v27, v25, 1, v20
    v_lshl_add_u32 v31, v27, 15, v24
    v_lshlrev_b32 v24, 4, v17
    v_mul_u32_u24 v29, 1280, v16
    v_add_u32 v29, v29, v24
    v_lshl_add_u32 v28, v16, 13, v24
    s_lshl_b32 s33, s28, 8
    s_lshl_b32 s31, s29, 17
    s_add_u32 s33, s33, s31
    s_mul_i32 s34, s28, 163840
    s_mul_i32 s31, s29, 20480
    s_add_u32 s34, s34, s31
    s_lshl_b32 s50, s29, 14
    s_lshl_b32 s31, s28, 7
    s_add_u32 s50, s50, s31
    s_mov_b32 s30, 0
    s_mov_b32 s3, 0
    s_mov_b32 s48, 0
    s_lshl_b32 s32, s28, 12
    s_add_u32 s71, s32, 50331648
    s_lshl_b32 s31, s29, 9
    s_add_u32 s62, s71, s31
    s_add_u32 s63, s4, 0x5fffff
    s_and_b32 s63, s63, 0xffe00000
    s_sub_u32 s63, s63, s4
    s_lshl_b32 s31, s29, 10
    s_lshr_b32 s32, s28, 1
    s_lshl_b32 s32, s32, 14
    s_add_u32 s66, s31, s32
    s_and_b32 s32, s28, 1
    s_lshl_b32 s32, s32, 12
    s_add_u32 s66, s66, s32
    s_add_u32 s66, s66, 262144
    s_cmp_eq_u32 s35, 0
    s_cbranch_scc1 adaLN_cond__memory_aug_recurrent_mem_tr__glu_gated_swiglu__prompt_kernel_chain
    s_getpc_b64 s[44:45]
Lfj2:
    s_add_u32 s44, s44, adaLN_cond__memory_aug_recurrent_mem_tr__glu_gated_swiglu__prompt_kernel_helper-Lfj2
    s_addc_u32 s45, s45, 0
    s_setpc_b64 s[44:45]
adaLN_cond__memory_aug_recurrent_mem_tr__glu_gated_swiglu__prompt_kernel_chain:
    s_mov_b32 s38, 0x3e0293ee
    s_mov_b32 s39, 0x3e0293ee
    s_mov_b32 s40, -1
    s_mov_b32 s41, 0
    s_lshl_b32 s31, s28, 1
    s_add_u32 s31, s31, s29
    s_add_u32 s36, s31, 16
    s_cmp_lt_u32 s28, 16
    s_cselect_b32 s31, s28, 255
    s_cmp_eq_u32 s29, 2
    s_cselect_b32 s36, s31, s36
    s_cmp_eq_u32 s29, 3
    s_cselect_b32 s36, 255, s36
    s_mul_i32 s64, s29, 2560
    s_add_u32 s31, s33, 524288
    s_add_u32 m0, s42, 0
    s_nop 0
    buffer_load_dwordx4 v28, s[12:15], s31 offen nt lds
    s_add_u32 s31, s33, 557056
    s_add_u32 m0, s42, 1024
    s_nop 0
    buffer_load_dwordx4 v28, s[12:15], s31 offen nt lds
    s_add_u32 s31, s33, 589824
    s_add_u32 m0, s42, 2048
    s_nop 0
    buffer_load_dwordx4 v28, s[12:15], s31 offen nt lds
    s_add_u32 s31, s33, 622592
    s_add_u32 m0, s42, 3072
    s_nop 0
    buffer_load_dwordx4 v28, s[12:15], s31 offen nt lds
    s_add_u32 s31, s33, 524288
    s_add_u32 m0, s42, 4096
    s_nop 0
    buffer_load_dwordx4 v28, s[16:19], s31 offen nt lds
    s_add_u32 s31, s33, 557056
    s_add_u32 m0, s42, 5120
    s_nop 0
    buffer_load_dwordx4 v28, s[16:19], s31 offen nt lds
    s_add_u32 s31, s33, 589824
    s_add_u32 m0, s42, 6144
    s_nop 0
    buffer_load_dwordx4 v28, s[16:19], s31 offen nt lds
    s_add_u32 s31, s33, 622592
    s_add_u32 m0, s42, 7168
    s_nop 0
    buffer_load_dwordx4 v28, s[16:19], s31 offen nt lds
    s_add_u32 s31, s33, 1048576
    s_add_u32 m0, s42, 8192
    s_nop 0
    buffer_load_dwordx4 v28, s[12:15], s31 offen nt lds
    s_add_u32 s31, s33, 1081344
    s_add_u32 m0, s42, 9216
    s_nop 0
    buffer_load_dwordx4 v28, s[12:15], s31 offen nt lds
    s_add_u32 s31, s33, 1114112
    s_add_u32 m0, s42, 10240
    s_nop 0
    buffer_load_dwordx4 v28, s[12:15], s31 offen nt lds
    s_add_u32 s31, s33, 1146880
    s_add_u32 m0, s42, 11264
    s_nop 0
    buffer_load_dwordx4 v28, s[12:15], s31 offen nt lds
    s_add_u32 s31, s33, 1572864
    s_add_u32 m0, s42, 12288
    s_nop 0
    buffer_load_dwordx4 v28, s[12:15], s31 offen nt lds
    s_add_u32 s31, s33, 1605632
    s_add_u32 m0, s42, 13312
    s_nop 0
    buffer_load_dwordx4 v28, s[12:15], s31 offen nt lds
    s_add_u32 s31, s33, 1638400
    s_add_u32 m0, s42, 14336
    s_nop 0
    buffer_load_dwordx4 v28, s[12:15], s31 offen nt lds
    s_add_u32 s31, s33, 1671168
    s_add_u32 m0, s42, 15360
    s_nop 0
    buffer_load_dwordx4 v28, s[12:15], s31 offen nt lds
    s_and_b32 s31, s37, 7
    s_lshl_b32 s31, s31, 3
    s_lshl_b64 s[76:77], 1, s31
    v_mov_b32 v44, 160
    v_mov_b32 v46, s76
    v_mov_b32 v47, s77
    s_cmp_eq_u32 s29, 0
    s_cselect_b32 s31, 0, 0x40000000
    s_mov_b64 exec, 1
    buffer_atomic_add_x2 v[46:47], v44, s[8:11], s31 offen
    s_mov_b64 exec, -1
    s_waitcnt vmcnt(13)
    s_barrier
    ds_read_b64_tr_b16 v[96:97], v30 offset:0
    ds_read_b64_tr_b16 v[98:99], v30 offset:512
    ds_read_b64_tr_b16 v[100:101], v30 offset:2048
    ds_read_b64_tr_b16 v[102:103], v30 offset:2560
    ds_read_b64_tr_b16 v[104:105], v30 offset:32
    ds_read_b64_tr_b16 v[106:107], v30 offset:544
    ds_read_b64_tr_b16 v[108:109], v30 offset:2080
    ds_read_b64_tr_b16 v[110:111], v30 offset:2592
    s_waitcnt lgkmcnt(0)
    s_waitcnt vmcnt(9)
    s_barrier
    s_add_u32 s31, s33, 1572864
    s_add_u32 m0, s42, 16384
    s_nop 0
    buffer_load_dwordx4 v28, s[16:19], s31 offen nt lds
    s_add_u32 s31, s33, 1605632
    s_add_u32 m0, s42, 17408
    s_nop 0
    buffer_load_dwordx4 v28, s[16:19], s31 offen nt lds
    s_add_u32 s31, s33, 1638400
    s_add_u32 m0, s42, 18432
    s_nop 0
    buffer_load_dwordx4 v28, s[16:19], s31 offen nt lds
    s_add_u32 s31, s33, 1671168
    s_add_u32 m0, s42, 19456
    s_nop 0
    buffer_load_dwordx4 v28, s[16:19], s31 offen nt lds
    ds_read_b64_tr_b16 v[112:113], v30 offset:4096
    ds_read_b64_tr_b16 v[114:115], v30 offset:4608
    ds_read_b64_tr_b16 v[116:117], v30 offset:6144
    ds_read_b64_tr_b16 v[118:119], v30 offset:6656
    ds_read_b64_tr_b16 v[120:121], v30 offset:4128
    ds_read_b64_tr_b16 v[122:123], v30 offset:4640
    ds_read_b64_tr_b16 v[124:125], v30 offset:6176
    ds_read_b64_tr_b16 v[126:127], v30 offset:6688
    s_waitcnt lgkmcnt(0)
    s_waitcnt vmcnt(9)
    s_barrier
    s_add_u32 s31, s33, 2097152
    s_add_u32 m0, s42, 20480
    s_nop 0
    buffer_load_dwordx4 v28, s[12:15], s31 offen nt lds
    s_add_u32 s31, s33, 2129920
    s_add_u32 m0, s42, 21504
    s_nop 0
    buffer_load_dwordx4 v28, s[12:15], s31 offen nt lds
    s_add_u32 s31, s33, 2162688
    s_add_u32 m0, s42, 22528
    s_nop 0
    buffer_load_dwordx4 v28, s[12:15], s31 offen nt lds
    s_add_u32 s31, s33, 2195456
    s_add_u32 m0, s42, 23552
    s_nop 0
    buffer_load_dwordx4 v28, s[12:15], s31 offen nt lds
    ds_read_b64_tr_b16 v[128:129], v30 offset:8192
    ds_read_b64_tr_b16 v[130:131], v30 offset:8704
    ds_read_b64_tr_b16 v[132:133], v30 offset:10240
    ds_read_b64_tr_b16 v[134:135], v30 offset:10752
    ds_read_b64_tr_b16 v[136:137], v30 offset:8224
    ds_read_b64_tr_b16 v[138:139], v30 offset:8736
    ds_read_b64_tr_b16 v[140:141], v30 offset:10272
    ds_read_b64_tr_b16 v[142:143], v30 offset:10784
    s_waitcnt lgkmcnt(0)
    s_waitcnt vmcnt(9)
    s_barrier
    s_add_u32 s31, s33, 2097152
    s_add_u32 m0, s42, 24576
    s_nop 0
    buffer_load_dwordx4 v28, s[16:19], s31 offen nt lds
    s_add_u32 s31, s33, 2129920
    s_add_u32 m0, s42, 25600
    s_nop 0
    buffer_load_dwordx4 v28, s[16:19], s31 offen nt lds
    s_add_u32 s31, s33, 2162688
    s_add_u32 m0, s42, 26624
    s_nop 0
    buffer_load_dwordx4 v28, s[16:19], s31 offen nt lds
    s_add_u32 s31, s33, 2195456
    s_add_u32 m0, s42, 27648
    s_nop 0
    buffer_load_dwordx4 v28, s[16:19], s31 offen nt lds
    ds_read_b64_tr_b16 v[144:145], v30 offset:12288
    ds_read_b64_tr_b16 v[146:147], v30 offset:12800
    ds_read_b64_tr_b16 v[148:149], v30 offset:14336
    ds_read_b64_tr_b16 v[150:151], v30 offset:14848
    ds_read_b64_tr_b16 v[152:153], v30 offset:12320
    ds_read_b64_tr_b16 v[154:155], v30 offset:12832
    ds_read_b64_tr_b16 v[156:157], v30 offset:14368
    ds_read_b64_tr_b16 v[158:159], v30 offset:14880
    s_waitcnt lgkmcnt(0)
    s_waitcnt vmcnt(8)
    s_barrier
    s_add_u32 s31, s33, 2621440
    s_add_u32 m0, s42, 28672
    s_nop 0
    buffer_load_dwordx4 v28, s[12:15], s31 offen nt lds
    s_add_u32 s31, s33, 2654208
    s_add_u32 m0, s42, 29696
    s_nop 0
    buffer_load_dwordx4 v28, s[12:15], s31 offen nt lds
    s_add_u32 s31, s33, 2686976
    s_add_u32 m0, s42, 30720
    s_nop 0
    buffer_load_dwordx4 v28, s[12:15], s31 offen nt lds
    s_add_u32 s31, s33, 2719744
    s_add_u32 m0, s42, 31744
    s_nop 0
    buffer_load_dwordx4 v28, s[12:15], s31 offen nt lds
    ds_read_b64_tr_b16 v[160:161], v30 offset:16384
    ds_read_b64_tr_b16 v[162:163], v30 offset:16896
    ds_read_b64_tr_b16 v[164:165], v30 offset:18432
    ds_read_b64_tr_b16 v[166:167], v30 offset:18944
    ds_read_b64_tr_b16 v[168:169], v30 offset:16416
    ds_read_b64_tr_b16 v[170:171], v30 offset:16928
    ds_read_b64_tr_b16 v[172:173], v30 offset:18464
    ds_read_b64_tr_b16 v[174:175], v30 offset:18976
    s_waitcnt lgkmcnt(0)
    s_waitcnt vmcnt(8)
    s_barrier
    s_add_u32 s31, s33, 2621440
    s_add_u32 m0, s42, 0
    s_nop 0
    buffer_load_dwordx4 v28, s[16:19], s31 offen nt lds
    s_add_u32 s31, s33, 2654208
    s_add_u32 m0, s42, 1024
    s_nop 0
    buffer_load_dwordx4 v28, s[16:19], s31 offen nt lds
    s_add_u32 s31, s33, 2686976
    s_add_u32 m0, s42, 2048
    s_nop 0
    buffer_load_dwordx4 v28, s[16:19], s31 offen nt lds
    s_add_u32 s31, s33, 2719744
    s_add_u32 m0, s42, 3072
    s_nop 0
    buffer_load_dwordx4 v28, s[16:19], s31 offen nt lds
    ds_read_b64_tr_b16 v[176:177], v30 offset:20480
    ds_read_b64_tr_b16 v[178:179], v30 offset:20992
    ds_read_b64_tr_b16 v[180:181], v30 offset:22528
    ds_read_b64_tr_b16 v[182:183], v30 offset:23040
    ds_read_b64_tr_b16 v[184:185], v30 offset:20512
    ds_read_b64_tr_b16 v[186:187], v30 offset:21024
    ds_read_b64_tr_b16 v[188:189], v30 offset:22560
    ds_read_b64_tr_b16 v[190:191], v30 offset:23072
    s_waitcnt lgkmcnt(0)
    s_waitcnt vmcnt(8)
    s_barrier
    s_add_u32 s31, s33, 3145728
    s_add_u32 m0, s42, 4096
    s_nop 0
    buffer_load_dwordx4 v28, s[12:15], s31 offen nt lds
    s_add_u32 s31, s33, 3178496
    s_add_u32 m0, s42, 5120
    s_nop 0
    buffer_load_dwordx4 v28, s[12:15], s31 offen nt lds
    s_add_u32 s31, s33, 3211264
    s_add_u32 m0, s42, 6144
    s_nop 0
    buffer_load_dwordx4 v28, s[12:15], s31 offen nt lds
    s_add_u32 s31, s33, 3244032
    s_add_u32 m0, s42, 7168
    s_nop 0
    buffer_load_dwordx4 v28, s[12:15], s31 offen nt lds
    ds_read_b64_tr_b16 v[192:193], v30 offset:24576
    ds_read_b64_tr_b16 v[194:195], v30 offset:25088
    ds_read_b64_tr_b16 v[196:197], v30 offset:26624
    ds_read_b64_tr_b16 v[198:199], v30 offset:27136
    ds_read_b64_tr_b16 v[200:201], v30 offset:24608
    ds_read_b64_tr_b16 v[202:203], v30 offset:25120
    ds_read_b64_tr_b16 v[204:205], v30 offset:26656
    ds_read_b64_tr_b16 v[206:207], v30 offset:27168
    s_waitcnt lgkmcnt(0)
    s_waitcnt vmcnt(8)
    s_barrier
    s_add_u32 s31, s33, 3670016
    s_add_u32 m0, s42, 8192
    s_nop 0
    buffer_load_dwordx4 v28, s[12:15], s31 offen nt lds
    s_add_u32 s31, s33, 3702784
    s_add_u32 m0, s42, 9216
    s_nop 0
    buffer_load_dwordx4 v28, s[12:15], s31 offen nt lds
    s_add_u32 s31, s33, 3735552
    s_add_u32 m0, s42, 10240
    s_nop 0
    buffer_load_dwordx4 v28, s[12:15], s31 offen nt lds
    s_add_u32 s31, s33, 3768320
    s_add_u32 m0, s42, 11264
    s_nop 0
    buffer_load_dwordx4 v28, s[12:15], s31 offen nt lds
    ds_read_b64_tr_b16 v[208:209], v30 offset:28672
    ds_read_b64_tr_b16 v[210:211], v30 offset:29184
    ds_read_b64_tr_b16 v[212:213], v30 offset:30720
    ds_read_b64_tr_b16 v[214:215], v30 offset:31232
    ds_read_b64_tr_b16 v[216:217], v30 offset:28704
    ds_read_b64_tr_b16 v[218:219], v30 offset:29216
    ds_read_b64_tr_b16 v[220:221], v30 offset:30752
    ds_read_b64_tr_b16 v[222:223], v30 offset:31264
    s_waitcnt lgkmcnt(0)
    s_waitcnt vmcnt(8)
    s_barrier
    s_add_u32 s31, s33, 4194304
    s_add_u32 m0, s42, 12288
    s_nop 0
    buffer_load_dwordx4 v28, s[12:15], s31 offen nt lds
    s_add_u32 s31, s33, 4227072
    s_add_u32 m0, s42, 13312
    s_nop 0
    buffer_load_dwordx4 v28, s[12:15], s31 offen nt lds
    s_add_u32 s31, s33, 4259840
    s_add_u32 m0, s42, 14336
    s_nop 0
    buffer_load_dwordx4 v28, s[12:15], s31 offen nt lds
    s_add_u32 s31, s33, 4292608
    s_add_u32 m0, s42, 15360
    s_nop 0
    buffer_load_dwordx4 v28, s[12:15], s31 offen nt lds
    ds_read_b64_tr_b16 v[224:225], v30 offset:0
    ds_read_b64_tr_b16 v[226:227], v30 offset:512
    ds_read_b64_tr_b16 v[228:229], v30 offset:2048
    ds_read_b64_tr_b16 v[230:231], v30 offset:2560
    ds_read_b64_tr_b16 v[232:233], v30 offset:32
    ds_read_b64_tr_b16 v[234:235], v30 offset:544
    ds_read_b64_tr_b16 v[236:237], v30 offset:2080
    ds_read_b64_tr_b16 v[238:239], v30 offset:2592
    s_waitcnt lgkmcnt(0)
    s_waitcnt vmcnt(8)
    s_barrier
    s_add_u32 s31, s33, 4718592
    s_add_u32 m0, s42, 16384
    s_nop 0
    buffer_load_dwordx4 v28, s[12:15], s31 offen nt lds
    s_add_u32 s31, s33, 4751360
    s_add_u32 m0, s42, 17408
    s_nop 0
    buffer_load_dwordx4 v28, s[12:15], s31 offen nt lds
    s_add_u32 s31, s33, 4784128
    s_add_u32 m0, s42, 18432
    s_nop 0
    buffer_load_dwordx4 v28, s[12:15], s31 offen nt lds
    s_add_u32 s31, s33, 4816896
    s_add_u32 m0, s42, 19456
    s_nop 0
    buffer_load_dwordx4 v28, s[12:15], s31 offen nt lds
    ds_read_b64_tr_b16 v[240:241], v30 offset:4096
    ds_read_b64_tr_b16 v[242:243], v30 offset:4608
    ds_read_b64_tr_b16 v[244:245], v30 offset:6144
    ds_read_b64_tr_b16 v[246:247], v30 offset:6656
    ds_read_b64_tr_b16 v[248:249], v30 offset:4128
    ds_read_b64_tr_b16 v[250:251], v30 offset:4640
    ds_read_b64_tr_b16 v[252:253], v30 offset:6176
    ds_read_b64_tr_b16 v[254:255], v30 offset:6688
    s_waitcnt lgkmcnt(0)
    s_waitcnt vmcnt(8)
    s_barrier
    s_add_u32 s31, s33, 3145728
    s_add_u32 m0, s42, 20480
    s_nop 0
    buffer_load_dwordx4 v28, s[16:19], s31 offen nt lds
    s_add_u32 s31, s33, 3178496
    s_add_u32 m0, s42, 21504
    s_nop 0
    buffer_load_dwordx4 v28, s[16:19], s31 offen nt lds
    s_add_u32 s31, s33, 3211264
    s_add_u32 m0, s42, 22528
    s_nop 0
    buffer_load_dwordx4 v28, s[16:19], s31 offen nt lds
    s_add_u32 s31, s33, 3244032
    s_add_u32 m0, s42, 23552
    s_nop 0
    buffer_load_dwordx4 v28, s[16:19], s31 offen nt lds
    ds_read_b64_tr_b16 a[0:1], v30 offset:8192
    ds_read_b64_tr_b16 a[2:3], v30 offset:8704
    ds_read_b64_tr_b16 a[4:5], v30 offset:10240
    ds_read_b64_tr_b16 a[6:7], v30 offset:10752
    ds_read_b64_tr_b16 a[8:9], v30 offset:8224
    ds_read_b64_tr_b16 a[10:11], v30 offset:8736
    ds_read_b64_tr_b16 a[12:13], v30 offset:10272
    ds_read_b64_tr_b16 a[14:15], v30 offset:10784
    s_waitcnt lgkmcnt(0)
    s_waitcnt vmcnt(8)
    s_barrier
    s_add_u32 s31, s33, 3670016
    s_add_u32 m0, s42, 24576
    s_nop 0
    buffer_load_dwordx4 v28, s[16:19], s31 offen nt lds
    s_add_u32 s31, s33, 3702784
    s_add_u32 m0, s42, 25600
    s_nop 0
    buffer_load_dwordx4 v28, s[16:19], s31 offen nt lds
    s_add_u32 s31, s33, 3735552
    s_add_u32 m0, s42, 26624
    s_nop 0
    buffer_load_dwordx4 v28, s[16:19], s31 offen nt lds
    s_add_u32 s31, s33, 3768320
    s_add_u32 m0, s42, 27648
    s_nop 0
    buffer_load_dwordx4 v28, s[16:19], s31 offen nt lds
    ds_read_b64_tr_b16 a[16:17], v30 offset:12288
    ds_read_b64_tr_b16 a[18:19], v30 offset:12800
    ds_read_b64_tr_b16 a[20:21], v30 offset:14336
    ds_read_b64_tr_b16 a[22:23], v30 offset:14848
    ds_read_b64_tr_b16 a[24:25], v30 offset:12320
    ds_read_b64_tr_b16 a[26:27], v30 offset:12832
    ds_read_b64_tr_b16 a[28:29], v30 offset:14368
    ds_read_b64_tr_b16 a[30:31], v30 offset:14880
    s_waitcnt lgkmcnt(0)
    s_waitcnt vmcnt(8)
    s_barrier
    s_add_u32 s31, s33, 4194304
    s_add_u32 m0, s42, 28672
    s_nop 0
    buffer_load_dwordx4 v28, s[16:19], s31 offen nt lds
    s_add_u32 s31, s33, 4227072
    s_add_u32 m0, s42, 29696
    s_nop 0
    buffer_load_dwordx4 v28, s[16:19], s31 offen nt lds
    s_add_u32 s31, s33, 4259840
    s_add_u32 m0, s42, 30720
    s_nop 0
    buffer_load_dwordx4 v28, s[16:19], s31 offen nt lds
    s_add_u32 s31, s33, 4292608
    s_add_u32 m0, s42, 31744
    s_nop 0
    buffer_load_dwordx4 v28, s[16:19], s31 offen nt lds
    ds_read_b64_tr_b16 a[32:33], v30 offset:16384
    ds_read_b64_tr_b16 a[34:35], v30 offset:16896
    ds_read_b64_tr_b16 a[36:37], v30 offset:18432
    ds_read_b64_tr_b16 a[38:39], v30 offset:18944
    ds_read_b64_tr_b16 a[40:41], v30 offset:16416
    ds_read_b64_tr_b16 a[42:43], v30 offset:16928
    ds_read_b64_tr_b16 a[44:45], v30 offset:18464
    ds_read_b64_tr_b16 a[46:47], v30 offset:18976
    s_waitcnt lgkmcnt(0)
    s_waitcnt vmcnt(8)
    s_barrier
    s_add_u32 s31, s33, 4718592
    s_add_u32 m0, s42, 0
    s_nop 0
    buffer_load_dwordx4 v28, s[16:19], s31 offen nt lds
    s_add_u32 s31, s33, 4751360
    s_add_u32 m0, s42, 1024
    s_nop 0
    buffer_load_dwordx4 v28, s[16:19], s31 offen nt lds
    s_add_u32 s31, s33, 4784128
    s_add_u32 m0, s42, 2048
    s_nop 0
    buffer_load_dwordx4 v28, s[16:19], s31 offen nt lds
    s_add_u32 s31, s33, 4816896
    s_add_u32 m0, s42, 3072
    s_nop 0
    buffer_load_dwordx4 v28, s[16:19], s31 offen nt lds
    ds_read_b64_tr_b16 a[48:49], v30 offset:20480
    ds_read_b64_tr_b16 a[50:51], v30 offset:20992
    ds_read_b64_tr_b16 a[52:53], v30 offset:22528
    ds_read_b64_tr_b16 a[54:55], v30 offset:23040
    ds_read_b64_tr_b16 a[56:57], v30 offset:20512
    ds_read_b64_tr_b16 a[58:59], v30 offset:21024
    ds_read_b64_tr_b16 a[60:61], v30 offset:22560
    ds_read_b64_tr_b16 a[62:63], v30 offset:23072
    s_waitcnt lgkmcnt(0)
    s_waitcnt vmcnt(8)
    s_barrier
    s_add_u32 s31, s33, 4194304
    s_add_u32 m0, s42, 4096
    s_nop 0
    buffer_load_dwordx4 v28, s[20:23], s31 offen nt lds
    s_add_u32 s31, s33, 4227072
    s_add_u32 m0, s42, 5120
    s_nop 0
    buffer_load_dwordx4 v28, s[20:23], s31 offen nt lds
    s_add_u32 s31, s33, 4259840
    s_add_u32 m0, s42, 6144
    s_nop 0
    buffer_load_dwordx4 v28, s[20:23], s31 offen nt lds
    s_add_u32 s31, s33, 4292608
    s_add_u32 m0, s42, 7168
    s_nop 0
    buffer_load_dwordx4 v28, s[20:23], s31 offen nt lds
    ds_read_b64_tr_b16 a[64:65], v30 offset:24576
    ds_read_b64_tr_b16 a[66:67], v30 offset:25088
    ds_read_b64_tr_b16 a[68:69], v30 offset:26624
    ds_read_b64_tr_b16 a[70:71], v30 offset:27136
    ds_read_b64_tr_b16 a[72:73], v30 offset:24608
    ds_read_b64_tr_b16 a[74:75], v30 offset:25120
    ds_read_b64_tr_b16 a[76:77], v30 offset:26656
    ds_read_b64_tr_b16 a[78:79], v30 offset:27168
    s_waitcnt lgkmcnt(0)
    s_waitcnt vmcnt(8)
    s_barrier
    s_add_u32 s31, s33, 4718592
    s_add_u32 m0, s42, 8192
    s_nop 0
    buffer_load_dwordx4 v28, s[20:23], s31 offen nt lds
    s_add_u32 s31, s33, 4751360
    s_add_u32 m0, s42, 9216
    s_nop 0
    buffer_load_dwordx4 v28, s[20:23], s31 offen nt lds
    s_add_u32 s31, s33, 4784128
    s_add_u32 m0, s42, 10240
    s_nop 0
    buffer_load_dwordx4 v28, s[20:23], s31 offen nt lds
    s_add_u32 s31, s33, 4816896
    s_add_u32 m0, s42, 11264
    s_nop 0
    buffer_load_dwordx4 v28, s[20:23], s31 offen nt lds
    ds_read_b64_tr_b16 a[80:81], v30 offset:28672
    ds_read_b64_tr_b16 a[82:83], v30 offset:29184
    ds_read_b64_tr_b16 a[84:85], v30 offset:30720
    ds_read_b64_tr_b16 a[86:87], v30 offset:31232
    ds_read_b64_tr_b16 a[88:89], v30 offset:28704
    ds_read_b64_tr_b16 a[90:91], v30 offset:29216
    ds_read_b64_tr_b16 a[92:93], v30 offset:30752
    ds_read_b64_tr_b16 a[94:95], v30 offset:31264
    s_waitcnt lgkmcnt(0)
    s_waitcnt vmcnt(8)
    s_barrier
    s_add_u32 s31, s34, 0
    s_add_u32 m0, s42, 12288
    s_nop 0
    buffer_load_dwordx4 v29, s[24:27], s31 offen nt lds
    s_add_u32 s31, s34, 5120
    s_add_u32 m0, s42, 13312
    s_nop 0
    buffer_load_dwordx4 v29, s[24:27], s31 offen nt lds
    s_add_u32 s31, s34, 10240
    s_add_u32 m0, s42, 14336
    s_nop 0
    buffer_load_dwordx4 v29, s[24:27], s31 offen nt lds
    s_add_u32 s31, s34, 15360
    s_add_u32 m0, s42, 15360
    s_nop 0
    buffer_load_dwordx4 v29, s[24:27], s31 offen nt lds
    ds_read_b64_tr_b16 a[96:97], v30 offset:0
    ds_read_b64_tr_b16 a[98:99], v30 offset:512
    ds_read_b64_tr_b16 a[100:101], v30 offset:2048
    ds_read_b64_tr_b16 a[102:103], v30 offset:2560
    ds_read_b64_tr_b16 a[104:105], v30 offset:32
    ds_read_b64_tr_b16 a[106:107], v30 offset:544
    ds_read_b64_tr_b16 a[108:109], v30 offset:2080
    ds_read_b64_tr_b16 a[110:111], v30 offset:2592
    s_waitcnt lgkmcnt(0)
    s_waitcnt vmcnt(8)
    s_barrier
    s_add_u32 s31, s34, 256
    s_add_u32 m0, s42, 16384
    s_nop 0
    buffer_load_dwordx4 v29, s[24:27], s31 offen nt lds
    s_add_u32 s31, s34, 5376
    s_add_u32 m0, s42, 17408
    s_nop 0
    buffer_load_dwordx4 v29, s[24:27], s31 offen nt lds
    s_add_u32 s31, s34, 10496
    s_add_u32 m0, s42, 18432
    s_nop 0
    buffer_load_dwordx4 v29, s[24:27], s31 offen nt lds
    s_add_u32 s31, s34, 15616
    s_add_u32 m0, s42, 19456
    s_nop 0
    buffer_load_dwordx4 v29, s[24:27], s31 offen nt lds
    ds_read_b64_tr_b16 a[112:113], v30 offset:4096
    ds_read_b64_tr_b16 a[114:115], v30 offset:4608
    ds_read_b64_tr_b16 a[116:117], v30 offset:6144
    ds_read_b64_tr_b16 a[118:119], v30 offset:6656
    ds_read_b64_tr_b16 a[120:121], v30 offset:4128
    ds_read_b64_tr_b16 a[122:123], v30 offset:4640
    ds_read_b64_tr_b16 a[124:125], v30 offset:6176
    ds_read_b64_tr_b16 a[126:127], v30 offset:6688
    s_waitcnt lgkmcnt(0)
    s_waitcnt vmcnt(8)
    s_barrier
    s_add_u32 s31, s34, 82176
    s_add_u32 m0, s42, 20480
    s_nop 0
    buffer_load_dwordx4 v29, s[24:27], s31 offen nt lds
    s_add_u32 s31, s34, 87296
    s_add_u32 m0, s42, 21504
    s_nop 0
    buffer_load_dwordx4 v29, s[24:27], s31 offen nt lds
    s_add_u32 s31, s34, 92416
    s_add_u32 m0, s42, 22528
    s_nop 0
    buffer_load_dwordx4 v29, s[24:27], s31 offen nt lds
    s_add_u32 s31, s34, 97536
    s_add_u32 m0, s42, 23552
    s_nop 0
    buffer_load_dwordx4 v29, s[24:27], s31 offen nt lds
    ds_read_b64_tr_b16 a[128:129], v30 offset:8192
    ds_read_b64_tr_b16 a[130:131], v30 offset:8704
    ds_read_b64_tr_b16 a[132:133], v30 offset:10240
    ds_read_b64_tr_b16 a[134:135], v30 offset:10752
    ds_read_b64_tr_b16 a[136:137], v30 offset:8224
    ds_read_b64_tr_b16 a[138:139], v30 offset:8736
    ds_read_b64_tr_b16 a[140:141], v30 offset:10272
    ds_read_b64_tr_b16 a[142:143], v30 offset:10784
    s_waitcnt lgkmcnt(0)
    s_waitcnt vmcnt(8)
    s_barrier
    s_add_u32 s31, s34, 82432
    s_add_u32 m0, s42, 24576
    s_nop 0
    buffer_load_dwordx4 v29, s[24:27], s31 offen nt lds
    s_add_u32 s31, s34, 87552
    s_add_u32 m0, s42, 25600
    s_nop 0
    buffer_load_dwordx4 v29, s[24:27], s31 offen nt lds
    s_add_u32 s31, s34, 92672
    s_add_u32 m0, s42, 26624
    s_nop 0
    buffer_load_dwordx4 v29, s[24:27], s31 offen nt lds
    s_add_u32 s31, s34, 97792
    s_add_u32 m0, s42, 27648
    s_nop 0
    buffer_load_dwordx4 v29, s[24:27], s31 offen nt lds
    ds_read_b64_tr_b16 a[144:145], v31 offset:12288
    ds_read_b64_tr_b16 a[146:147], v31 offset:12800
    ds_read_b64_tr_b16 a[148:149], v31 offset:14336
    ds_read_b64_tr_b16 a[150:151], v31 offset:14848
    ds_read_b64_tr_b16 a[152:153], v31 offset:12320
    ds_read_b64_tr_b16 a[154:155], v31 offset:12832
    ds_read_b64_tr_b16 a[156:157], v31 offset:14368
    ds_read_b64_tr_b16 a[158:159], v31 offset:14880
    s_waitcnt lgkmcnt(0)
    s_waitcnt vmcnt(8)
    s_barrier
    s_add_u32 s31, s34, 768
    s_add_u32 m0, s42, 28672
    s_nop 0
    buffer_load_dwordx4 v29, s[24:27], s31 offen nt lds
    s_add_u32 s31, s34, 5888
    s_add_u32 m0, s42, 29696
    s_nop 0
    buffer_load_dwordx4 v29, s[24:27], s31 offen nt lds
    s_add_u32 s31, s34, 11008
    s_add_u32 m0, s42, 30720
    s_nop 0
    buffer_load_dwordx4 v29, s[24:27], s31 offen nt lds
    s_add_u32 s31, s34, 16128
    s_add_u32 m0, s42, 31744
    s_nop 0
    buffer_load_dwordx4 v29, s[24:27], s31 offen nt lds
    ds_read_b64_tr_b16 a[160:161], v31 offset:16384
    ds_read_b64_tr_b16 a[162:163], v31 offset:16896
    ds_read_b64_tr_b16 a[164:165], v31 offset:18432
    ds_read_b64_tr_b16 a[166:167], v31 offset:18944
    ds_read_b64_tr_b16 a[168:169], v31 offset:16416
    ds_read_b64_tr_b16 a[170:171], v31 offset:16928
    ds_read_b64_tr_b16 a[172:173], v31 offset:18464
    ds_read_b64_tr_b16 a[174:175], v31 offset:18976
    s_waitcnt lgkmcnt(0)
    s_waitcnt vmcnt(8)
    s_barrier
    s_add_u32 s31, s34, 1024
    s_add_u32 m0, s42, 0
    s_nop 0
    buffer_load_dwordx4 v29, s[24:27], s31 offen nt lds
    s_add_u32 s31, s34, 6144
    s_add_u32 m0, s42, 1024
    s_nop 0
    buffer_load_dwordx4 v29, s[24:27], s31 offen nt lds
    s_add_u32 s31, s34, 11264
    s_add_u32 m0, s42, 2048
    s_nop 0
    buffer_load_dwordx4 v29, s[24:27], s31 offen nt lds
    s_add_u32 s31, s34, 16384
    s_add_u32 m0, s42, 3072
    s_nop 0
    buffer_load_dwordx4 v29, s[24:27], s31 offen nt lds
    ds_read_b64_tr_b16 a[176:177], v31 offset:20480
    ds_read_b64_tr_b16 a[178:179], v31 offset:20992
    ds_read_b64_tr_b16 a[180:181], v31 offset:22528
    ds_read_b64_tr_b16 a[182:183], v31 offset:23040
    ds_read_b64_tr_b16 a[184:185], v31 offset:20512
    ds_read_b64_tr_b16 a[186:187], v31 offset:21024
    ds_read_b64_tr_b16 a[188:189], v31 offset:22560
    ds_read_b64_tr_b16 a[190:191], v31 offset:23072
    s_waitcnt lgkmcnt(0)
    s_waitcnt vmcnt(8)
    s_barrier
    s_add_u32 s31, s34, 82944
    s_add_u32 m0, s42, 4096
    s_nop 0
    buffer_load_dwordx4 v29, s[24:27], s31 offen nt lds
    s_add_u32 s31, s34, 88064
    s_add_u32 m0, s42, 5120
    s_nop 0
    buffer_load_dwordx4 v29, s[24:27], s31 offen nt lds
    s_add_u32 s31, s34, 93184
    s_add_u32 m0, s42, 6144
    s_nop 0
    buffer_load_dwordx4 v29, s[24:27], s31 offen nt lds
    s_add_u32 s31, s34, 98304
    s_add_u32 m0, s42, 7168
    s_nop 0
    buffer_load_dwordx4 v29, s[24:27], s31 offen nt lds
    ds_read_b64_tr_b16 a[192:193], v31 offset:24576
    ds_read_b64_tr_b16 a[194:195], v31 offset:25088
    ds_read_b64_tr_b16 a[196:197], v31 offset:26624
    ds_read_b64_tr_b16 a[198:199], v31 offset:27136
    ds_read_b64_tr_b16 a[200:201], v31 offset:24608
    ds_read_b64_tr_b16 a[202:203], v31 offset:25120
    ds_read_b64_tr_b16 a[204:205], v31 offset:26656
    ds_read_b64_tr_b16 a[206:207], v31 offset:27168
    s_waitcnt lgkmcnt(0)
    s_waitcnt vmcnt(8)
    s_barrier
    s_add_u32 s31, s33, 0
    s_add_u32 m0, s42, 8192
    s_nop 0
    buffer_load_dwordx4 v28, s[12:15], s31 offen nt lds
    s_add_u32 s31, s33, 32768
    s_add_u32 m0, s42, 9216
    s_nop 0
    buffer_load_dwordx4 v28, s[12:15], s31 offen nt lds
    s_add_u32 s31, s33, 65536
    s_add_u32 m0, s42, 10240
    s_nop 0
    buffer_load_dwordx4 v28, s[12:15], s31 offen nt lds
    s_add_u32 s31, s33, 98304
    s_add_u32 m0, s42, 11264
    s_nop 0
    buffer_load_dwordx4 v28, s[12:15], s31 offen nt lds
    ds_read_b64_tr_b16 a[208:209], v31 offset:28672
    ds_read_b64_tr_b16 a[210:211], v31 offset:29184
    ds_read_b64_tr_b16 a[212:213], v31 offset:30720
    ds_read_b64_tr_b16 a[214:215], v31 offset:31232
    ds_read_b64_tr_b16 a[216:217], v31 offset:28704
    ds_read_b64_tr_b16 a[218:219], v31 offset:29216
    ds_read_b64_tr_b16 a[220:221], v31 offset:30752
    ds_read_b64_tr_b16 a[222:223], v31 offset:31264
    s_waitcnt lgkmcnt(0)
    s_waitcnt vmcnt(8)
    s_barrier
    s_add_u32 s31, s33, 0
    s_add_u32 m0, s42, 12288
    s_nop 0
    buffer_load_dwordx4 v28, s[16:19], s31 offen nt lds
    s_add_u32 s31, s33, 32768
    s_add_u32 m0, s42, 13312
    s_nop 0
    buffer_load_dwordx4 v28, s[16:19], s31 offen nt lds
    s_add_u32 s31, s33, 65536
    s_add_u32 m0, s42, 14336
    s_nop 0
    buffer_load_dwordx4 v28, s[16:19], s31 offen nt lds
    s_add_u32 s31, s33, 98304
    s_add_u32 m0, s42, 15360
    s_nop 0
    buffer_load_dwordx4 v28, s[16:19], s31 offen nt lds
    ds_read_b64_tr_b16 a[224:225], v31 offset:0
    ds_read_b64_tr_b16 a[226:227], v31 offset:512
    ds_read_b64_tr_b16 a[228:229], v31 offset:2048
    ds_read_b64_tr_b16 a[230:231], v31 offset:2560
    ds_read_b64_tr_b16 a[232:233], v31 offset:32
    ds_read_b64_tr_b16 a[234:235], v31 offset:544
    ds_read_b64_tr_b16 a[236:237], v31 offset:2080
    ds_read_b64_tr_b16 a[238:239], v31 offset:2592
    s_waitcnt lgkmcnt(0)
    s_waitcnt vmcnt(8)
    s_barrier
    s_add_u32 s31, s33, 1048576
    s_add_u32 m0, s42, 16384
    s_nop 0
    buffer_load_dwordx4 v28, s[16:19], s31 offen nt lds
    s_add_u32 s31, s33, 1081344
    s_add_u32 m0, s42, 17408
    s_nop 0
    buffer_load_dwordx4 v28, s[16:19], s31 offen nt lds
    s_add_u32 s31, s33, 1114112
    s_add_u32 m0, s42, 18432
    s_nop 0
    buffer_load_dwordx4 v28, s[16:19], s31 offen nt lds
    s_add_u32 s31, s33, 1146880
    s_add_u32 m0, s42, 19456
    s_nop 0
    buffer_load_dwordx4 v28, s[16:19], s31 offen nt lds
    ds_read_b64_tr_b16 a[240:241], v31 offset:4096
    ds_read_b64_tr_b16 a[242:243], v31 offset:4608
    ds_read_b64_tr_b16 a[244:245], v31 offset:6144
    ds_read_b64_tr_b16 a[246:247], v31 offset:6656
    ds_read_b64_tr_b16 a[248:249], v31 offset:4128
    ds_read_b64_tr_b16 a[250:251], v31 offset:4640
    ds_read_b64_tr_b16 a[252:253], v31 offset:6176
    ds_read_b64_tr_b16 a[254:255], v31 offset:6688
    s_waitcnt lgkmcnt(0)
    s_waitcnt vmcnt(8)
    s_barrier
    s_add_u32 s31, s34, 81920
    s_add_u32 m0, s42, 20480
    s_nop 0
    buffer_load_dwordx4 v29, s[24:27], s31 offen nt lds
    s_add_u32 s31, s34, 87040
    s_add_u32 m0, s42, 21504
    s_nop 0
    buffer_load_dwordx4 v29, s[24:27], s31 offen nt lds
    s_add_u32 s31, s34, 92160
    s_add_u32 m0, s42, 22528
    s_nop 0
    buffer_load_dwordx4 v29, s[24:27], s31 offen nt lds
    s_add_u32 s31, s34, 97280
    s_add_u32 m0, s42, 23552
    s_nop 0
    buffer_load_dwordx4 v29, s[24:27], s31 offen nt lds
    ds_read_b64_tr_b16 v[48:49], v30 offset:8192
    ds_read_b64_tr_b16 v[50:51], v30 offset:8704
    ds_read_b64_tr_b16 v[52:53], v30 offset:10240
    ds_read_b64_tr_b16 v[54:55], v30 offset:10752
    ds_read_b64_tr_b16 v[56:57], v30 offset:8224
    ds_read_b64_tr_b16 v[58:59], v30 offset:8736
    ds_read_b64_tr_b16 v[60:61], v30 offset:10272
    ds_read_b64_tr_b16 v[62:63], v30 offset:10784
    s_waitcnt lgkmcnt(0)
    s_waitcnt vmcnt(8)
    s_barrier
    s_add_u32 s31, s34, 512
    s_add_u32 m0, s42, 24576
    s_nop 0
    buffer_load_dwordx4 v29, s[24:27], s31 offen nt lds
    s_add_u32 s31, s34, 5632
    s_add_u32 m0, s42, 25600
    s_nop 0
    buffer_load_dwordx4 v29, s[24:27], s31 offen nt lds
    s_add_u32 s31, s34, 10752
    s_add_u32 m0, s42, 26624
    s_nop 0
    buffer_load_dwordx4 v29, s[24:27], s31 offen nt lds
    s_add_u32 s31, s34, 15872
    s_add_u32 m0, s42, 27648
    s_nop 0
    buffer_load_dwordx4 v29, s[24:27], s31 offen nt lds
    ds_write_b128 v4, v[48:51] offset:8192
    ds_write_b128 v4, v[52:55] offset:9216
    ds_write_b128 v4, v[56:59] offset:10240
    ds_write_b128 v4, v[60:63] offset:11264
    ds_read_b64_tr_b16 v[64:65], v30 offset:12288
    ds_read_b64_tr_b16 v[66:67], v30 offset:12800
    ds_read_b64_tr_b16 v[68:69], v30 offset:14336
    ds_read_b64_tr_b16 v[70:71], v30 offset:14848
    ds_read_b64_tr_b16 v[72:73], v30 offset:12320
    ds_read_b64_tr_b16 v[74:75], v30 offset:12832
    ds_read_b64_tr_b16 v[76:77], v30 offset:14368
    ds_read_b64_tr_b16 v[78:79], v30 offset:14880
    s_waitcnt lgkmcnt(0)
    s_waitcnt vmcnt(8)
    s_barrier
    s_add_u32 s31, s34, 82688
    s_add_u32 m0, s42, 28672
    s_nop 0
    buffer_load_dwordx4 v29, s[24:27], s31 offen nt lds
    s_add_u32 s31, s34, 87808
    s_add_u32 m0, s42, 29696
    s_nop 0
    buffer_load_dwordx4 v29, s[24:27], s31 offen nt lds
    s_add_u32 s31, s34, 92928
    s_add_u32 m0, s42, 30720
    s_nop 0
    buffer_load_dwordx4 v29, s[24:27], s31 offen nt lds
    s_add_u32 s31, s34, 98048
    s_add_u32 m0, s42, 31744
    s_nop 0
    buffer_load_dwordx4 v29, s[24:27], s31 offen nt lds
    ds_write_b128 v4, v[64:67] offset:12288
    ds_write_b128 v4, v[68:71] offset:13312
    ds_write_b128 v4, v[72:75] offset:14336
    ds_write_b128 v4, v[76:79] offset:15360
    ds_read_b64_tr_b16 v[48:49], v30 offset:16384
    ds_read_b64_tr_b16 v[50:51], v30 offset:16896
    ds_read_b64_tr_b16 v[52:53], v30 offset:18432
    ds_read_b64_tr_b16 v[54:55], v30 offset:18944
    ds_read_b64_tr_b16 v[56:57], v30 offset:16416
    ds_read_b64_tr_b16 v[58:59], v30 offset:16928
    ds_read_b64_tr_b16 v[60:61], v30 offset:18464
    ds_read_b64_tr_b16 v[62:63], v30 offset:18976
    s_waitcnt lgkmcnt(0)
    s_waitcnt vmcnt(8)
    s_barrier
    ds_write_b128 v4, v[48:51] offset:16384
    ds_write_b128 v4, v[52:55] offset:17408
    ds_write_b128 v4, v[56:59] offset:18432
    ds_write_b128 v4, v[60:63] offset:19456
    ds_read_b64_tr_b16 v[64:65], v31 offset:20480
    ds_read_b64_tr_b16 v[66:67], v31 offset:20992
    ds_read_b64_tr_b16 v[68:69], v31 offset:22528
    ds_read_b64_tr_b16 v[70:71], v31 offset:23040
    ds_read_b64_tr_b16 v[72:73], v31 offset:20512
    ds_read_b64_tr_b16 v[74:75], v31 offset:21024
    ds_read_b64_tr_b16 v[76:77], v31 offset:22560
    ds_read_b64_tr_b16 v[78:79], v31 offset:23072
    s_waitcnt lgkmcnt(0)
    s_waitcnt vmcnt(4)
    s_barrier
    ds_write_b128 v4, v[64:67] offset:20480
    ds_write_b128 v4, v[68:71] offset:21504
    ds_write_b128 v4, v[72:75] offset:22528
    ds_write_b128 v4, v[76:79] offset:23552
    ds_read_b64_tr_b16 v[48:49], v31 offset:24576
    ds_read_b64_tr_b16 v[50:51], v31 offset:25088
    ds_read_b64_tr_b16 v[52:53], v31 offset:26624
    ds_read_b64_tr_b16 v[54:55], v31 offset:27136
    ds_read_b64_tr_b16 v[56:57], v31 offset:24608
    ds_read_b64_tr_b16 v[58:59], v31 offset:25120
    ds_read_b64_tr_b16 v[60:61], v31 offset:26656
    ds_read_b64_tr_b16 v[62:63], v31 offset:27168
    s_waitcnt lgkmcnt(0)
    s_waitcnt vmcnt(0)
    s_barrier
    ds_write_b128 v4, v[48:51] offset:24576
    ds_write_b128 v4, v[52:55] offset:25600
    ds_write_b128 v4, v[56:59] offset:26624
    ds_write_b128 v4, v[60:63] offset:27648
    ds_read_b64_tr_b16 v[64:65], v31 offset:28672
    ds_read_b64_tr_b16 v[66:67], v31 offset:29184
    ds_read_b64_tr_b16 v[68:69], v31 offset:30720
    ds_read_b64_tr_b16 v[70:71], v31 offset:31232
    ds_read_b64_tr_b16 v[72:73], v31 offset:28704
    ds_read_b64_tr_b16 v[74:75], v31 offset:29216
    ds_read_b64_tr_b16 v[76:77], v31 offset:30752
    ds_read_b64_tr_b16 v[78:79], v31 offset:31264
    s_waitcnt lgkmcnt(0)
    s_barrier
    ds_write_b128 v4, v[64:67] offset:28672
    ds_write_b128 v4, v[68:71] offset:29696
    ds_write_b128 v4, v[72:75] offset:30720
    ds_write_b128 v4, v[76:79] offset:31744
    s_waitcnt lgkmcnt(0)
    s_barrier
    v_and_b32 v28, 16, v0
    s_mov_b32 s31, 0x3f80
    v_lshlrev_b32 v28, v28, s31
    v_bfe_u32 v29, v0, 5, 2
    v_cmp_eq_u32 vcc, 0, v29
    s_nop 1
    v_cndmask_b32 v16, 0, v28, vcc
    v_mov_b32 v20, 0x3f803f80
    v_cmp_eq_u32 vcc, 1, v29
    s_nop 1
    v_cndmask_b32 v17, 0, v28, vcc
    v_mov_b32 v21, 0x3f803f80
    v_cmp_eq_u32 vcc, 2, v29
    s_nop 1
    v_cndmask_b32 v18, 0, v28, vcc
    v_mov_b32 v22, 0x3f803f80
    v_cmp_eq_u32 vcc, 3, v29
    s_nop 1
    v_cndmask_b32 v19, 0, v28, vcc
    v_mov_b32 v23, 0x3f803f80
    v_mov_b32 v25, 0
    v_mov_b32 v26, 0
    s_add_u32 s44, s64, 65536
    s_add_u32 s50, s50, 1048576
    s_add_u32 s51, s50, 65536
    s_add_u32 s52, s50, 131072
    s_add_u32 s53, s50, 196608
    s_add_u32 s54, s50, 262144
    s_lshl_b32 s31, s36, 12
    s_add_u32 s60, s31, 1048576
    s_lshl_b32 s55, s36, 7
    s_add_u32 s55, s55, 65536
    s_mov_b32 s56, s55
    s_add_u32 s57, s55, 16384
    s_lshl_b32 s43, s28, 13
    s_lshl_b32 s31, s29, 11
    s_add_u32 s70, s31, s43
    s_add_u32 s72, s70, 17039360
    s_add_u32 s70, s70, 33554432
    s_add_u32 s59, s31, 16384
    s_lshr_b32 s31, s29, 1
    s_lshl_b32 s31, s31, 10
    s_and_b32 s32, s29, 1
    s_lshl_b32 s32, s32, 12
    s_add_u32 s58, s31, s32
    s_add_u32 s58, s58, s43
    s_add_u32 s58, s58, 16777216
    v_mov_b32 v36, 0
    s_branch adaLN_cond__memory_aug_recurrent_mem_tr__glu_gated_swiglu__prompt_kernel_ib1
adaLN_cond__memory_aug_recurrent_mem_tr__glu_gated_swiglu__prompt_kernel_ib0:
    s_sleep 4
adaLN_cond__memory_aug_recurrent_mem_tr__glu_gated_swiglu__prompt_kernel_ib1:
    buffer_load_dwordx2 v[28:29], v36, s[8:11], 0 offen offset:128 sc1
    buffer_load_dwordx2 v[30:31], v36, s[8:11], 0 offen offset:160 sc1
    s_mov_b32 s34, 303104
    buffer_load_dword v32, v36, s[8:11], 0 offen sc1
    buffer_load_dword v33, v12, s[4:7], s34 offen sc1
    s_waitcnt vmcnt(0)
    v_readfirstlane_b32 s32, v29
    v_sad_u8 v34, v30, 0, 0
    v_sad_u8 v34, v31, 0, v34
    v_or_b32 v30, v30, v31
    v_readfirstlane_b32 s33, v34
    v_readfirstlane_b32 s35, v30
    s_and_b32 s31, s32, 0xffff
    s_min_u32 s31, s31, s33
    s_cmp_lt_u32 s31, 32
    s_cbranch_scc1 adaLN_cond__memory_aug_recurrent_mem_tr__glu_gated_swiglu__prompt_kernel_ib0
    v_readfirstlane_b32 s31, v32
    s_nop 0
    s_cmp_lt_u32 s31, 1
    s_cbranch_scc1 adaLN_cond__memory_aug_recurrent_mem_tr__glu_gated_swiglu__prompt_kernel_ib0
    v_cmp_le_u32 vcc, 32, v33
    s_nop 0
    s_and_b32 s16, vcc_lo, 0xffff
    s_ff0_i32_b32 s16, s16
    s_cmp_eq_u32 s16, 0
    s_cbranch_scc1 adaLN_cond__memory_aug_recurrent_mem_tr__glu_gated_swiglu__prompt_kernel_ib0
    s_mov_b32 m0, s59
    s_add_u32 s31, s58, 2048
    buffer_load_dwordx4 v9, s[4:7], s58 offen nt lds
    s_add_u32 m0, s59, 1024
    s_add_u32 s58, s58, 262144
    buffer_load_dwordx4 v9, s[4:7], s31 offen nt lds
    s_add_u32 m0, s59, 8192
    s_nop 0
    buffer_load_dwordx4 v0, s[4:7], s70 offen nt lds
    buffer_load_dwordx4 v0, s[4:7], s70 offen offset:1024 nt lds
    s_add_u32 s70, s70, 262144
    s_lshr_b32 s32, s32, 16
    s_cmp_ge_u32 s32, 16
    s_cselect_b32 s31, 8192, 0
    s_add_u32 s63, s63, s31
    s_add_u32 s66, s66, s63
    s_mov_b32 s67, s66
    s_lshl_b32 s68, s36, 7
    s_cmp_ge_u32 s36, 64
    s_cselect_b32 s31, 8192, 0
    s_add_u32 s68, s68, s31
    s_add_u32 s68, s68, s63
    s_cmp_ge_u32 s36, 80
    s_cselect_b32 s68, 0x40000000, s68
    s_cmp_lt_u32 s36, 64
    s_cselect_b32 s73, s68, 0x40000000
    s_cselect_b32 s74, 0x40000000, s68
    s_add_u32 s75, s73, 32768
    s_mov_b32 s47, 0x40000000
    s_add_u32 s65, s68, 65536
    s_and_b32 s35, s35, 0x1f1f1f1f
    s_mov_b32 s13, s16
    s_lshl_b32 s12, s16, 7
    s_add_u32 s12, s12, 303104
    s_add_u32 s31, s30, 5
    s_min_u32 s31, s31, 64
    s_cmp_lt_u32 s16, s31
    s_cselect_b32 s12, s12, 0x40000000
    ds_read_b128 v[88:91], v4 offset:8192
    ds_read_b128 v[92:95], v4 offset:9216
    ds_read_b128 v[80:83], v4 offset:10240
    ds_read_b128 v[84:87], v4 offset:11264
    ds_read_b128 v[72:75], v4 offset:12288
    ds_read_b128 v[76:79], v4 offset:13312
    ds_read_b128 v[64:67], v4 offset:14336
    ds_read_b128 v[68:71], v4 offset:15360
    s_waitcnt lgkmcnt(0)
    s_cmp_lg_u32 s35, 0
    s_cbranch_scc1 adaLN_cond__memory_aug_recurrent_mem_tr__glu_gated_swiglu__prompt_kernel_slow
adaLN_cond__memory_aug_recurrent_mem_tr__glu_gated_swiglu__prompt_kernel_fast:
    v_add_u32 v51, s64, v0
    s_barrier
    s_sleep 3
adaLN_cond__memory_aug_recurrent_mem_tr__glu_gated_swiglu__prompt_kernel_fast_pollA:
    buffer_load_dwordx4 v[28:31], v0, s[4:7], s44 offen offset:0 sc1
    buffer_load_dwordx4 v[32:35], v0, s[4:7], s44 offen offset:1024 sc1
    buffer_load_dwordx4 v[36:39], v0, s[4:7], s44 offen offset:1536 sc1
    s_waitcnt vmcnt(2)
    ds_write_b128 v51, v[28:31] offset:0
    s_waitcnt vmcnt(1)
    ds_write_b128 v51, v[32:35] offset:1024
    s_waitcnt vmcnt(0)
    ds_write_b128 v51, v[36:39] offset:1536
    v_max3_u32 v50, v28, v32, v36
    v_cmp_eq_u32 vcc, -1, v50
    s_nop 0
    s_mov_b64 exec, vcc
    s_cbranch_execnz adaLN_cond__memory_aug_recurrent_mem_tr__glu_gated_swiglu__prompt_kernel_fast_pollA
    s_mov_b64 exec, -1
    s_waitcnt lgkmcnt(0)
adaLN_cond__memory_aug_recurrent_mem_tr__glu_gated_swiglu__prompt_kernel_fast_gd:
    s_barrier
    ds_read_b64_tr_b16 v[44:45], v2 offset:0
    ds_read_b64_tr_b16 v[46:47], v2 offset:512
    ds_read_b64_tr_b16 v[48:49], v2 offset:1024
    ds_read_b64_tr_b16 v[50:51], v2 offset:1536
    v_mov_b64 v[28:29], 0
    v_mov_b64 v[30:31], 0
    v_mov_b64 v[32:33], 0
    v_mov_b64 v[34:35], 0
    v_mov_b64 v[36:37], 0
    v_mov_b64 v[38:39], 0
    v_mov_b64 v[40:41], 0
    v_mov_b64 v[42:43], 0
    s_waitcnt lgkmcnt(2)
    v_smfmac_f32_16x16x64_bf16 v[28:31], v[44:47], v[88:95], v1
    ds_read_b64_tr_b16 v[52:53], v2 offset:2048
    ds_read_b64_tr_b16 v[54:55], v2 offset:2560
    v_smfmac_f32_16x16x64_bf16 v[32:35], v[44:47], v[80:87], v1
    s_add_u32 s33, s30, 2
    s_cmp_ge_u32 s16, s33
    s_cbranch_scc1 adaLN_cond__memory_aug_recurrent_mem_tr__glu_gated_swiglu__prompt_kernel_fast_kv_ok
adaLN_cond__memory_aug_recurrent_mem_tr__glu_gated_swiglu__prompt_kernel_fast_kv_spin:
    s_lshl_b32 s34, s16, 7
    s_add_u32 s34, s34, 303104
    buffer_load_dword v13, v12, s[4:7], s34 offen sc1
    s_waitcnt vmcnt(0)
    v_cmp_le_u32 vcc, 32, v13
    s_nop 0
    s_and_b32 s34, vcc_lo, 0xffff
    s_ff0_i32_b32 s34, s34
    s_add_u32 s16, s16, s34
    s_cmp_ge_u32 s16, s33
    s_cbranch_scc0 adaLN_cond__memory_aug_recurrent_mem_tr__glu_gated_swiglu__prompt_kernel_fast_kv_spin
adaLN_cond__memory_aug_recurrent_mem_tr__glu_gated_swiglu__prompt_kernel_fast_kv_ok:
    v_smfmac_f32_16x16x64_bf16 v[36:39], v[44:47], v[72:79], v1
    buffer_load_dword v13, v12, s[4:7], s72 offen
    buffer_store_dword v11, v10, s[4:7], s47 offen sc1
    v_smfmac_f32_16x16x64_bf16 v[40:43], v[44:47], v[64:71], v1
    buffer_store_dword v14, v10, s[4:7], s65 offen sc1
    buffer_load_dword v11, v12, s[4:7], s12 offen sc1
    s_waitcnt lgkmcnt(2)
    v_smfmac_f32_16x16x64_bf16 v[28:31], v[48:51], v[96:103], v1
    ds_read_b128 v[88:91], v4 offset:16384
    ds_read_b128 v[92:95], v4 offset:17408
    ds_read_b64_tr_b16 v[44:45], v2 offset:3072
    ds_read_b64_tr_b16 v[46:47], v2 offset:3584
    v_smfmac_f32_16x16x64_bf16 v[32:35], v[48:51], v[104:111], v1
    ds_read_b128 v[80:83], v4 offset:18432
    ds_read_b128 v[84:87], v4 offset:19456
    v_smfmac_f32_16x16x64_bf16 v[36:39], v[48:51], v[112:119], v1
    v_smfmac_f32_16x16x64_bf16 v[40:43], v[48:51], v[120:127], v1
    s_waitcnt lgkmcnt(6)
    v_smfmac_f32_16x16x64_bf16 v[28:31], v[52:55], v[128:135], v1
    ds_read_b64_tr_b16 v[48:49], v2 offset:4096
    ds_read_b64_tr_b16 v[50:51], v2 offset:4608
    v_smfmac_f32_16x16x64_bf16 v[32:35], v[52:55], v[136:143], v1
    s_waitcnt lgkmcnt(6)
    v_smfmac_f32_16x16x64_bf16 v[36:39], v[52:55], v[88:95], v1
    s_waitcnt lgkmcnt(2)
    v_smfmac_f32_16x16x64_bf16 v[40:43], v[52:55], v[80:87], v1
    v_smfmac_f32_16x16x64_bf16 v[28:31], v[44:47], v[144:151], v1
    ds_read_b64_tr_b16 v[52:53], v2 offset:5120
    ds_read_b64_tr_b16 v[54:55], v2 offset:5632
    v_smfmac_f32_16x16x64_bf16 v[32:35], v[44:47], v[152:159], v1
    v_smfmac_f32_16x16x64_bf16 v[36:39], v[44:47], v[160:167], v1
    v_smfmac_f32_16x16x64_bf16 v[40:43], v[44:47], v[168:175], v1
    s_waitcnt lgkmcnt(2)
    v_smfmac_f32_16x16x64_bf16 v[28:31], v[48:51], v[176:183], v1
    ds_read_b64_tr_b16 v[44:45], v2 offset:6144
    ds_read_b64_tr_b16 v[46:47], v2 offset:6656
    v_smfmac_f32_16x16x64_bf16 v[32:35], v[48:51], v[184:191], v1
    v_smfmac_f32_16x16x64_bf16 v[36:39], v[48:51], v[192:199], v1
    ds_read_b64_tr_b16 v[56:57], v2 offset:7168
    ds_read_b64_tr_b16 v[58:59], v2 offset:7680
    v_smfmac_f32_16x16x64_bf16 v[40:43], v[48:51], v[200:207], v1
    s_waitcnt lgkmcnt(4)
    v_smfmac_f32_16x16x64_bf16 v[28:31], v[52:55], v[208:215], v1
    ds_read_b64_tr_b16 v[48:49], v2 offset:8192
    ds_read_b64_tr_b16 v[50:51], v2 offset:8704
    s_add_u32 s31, s72, 16777216
    buffer_load_dword v13, v12, s[4:7], s31 offen
    v_smfmac_f32_16x16x64_bf16 v[32:35], v[52:55], v[216:223], v1
    v_smfmac_f32_16x16x64_bf16 v[36:39], v[52:55], v[224:231], v1
    ds_read_b64_tr_b16 v[60:61], v2 offset:9216
    ds_read_b64_tr_b16 v[62:63], v2 offset:9728
    v_smfmac_f32_16x16x64_bf16 v[40:43], v[52:55], v[232:239], v1
    s_waitcnt lgkmcnt(6)
    v_smfmac_f32_16x16x64_bf16 v[28:31], v[44:47], v[240:247], v1
    v_smfmac_f32_16x16x64_bf16 v[32:35], v[44:47], v[248:255], v1
    s_waitcnt lgkmcnt(4)
    v_smfmac_f32_16x16x64_bf16 v[28:31], v[56:59], a[0:7], v1
    v_smfmac_f32_16x16x64_bf16 v[32:35], v[56:59], a[8:15], v1
    s_waitcnt lgkmcnt(2)
    v_smfmac_f32_16x16x64_bf16 v[28:31], v[48:51], a[16:23], v1
    v_smfmac_f32_16x16x64_bf16 v[32:35], v[48:51], a[24:31], v1
    s_waitcnt lgkmcnt(0)
    v_smfmac_f32_16x16x64_bf16 v[28:31], v[60:63], a[32:39], v1
    v_smfmac_f32_16x16x64_bf16 v[32:35], v[60:63], a[40:47], v1
    v_smfmac_f32_16x16x64_bf16 v[36:39], v[44:47], a[48:55], v1
    ds_read_b128 v[52:55], v0 offset:16384
    ds_read_b128 v[64:67], v0 offset:20480
    v_smfmac_f32_16x16x64_bf16 v[40:43], v[44:47], a[56:63], v1
    s_nop 2
    v_pk_add_f32 v[28:29], v[28:29], v[30:31]
    v_cvt_pk_bf16_f32 v88, v28, v29
    v_pk_add_f32 v[32:33], v[32:33], v[34:35]
    v_smfmac_f32_16x16x64_bf16 v[36:39], v[56:59], a[64:71], v1
    v_cvt_pk_bf16_f32 v89, v32, v33
    ds_write2st64_b32 v5, v88, v89 offset0:0 offset1:1
    v_smfmac_f32_16x16x64_bf16 v[40:43], v[56:59], a[72:79], v1
    ds_read_b128 v[44:47], v0 offset:17408
    v_smfmac_f32_16x16x64_bf16 v[36:39], v[48:51], a[80:87], v1
    ds_read_b128 v[56:59], v0 offset:21504
    v_smfmac_f32_16x16x64_bf16 v[40:43], v[48:51], a[88:95], v1
    ds_read_b128 v[48:51], v0 offset:18432
    s_waitcnt lgkmcnt(3)
    s_barrier
    ds_read_b64_tr_b16 v[68:69], v3 offset:0
    ds_read_b64_tr_b16 v[70:71], v3 offset:256
    v_smfmac_f32_16x16x64_bf16 v[36:39], v[60:63], a[96:103], v1
    ds_read_b64_tr_b16 v[72:73], v3 offset:512
    ds_read_b64_tr_b16 v[74:75], v3 offset:768
    ds_read_b64_tr_b16 v[76:77], v3 offset:1024
    ds_read_b64_tr_b16 v[78:79], v3 offset:1280
    v_smfmac_f32_16x16x64_bf16 v[40:43], v[60:63], a[104:111], v1
    ds_read_b128 v[60:63], v0 offset:22528
    ds_read_b64_tr_b16 v[80:81], v3 offset:1536
    ds_read_b64_tr_b16 v[82:83], v3 offset:1792
    ds_read_b128 v[84:87], v0 offset:19456
    v_pk_add_f32 v[36:37], v[36:37], v[38:39]
    v_cvt_pk_bf16_f32 v90, v36, v37
    s_nop 1
    v_pk_add_f32 v[40:41], v[40:41], v[42:43]
    v_cvt_pk_bf16_f32 v91, v40, v41
    ds_write2st64_b32 v5, v90, v91 offset0:8 offset1:9
    s_waitcnt lgkmcnt(9)
    v_mfma_f32_16x16x32_bf16 v[28:31], v[52:55], v[68:71], 0
    ds_read_b128 v[52:55], v0 offset:23552
    v_mfma_f32_16x16x32_bf16 v[32:35], v[64:67], v[68:71], 0
    s_waitcnt lgkmcnt(8)
    v_mfma_f32_16x16x32_bf16 v[28:31], v[44:47], v[72:75], v[28:31]
    v_mfma_f32_16x16x32_bf16 v[32:35], v[56:59], v[72:75], v[32:35]
    s_waitcnt lgkmcnt(1)
    s_barrier
    ds_read_b64_tr_b16 v[40:41], v3 offset:2048
    ds_read_b64_tr_b16 v[42:43], v3 offset:2304
    ds_read_b64_tr_b16 v[44:45], v3 offset:2560
    ds_read_b64_tr_b16 v[46:47], v3 offset:2816
    ds_read_b64_tr_b16 v[56:57], v3 offset:3072
    ds_read_b64_tr_b16 v[58:59], v3 offset:3328
    ds_read_b64_tr_b16 v[64:65], v3 offset:3584
    ds_read_b64_tr_b16 v[66:67], v3 offset:3840
    v_mfma_f32_16x16x32_bf16 v[28:31], v[48:51], v[76:79], v[28:31]
    v_mfma_f32_16x16x32_bf16 v[32:35], v[60:63], v[76:79], v[32:35]
    v_mfma_f32_16x16x32_bf16 v[28:31], v[84:87], v[80:83], v[28:31]
    s_waitcnt lgkmcnt(8)
    v_mfma_f32_16x16x32_bf16 v[32:35], v[52:55], v[80:83], v[32:35]
    buffer_load_dwordx4 v[92:95], v0, s[4:7], s67 offen sc1
    s_waitcnt lgkmcnt(6)
    v_mfma_f32_16x16x32_bf16 v[36:39], v[40:43], v[68:71], 0
    s_waitcnt lgkmcnt(4)
    v_mfma_f32_16x16x32_bf16 v[36:39], v[44:47], v[72:75], v[36:39]
    s_waitcnt lgkmcnt(2)
    v_mfma_f32_16x16x32_bf16 v[36:39], v[56:59], v[76:79], v[36:39]
    s_waitcnt lgkmcnt(0)
    v_mfma_f32_16x16x32_bf16 v[36:39], v[64:67], v[80:83], v[36:39]
    ds_read_b64_tr_b16 v[48:49], v2 offset:8192
    ds_read_b64_tr_b16 v[50:51], v2 offset:8704
    ds_read_b64_tr_b16 v[52:53], v2 offset:9216
    ds_read_b64_tr_b16 v[54:55], v2 offset:9728
    v_mov_b64 v[40:41], 0
    v_mov_b64 v[42:43], 0
    v_mov_b64 v[44:45], 0
    v_mov_b64 v[46:47], 0
    v_add_u32 v80, s59, v0
    v_max3_f32 v88, v28, v29, v30
    v_max3_f32 v89, v31, v32, v33
    v_max3_f32 v88, v88, v34, v35
    v_cndmask_b32 v36, v38, v36, s[40:41]
    v_cndmask_b32 v37, v39, v37, s[40:41]
    v_max3_f32 v89, v89, v36, v37
    v_max_f32 v88, v88, v89
    v_max_f32 v89, v88, v89
    s_waitcnt lgkmcnt(2)
    v_smfmac_f32_16x16x64_bf16 v[40:43], v[48:51], a[112:119], v1
    v_permlane32_swap_b32 v88, v89
    v_smfmac_f32_16x16x64_bf16 v[44:47], v[48:51], a[120:127], v1
    v_max_f32 v90, v88, v89
    v_max_f32 v89, v88, v89
    s_waitcnt lgkmcnt(0)
    v_smfmac_f32_16x16x64_bf16 v[40:43], v[52:55], a[128:135], v1
    v_permlane16_swap_b32 v90, v89
    v_smfmac_f32_16x16x64_bf16 v[44:47], v[52:55], a[136:143], v1
    v_max_f32 v88, v90, v89
    v_mul_f32 v88, s38, v88
    ds_read_b128 v[84:87], v80 offset:9216
    ds_read_b128 v[80:83], v80 offset:8192
    v_pk_fma_f32 v[28:29], v[28:29], s[38:39], v[88:89] op_sel_hi:[1,1,0] neg_lo:[0,0,1] neg_hi:[0,0,1]
    v_pk_fma_f32 v[30:31], v[30:31], s[38:39], v[88:89] op_sel_hi:[1,1,0] neg_lo:[0,0,1] neg_hi:[0,0,1]
    v_pk_fma_f32 v[32:33], v[32:33], s[38:39], v[88:89] op_sel_hi:[1,1,0] neg_lo:[0,0,1] neg_hi:[0,0,1]
    v_pk_fma_f32 v[34:35], v[34:35], s[38:39], v[88:89] op_sel_hi:[1,1,0] neg_lo:[0,0,1] neg_hi:[0,0,1]
    v_pk_fma_f32 v[36:37], v[36:37], s[38:39], v[88:89] op_sel_hi:[1,1,0] neg_lo:[0,0,1] neg_hi:[0,0,1]
    v_exp_f32 v28, v28
    v_exp_f32 v29, v29
    v_exp_f32 v30, v30
    v_exp_f32 v31, v31
    v_exp_f32 v32, v32
    v_exp_f32 v33, v33
    v_exp_f32 v34, v34
    v_exp_f32 v35, v35
    v_cvt_pk_bf16_f32 v64, v28, v29
    v_cvt_pk_bf16_f32 v65, v30, v31
    v_cvt_pk_bf16_f32 v66, v32, v33
    v_cvt_pk_bf16_f32 v67, v34, v35
    s_waitcnt lgkmcnt(0)
    v_exp_f32 v36, v36
    v_mfma_f32_16x16x32_bf16 v[76:79], v[20:23], v[64:67], 0
    v_exp_f32 v37, v37
    v_mfma_f32_16x16x32_bf16 v[68:71], v[80:83], v[64:67], 0
    v_cvt_pk_bf16_f32 v24, v36, v37
    v_cvt_pk_bf16_f32 v27, v36, v37
    v_mfma_f32_16x16x32_bf16 v[72:75], v[84:87], v[64:67], 0
    v_pk_add_f32 v[40:41], v[40:41], v[42:43]
    v_pk_add_f32 v[44:45], v[44:45], v[46:47]
    v_mfma_f32_16x16x16_bf16 v[76:79], v[20:21], v[24:25], v[76:79]
    v_mov_b64 v[48:49], 0
    v_mov_b64 v[50:51], 0
    v_mov_b64 v[52:53], 0
    v_mov_b64 v[54:55], 0
    s_waitcnt vmcnt(0)
    v_cmp_eq_u32 vcc, -1, v92
    s_cbranch_vccnz adaLN_cond__memory_aug_recurrent_mem_tr__glu_gated_swiglu__prompt_kernel_fast_fixv
adaLN_cond__memory_aug_recurrent_mem_tr__glu_gated_swiglu__prompt_kernel_fast_pv2:
    v_pk_add_f32 v[92:93], v[92:93], v[40:41]
    v_pk_add_f32 v[94:95], v[94:95], v[44:45]
    v_cvt_pk_bf16_f32 v42, v92, v93
    v_cvt_pk_bf16_f32 v43, v94, v95
    v_rcp_f32 v88, v76
    v_mov_b64 v[56:57], 0
    v_mfma_f32_16x16x16_bf16 v[68:71], v[42:43], v[24:25], v[68:71]
    v_mfma_f32_16x16x16_bf16 v[72:75], v[42:43], v[26:27], v[72:75]
    v_mov_b64 v[58:59], 0
    v_mov_b64 v[60:61], 0
    v_mov_b64 v[62:63], 0
    ds_read_b128 v[80:83], v4 offset:20480
    ds_read_b128 v[84:87], v4 offset:21504
    ds_read_b128 v[40:43], v4 offset:22528
    ds_read_b128 v[44:47], v4 offset:23552
    v_pk_mul_f32 v[68:69], v[68:69], v[88:89] op_sel_hi:[1,0]
    v_pk_mul_f32 v[70:71], v[70:71], v[88:89] op_sel_hi:[1,0]
    v_pk_mul_f32 v[72:73], v[72:73], v[88:89] op_sel_hi:[1,0]
    v_pk_mul_f32 v[74:75], v[74:75], v[88:89] op_sel_hi:[1,0]
    v_cvt_pk_bf16_f32 v64, v68, v69
    v_cvt_pk_bf16_f32 v65, v70, v71
    v_cvt_pk_bf16_f32 v66, v72, v73
    v_cvt_pk_bf16_f32 v67, v74, v75
    ds_write_b128 v6, v[64:67]
    s_add_u32 m0, s59, 8192
    s_nop 0
    buffer_load_dwordx4 v0, s[4:7], s70 offen nt lds
    buffer_load_dwordx4 v0, s[4:7], s70 offen offset:1024 nt lds
    s_add_u32 s70, s70, 262144
    v_cmp_le_u32 vcc, 32, v11
    s_waitcnt lgkmcnt(0)
    s_barrier
    ds_read_b128 v[28:31], v7
    ds_read_b128 v[32:35], v7 offset:1024
    s_mov_b32 m0, s59
    s_add_u32 s31, s58, 2048
    buffer_load_dwordx4 v9, s[4:7], s58 offen nt lds
    s_add_u32 m0, s59, 1024
    s_add_u32 s58, s58, 262144
    buffer_load_dwordx4 v9, s[4:7], s31 offen nt lds
    s_waitcnt lgkmcnt(1)
    v_smfmac_f32_16x16x64_bf16 v[48:51], v[28:31], a[144:151], v1
    s_add_u32 s72, s72, 262144
    s_add_u32 s48, s48, 16384
    v_smfmac_f32_16x16x64_bf16 v[52:55], v[28:31], a[152:159], v1
    s_and_b32 s48, s48, 49152
    s_add_u32 s57, s55, s48
    s_waitcnt lgkmcnt(0)
    v_smfmac_f32_16x16x64_bf16 v[48:51], v[32:35], v[80:87], v1
    ds_read_b128 v[80:83], v4 offset:24576
    ds_read_b128 v[84:87], v4 offset:25600
    s_lshl_b32 s31, s48, 1
    s_add_u32 s75, s73, s31
    v_smfmac_f32_16x16x64_bf16 v[52:55], v[32:35], v[40:47], v1
    ds_read_b128 v[72:75], v4 offset:26624
    ds_read_b128 v[76:79], v4 offset:27648
    v_smfmac_f32_16x16x64_bf16 v[56:59], v[28:31], a[160:167], v1
    v_smfmac_f32_16x16x64_bf16 v[60:63], v[28:31], a[168:175], v1
    v_pk_add_f32 v[48:49], v[48:49], v[50:51]
    v_cvt_pk_bf16_f32 v88, v48, v49
    s_nop 1
    v_pk_add_f32 v[52:53], v[52:53], v[54:55]
    v_cvt_pk_bf16_f32 v89, v52, v53
    v_smfmac_f32_16x16x64_bf16 v[56:59], v[32:35], a[176:183], v1
    v_mov_b64 v[48:49], 0
    v_mov_b64 v[50:51], 0
    v_permlane16_swap_b32 v88, v89
    buffer_store_dwordx2 v[88:89], v8, s[4:7], s50 offen
    v_smfmac_f32_16x16x64_bf16 v[60:63], v[32:35], a[184:191], v1
    v_mov_b64 v[52:53], 0
    v_mov_b64 v[54:55], 0
    s_waitcnt lgkmcnt(2)
    v_smfmac_f32_16x16x64_bf16 v[48:51], v[28:31], v[80:87], v1
    ds_read_b128 v[80:83], v4 offset:28672
    ds_read_b128 v[84:87], v4 offset:29696
    s_waitcnt lgkmcnt(2)
    v_smfmac_f32_16x16x64_bf16 v[52:55], v[28:31], v[72:79], v1
    ds_read_b128 v[72:75], v4 offset:30720
    ds_read_b128 v[76:79], v4 offset:31744
    v_pk_add_f32 v[56:57], v[56:57], v[58:59]
    v_cvt_pk_bf16_f32 v90, v56, v57
    v_pk_add_f32 v[60:61], v[60:61], v[62:63]
    v_cvt_pk_bf16_f32 v91, v60, v61
    v_smfmac_f32_16x16x64_bf16 v[48:51], v[32:35], a[192:199], v1
    v_mov_b64 v[56:57], 0
    v_mov_b64 v[58:59], 0
    v_permlane16_swap_b32 v90, v91
    buffer_store_dwordx2 v[90:91], v8, s[4:7], s51 offen
    v_smfmac_f32_16x16x64_bf16 v[52:55], v[32:35], a[200:207], v1
    v_mov_b64 v[60:61], 0
    v_mov_b64 v[62:63], 0
    v_smfmac_f32_16x16x64_bf16 v[56:59], v[28:31], a[208:215], v1
    s_nop 0
    v_smfmac_f32_16x16x64_bf16 v[60:63], v[28:31], a[216:223], v1
    v_pk_add_f32 v[48:49], v[48:49], v[50:51]
    v_cvt_pk_bf16_f32 v92, v48, v49
    s_nop 0
    v_pk_add_f32 v[52:53], v[52:53], v[54:55]
    v_cvt_pk_bf16_f32 v93, v52, v53
    s_waitcnt lgkmcnt(2)
    v_smfmac_f32_16x16x64_bf16 v[56:59], v[32:35], v[80:87], v1
    v_mov_b64 v[48:49], 0
    v_mov_b64 v[50:51], 0
    v_permlane16_swap_b32 v92, v93
    buffer_store_dwordx2 v[92:93], v8, s[4:7], s52 offen
    s_waitcnt lgkmcnt(0)
    v_smfmac_f32_16x16x64_bf16 v[60:63], v[32:35], v[72:79], v1
    v_mov_b64 v[52:53], 0
    v_mov_b64 v[54:55], 0
    v_smfmac_f32_16x16x64_bf16 v[48:51], v[28:31], a[224:231], v1
    v_smfmac_f32_16x16x64_bf16 v[48:51], v[32:35], a[240:247], v1
    v_pk_add_f32 v[56:57], v[56:57], v[58:59]
    v_cvt_pk_bf16_f32 v88, v56, v57
    s_nop 1
    v_pk_add_f32 v[60:61], v[60:61], v[62:63]
    v_smfmac_f32_16x16x64_bf16 v[52:55], v[28:31], a[232:239], v1
    v_cvt_pk_bf16_f32 v89, v60, v61
    s_nop 1
    v_permlane16_swap_b32 v88, v89
    v_smfmac_f32_16x16x64_bf16 v[52:55], v[32:35], a[248:255], v1
    buffer_store_dwordx2 v[88:89], v8, s[4:7], s53 offen
    v_pk_add_f32 v[48:49], v[48:49], v[50:51]
    v_cvt_pk_bf16_f32 v90, v48, v49
    s_nop 4
    v_pk_add_f32 v[52:53], v[52:53], v[54:55]
    v_cvt_pk_bf16_f32 v91, v52, v53
    s_nop 1
    v_permlane16_swap_b32 v90, v91
    buffer_store_dwordx2 v[90:91], v8, s[4:7], s54 offen
    s_add_u32 s47, s74, s31
    s_xor_b32 s31, s31, 65536
    s_add_u32 s65, s68, s31
    s_add_u32 s31, s48, 65536
    s_add_u32 s44, s31, s64
    s_lshl_b32 s31, s48, 4
    s_add_u32 s67, s66, s31
    s_add_u32 s30, s30, 1
    s_and_b32 s31, vcc_lo, 0xffff
    s_ff0_i32_b32 s31, s31
    s_add_u32 s31, s31, s13
    s_max_u32 s16, s16, s31
    s_mov_b32 s13, s16
    s_lshl_b32 s12, s16, 7
    s_add_u32 s12, s12, 303104
    s_add_u32 s31, s30, 5
    s_min_u32 s31, s31, 64
    s_cmp_lt_u32 s16, s31
    s_cselect_b32 s12, s12, 0x40000000
    ds_read_b128 v[88:91], v4 offset:8192
    ds_read_b128 v[92:95], v4 offset:9216
    ds_read_b128 v[80:83], v4 offset:10240
    ds_read_b128 v[84:87], v4 offset:11264
    ds_read_b128 v[72:75], v4 offset:12288
    ds_read_b128 v[76:79], v4 offset:13312
    ds_read_b128 v[64:67], v4 offset:14336
    ds_read_b128 v[68:71], v4 offset:15360
    s_xor_b32 s50, s50, 524288
    s_xor_b32 s51, s51, 524288
    s_xor_b32 s52, s52, 524288
    s_xor_b32 s53, s53, 524288
    s_xor_b32 s54, s54, 524288
    s_cmp_ge_u32 s36, 80
    s_cbranch_scc1 adaLN_cond__memory_aug_recurrent_mem_tr__glu_gated_swiglu__prompt_kernel_fast_nored
adaLN_cond__memory_aug_recurrent_mem_tr__glu_gated_swiglu__prompt_kernel_fast_pollK:
    buffer_load_dwordx4 v[28:31], v0, s[4:7], s60 offen offset:0 sc1
    buffer_load_dwordx4 v[32:35], v0, s[4:7], s60 offen offset:1024 sc1
    buffer_load_dwordx4 v[36:39], v0, s[4:7], s60 offen offset:2048 sc1
    buffer_load_dwordx4 v[40:43], v0, s[4:7], s60 offen offset:3072 sc1
adaLN_cond__memory_aug_recurrent_mem_tr__glu_gated_swiglu__prompt_kernel_fast_pk1:
    s_waitcnt vmcnt(3)
    v_mfma_f32_16x16x32_bf16 v[44:47], v[16:19], v[28:31], 0
    s_waitcnt vmcnt(2)
    v_mfma_f32_16x16x32_bf16 v[44:47], v[16:19], v[32:35], v[44:47]
    s_waitcnt vmcnt(1)
    v_mfma_f32_16x16x32_bf16 v[44:47], v[16:19], v[36:39], v[44:47]
    v_max3_u32 v48, v28, v32, v36
    s_waitcnt vmcnt(0)
    v_mfma_f32_16x16x32_bf16 v[44:47], v[16:19], v[40:43], v[44:47]
    v_max_u32 v48, v48, v40
    s_nop 1
    v_mov_b32_dpp v49, v48 quad_perm:[0,0,0,0] row_mask:0xf bank_mask:0xf
    v_cmp_eq_u32 vcc, -1, v49
    s_nop 0
    s_mov_b64 exec, vcc
    s_cbranch_execnz adaLN_cond__memory_aug_recurrent_mem_tr__glu_gated_swiglu__prompt_kernel_fast_pollK
    s_mov_b64 exec, -1
    v_permlane32_swap_b32 v44, v46
    v_permlane32_swap_b32 v45, v47
    s_nop 0
    v_add_f32_dpp v44, v46, v44 row_ror:8 row_mask:0xf bank_mask:0xf
    v_add_f32_dpp v45, v47, v45 row_ror:8 row_mask:0xf bank_mask:0xf
    v_cvt_pk_bf16_f32 v11, v44, v45
    buffer_store_dword v11, v10, s[4:7], s57 offen
    buffer_store_dword v11, v10, s[4:7], s75 offen sc1
    buffer_store_dword v14, v10, s[4:7], s56 offen
    buffer_store_dword v14, v15, s[4:7], s60 offen
    s_xor_b32 s60, s60, 524288
    s_mov_b32 s56, s57
    s_branch adaLN_cond__memory_aug_recurrent_mem_tr__glu_gated_swiglu__prompt_kernel_fast_end
adaLN_cond__memory_aug_recurrent_mem_tr__glu_gated_swiglu__prompt_kernel_fast_nored:
adaLN_cond__memory_aug_recurrent_mem_tr__glu_gated_swiglu__prompt_kernel_fast_end:
    s_waitcnt lgkmcnt(0)
    s_cmp_lg_u32 s30, 63
    s_cbranch_scc1 adaLN_cond__memory_aug_recurrent_mem_tr__glu_gated_swiglu__prompt_kernel_fast
    s_branch adaLN_cond__memory_aug_recurrent_mem_tr__glu_gated_swiglu__prompt_kernel_fin
adaLN_cond__memory_aug_recurrent_mem_tr__glu_gated_swiglu__prompt_kernel_fast_fixv:
    buffer_load_dwordx4 v[92:95], v0, s[4:7], s67 offen sc1
    s_waitcnt vmcnt(0)
    v_cmp_eq_u32 vcc, -1, v92
    s_cbranch_vccnz adaLN_cond__memory_aug_recurrent_mem_tr__glu_gated_swiglu__prompt_kernel_fast_fixv
    s_branch adaLN_cond__memory_aug_recurrent_mem_tr__glu_gated_swiglu__prompt_kernel_fast_pv2
adaLN_cond__memory_aug_recurrent_mem_tr__glu_gated_swiglu__prompt_kernel_slow:
    v_add_u32 v51, s64, v0
    s_barrier
    s_sleep 3
adaLN_cond__memory_aug_recurrent_mem_tr__glu_gated_swiglu__prompt_kernel_slow_pollA:
    buffer_load_dwordx4 v[28:31], v0, s[4:7], s44 offen offset:0 sc1
    buffer_load_dwordx4 v[32:35], v0, s[4:7], s44 offen offset:1024 sc1
    buffer_load_dwordx4 v[36:39], v0, s[4:7], s44 offen offset:1536 sc1
    s_waitcnt vmcnt(2)
    ds_write_b128 v51, v[28:31] offset:0
    s_waitcnt vmcnt(1)
    ds_write_b128 v51, v[32:35] offset:1024
    s_waitcnt vmcnt(0)
    ds_write_b128 v51, v[36:39] offset:1536
    v_max3_u32 v50, v28, v32, v36
    v_cmp_eq_u32 vcc, -1, v50
    s_nop 0
    s_mov_b64 exec, vcc
    s_cbranch_execnz adaLN_cond__memory_aug_recurrent_mem_tr__glu_gated_swiglu__prompt_kernel_slow_pollA
    s_mov_b64 exec, -1
    s_waitcnt lgkmcnt(0)
adaLN_cond__memory_aug_recurrent_mem_tr__glu_gated_swiglu__prompt_kernel_slow_gd:
    s_barrier
    ds_read_b64_tr_b16 v[44:45], v2 offset:0
    ds_read_b64_tr_b16 v[46:47], v2 offset:512
    ds_read_b64_tr_b16 v[48:49], v2 offset:1024
    ds_read_b64_tr_b16 v[50:51], v2 offset:1536
    v_mov_b64 v[28:29], 0
    v_mov_b64 v[30:31], 0
    v_mov_b64 v[32:33], 0
    v_mov_b64 v[34:35], 0
    v_mov_b64 v[36:37], 0
    v_mov_b64 v[38:39], 0
    v_mov_b64 v[40:41], 0
    v_mov_b64 v[42:43], 0
    s_waitcnt lgkmcnt(2)
    v_smfmac_f32_16x16x64_bf16 v[28:31], v[44:47], v[88:95], v1
    ds_read_b64_tr_b16 v[52:53], v2 offset:2048
    ds_read_b64_tr_b16 v[54:55], v2 offset:2560
    v_smfmac_f32_16x16x64_bf16 v[32:35], v[44:47], v[80:87], v1
    s_add_u32 s33, s30, 2
    s_cmp_ge_u32 s16, s33
    s_cbranch_scc1 adaLN_cond__memory_aug_recurrent_mem_tr__glu_gated_swiglu__prompt_kernel_slow_kv_ok
adaLN_cond__memory_aug_recurrent_mem_tr__glu_gated_swiglu__prompt_kernel_slow_kv_spin:
    s_lshl_b32 s34, s16, 7
    s_add_u32 s34, s34, 303104
    buffer_load_dword v13, v12, s[4:7], s34 offen sc1
    s_waitcnt vmcnt(0)
    v_cmp_le_u32 vcc, 32, v13
    s_nop 0
    s_and_b32 s34, vcc_lo, 0xffff
    s_ff0_i32_b32 s34, s34
    s_add_u32 s16, s16, s34
    s_cmp_ge_u32 s16, s33
    s_cbranch_scc0 adaLN_cond__memory_aug_recurrent_mem_tr__glu_gated_swiglu__prompt_kernel_slow_kv_spin
adaLN_cond__memory_aug_recurrent_mem_tr__glu_gated_swiglu__prompt_kernel_slow_kv_ok:
    v_smfmac_f32_16x16x64_bf16 v[36:39], v[44:47], v[72:79], v1
    buffer_load_dword v13, v12, s[4:7], s72 offen
    buffer_store_dword v11, v10, s[4:7], s47 offen sc1
    v_smfmac_f32_16x16x64_bf16 v[40:43], v[44:47], v[64:71], v1
    buffer_store_dword v14, v10, s[4:7], s65 offen sc1
    buffer_load_dword v11, v12, s[4:7], s12 offen sc1
    s_waitcnt lgkmcnt(2)
    v_smfmac_f32_16x16x64_bf16 v[28:31], v[48:51], v[96:103], v1
    ds_read_b128 v[88:91], v4 offset:16384
    ds_read_b128 v[92:95], v4 offset:17408
    ds_read_b64_tr_b16 v[44:45], v2 offset:3072
    ds_read_b64_tr_b16 v[46:47], v2 offset:3584
    v_smfmac_f32_16x16x64_bf16 v[32:35], v[48:51], v[104:111], v1
    ds_read_b128 v[80:83], v4 offset:18432
    ds_read_b128 v[84:87], v4 offset:19456
    v_smfmac_f32_16x16x64_bf16 v[36:39], v[48:51], v[112:119], v1
    v_smfmac_f32_16x16x64_bf16 v[40:43], v[48:51], v[120:127], v1
    s_waitcnt lgkmcnt(6)
    v_smfmac_f32_16x16x64_bf16 v[28:31], v[52:55], v[128:135], v1
    ds_read_b64_tr_b16 v[48:49], v2 offset:4096
    ds_read_b64_tr_b16 v[50:51], v2 offset:4608
    v_smfmac_f32_16x16x64_bf16 v[32:35], v[52:55], v[136:143], v1
    s_waitcnt lgkmcnt(6)
    v_smfmac_f32_16x16x64_bf16 v[36:39], v[52:55], v[88:95], v1
    s_waitcnt lgkmcnt(2)
    v_smfmac_f32_16x16x64_bf16 v[40:43], v[52:55], v[80:87], v1
    v_smfmac_f32_16x16x64_bf16 v[28:31], v[44:47], v[144:151], v1
    ds_read_b64_tr_b16 v[52:53], v2 offset:5120
    ds_read_b64_tr_b16 v[54:55], v2 offset:5632
    v_smfmac_f32_16x16x64_bf16 v[32:35], v[44:47], v[152:159], v1
    v_smfmac_f32_16x16x64_bf16 v[36:39], v[44:47], v[160:167], v1
    v_smfmac_f32_16x16x64_bf16 v[40:43], v[44:47], v[168:175], v1
    s_waitcnt lgkmcnt(2)
    v_smfmac_f32_16x16x64_bf16 v[28:31], v[48:51], v[176:183], v1
    ds_read_b64_tr_b16 v[44:45], v2 offset:6144
    ds_read_b64_tr_b16 v[46:47], v2 offset:6656
    v_smfmac_f32_16x16x64_bf16 v[32:35], v[48:51], v[184:191], v1
    v_smfmac_f32_16x16x64_bf16 v[36:39], v[48:51], v[192:199], v1
    ds_read_b64_tr_b16 v[56:57], v2 offset:7168
    ds_read_b64_tr_b16 v[58:59], v2 offset:7680
    v_smfmac_f32_16x16x64_bf16 v[40:43], v[48:51], v[200:207], v1
    s_waitcnt lgkmcnt(4)
    v_smfmac_f32_16x16x64_bf16 v[28:31], v[52:55], v[208:215], v1
    ds_read_b64_tr_b16 v[48:49], v2 offset:8192
    ds_read_b64_tr_b16 v[50:51], v2 offset:8704
    s_add_u32 s31, s72, 16777216
    buffer_load_dword v13, v12, s[4:7], s31 offen
    v_smfmac_f32_16x16x64_bf16 v[32:35], v[52:55], v[216:223], v1
    v_smfmac_f32_16x16x64_bf16 v[36:39], v[52:55], v[224:231], v1
    ds_read_b64_tr_b16 v[60:61], v2 offset:9216
    ds_read_b64_tr_b16 v[62:63], v2 offset:9728
    v_smfmac_f32_16x16x64_bf16 v[40:43], v[52:55], v[232:239], v1
    s_waitcnt lgkmcnt(6)
    v_smfmac_f32_16x16x64_bf16 v[28:31], v[44:47], v[240:247], v1
    v_smfmac_f32_16x16x64_bf16 v[32:35], v[44:47], v[248:255], v1
    s_waitcnt lgkmcnt(4)
    v_smfmac_f32_16x16x64_bf16 v[28:31], v[56:59], a[0:7], v1
    v_smfmac_f32_16x16x64_bf16 v[32:35], v[56:59], a[8:15], v1
    s_waitcnt lgkmcnt(2)
    v_smfmac_f32_16x16x64_bf16 v[28:31], v[48:51], a[16:23], v1
    v_smfmac_f32_16x16x64_bf16 v[32:35], v[48:51], a[24:31], v1
    s_waitcnt lgkmcnt(0)
    v_smfmac_f32_16x16x64_bf16 v[28:31], v[60:63], a[32:39], v1
    v_smfmac_f32_16x16x64_bf16 v[32:35], v[60:63], a[40:47], v1
    v_smfmac_f32_16x16x64_bf16 v[36:39], v[44:47], a[48:55], v1
    ds_read_b128 v[52:55], v0 offset:16384
    ds_read_b128 v[64:67], v0 offset:20480
    v_smfmac_f32_16x16x64_bf16 v[40:43], v[44:47], a[56:63], v1
    s_nop 2
    v_pk_add_f32 v[28:29], v[28:29], v[30:31]
    v_cvt_pk_bf16_f32 v88, v28, v29
    v_pk_add_f32 v[32:33], v[32:33], v[34:35]
    v_smfmac_f32_16x16x64_bf16 v[36:39], v[56:59], a[64:71], v1
    v_cvt_pk_bf16_f32 v89, v32, v33
    ds_write2st64_b32 v5, v88, v89 offset0:0 offset1:1
    v_smfmac_f32_16x16x64_bf16 v[40:43], v[56:59], a[72:79], v1
    ds_read_b128 v[44:47], v0 offset:17408
    v_smfmac_f32_16x16x64_bf16 v[36:39], v[48:51], a[80:87], v1
    ds_read_b128 v[56:59], v0 offset:21504
    v_smfmac_f32_16x16x64_bf16 v[40:43], v[48:51], a[88:95], v1
    ds_read_b128 v[48:51], v0 offset:18432
    s_waitcnt lgkmcnt(3)
    s_barrier
    ds_read_b64_tr_b16 v[68:69], v3 offset:0
    ds_read_b64_tr_b16 v[70:71], v3 offset:256
    v_smfmac_f32_16x16x64_bf16 v[36:39], v[60:63], a[96:103], v1
    ds_read_b64_tr_b16 v[72:73], v3 offset:512
    ds_read_b64_tr_b16 v[74:75], v3 offset:768
    ds_read_b64_tr_b16 v[76:77], v3 offset:1024
    ds_read_b64_tr_b16 v[78:79], v3 offset:1280
    v_smfmac_f32_16x16x64_bf16 v[40:43], v[60:63], a[104:111], v1
    ds_read_b128 v[60:63], v0 offset:22528
    ds_read_b64_tr_b16 v[80:81], v3 offset:1536
    ds_read_b64_tr_b16 v[82:83], v3 offset:1792
    ds_read_b128 v[84:87], v0 offset:19456
    v_pk_add_f32 v[36:37], v[36:37], v[38:39]
    v_cvt_pk_bf16_f32 v90, v36, v37
    s_nop 1
    v_pk_add_f32 v[40:41], v[40:41], v[42:43]
    v_cvt_pk_bf16_f32 v91, v40, v41
    ds_write2st64_b32 v5, v90, v91 offset0:8 offset1:9
    s_waitcnt lgkmcnt(9)
    v_mfma_f32_16x16x32_bf16 v[28:31], v[52:55], v[68:71], 0
    ds_read_b128 v[52:55], v0 offset:23552
    v_mfma_f32_16x16x32_bf16 v[32:35], v[64:67], v[68:71], 0
    s_waitcnt lgkmcnt(8)
    v_mfma_f32_16x16x32_bf16 v[28:31], v[44:47], v[72:75], v[28:31]
    v_mfma_f32_16x16x32_bf16 v[32:35], v[56:59], v[72:75], v[32:35]
    s_waitcnt lgkmcnt(1)
    s_barrier
    ds_read_b64_tr_b16 v[40:41], v3 offset:2048
    ds_read_b64_tr_b16 v[42:43], v3 offset:2304
    ds_read_b64_tr_b16 v[44:45], v3 offset:2560
    ds_read_b64_tr_b16 v[46:47], v3 offset:2816
    ds_read_b64_tr_b16 v[56:57], v3 offset:3072
    ds_read_b64_tr_b16 v[58:59], v3 offset:3328
    ds_read_b64_tr_b16 v[64:65], v3 offset:3584
    ds_read_b64_tr_b16 v[66:67], v3 offset:3840
    v_mfma_f32_16x16x32_bf16 v[28:31], v[48:51], v[76:79], v[28:31]
    v_mfma_f32_16x16x32_bf16 v[32:35], v[60:63], v[76:79], v[32:35]
    v_mfma_f32_16x16x32_bf16 v[28:31], v[84:87], v[80:83], v[28:31]
    s_waitcnt lgkmcnt(8)
    v_mfma_f32_16x16x32_bf16 v[32:35], v[52:55], v[80:83], v[32:35]
    buffer_load_dwordx4 v[92:95], v0, s[4:7], s67 offen sc1
    s_waitcnt lgkmcnt(6)
    v_mfma_f32_16x16x32_bf16 v[36:39], v[40:43], v[68:71], 0
    s_waitcnt lgkmcnt(4)
    v_mfma_f32_16x16x32_bf16 v[36:39], v[44:47], v[72:75], v[36:39]
    s_waitcnt lgkmcnt(2)
    v_mfma_f32_16x16x32_bf16 v[36:39], v[56:59], v[76:79], v[36:39]
    s_waitcnt lgkmcnt(0)
    v_mfma_f32_16x16x32_bf16 v[36:39], v[64:67], v[80:83], v[36:39]
    ds_read_b64_tr_b16 v[48:49], v2 offset:8192
    ds_read_b64_tr_b16 v[50:51], v2 offset:8704
    ds_read_b64_tr_b16 v[52:53], v2 offset:9216
    ds_read_b64_tr_b16 v[54:55], v2 offset:9728
    v_mov_b64 v[40:41], 0
    v_mov_b64 v[42:43], 0
    v_mov_b64 v[44:45], 0
    v_mov_b64 v[46:47], 0
    v_add_u32 v80, s59, v0
    v_max3_f32 v88, v28, v29, v30
    v_max3_f32 v89, v31, v32, v33
    v_max3_f32 v88, v88, v34, v35
    v_cndmask_b32 v36, v38, v36, s[40:41]
    v_cndmask_b32 v37, v39, v37, s[40:41]
    v_max3_f32 v89, v89, v36, v37
    v_max_f32 v88, v88, v89
    v_max_f32 v89, v88, v89
    s_waitcnt lgkmcnt(2)
    v_smfmac_f32_16x16x64_bf16 v[40:43], v[48:51], a[112:119], v1
    v_permlane32_swap_b32 v88, v89
    v_smfmac_f32_16x16x64_bf16 v[44:47], v[48:51], a[120:127], v1
    v_max_f32 v90, v88, v89
    v_max_f32 v89, v88, v89
    s_waitcnt lgkmcnt(0)
    v_smfmac_f32_16x16x64_bf16 v[40:43], v[52:55], a[128:135], v1
    v_permlane16_swap_b32 v90, v89
    v_smfmac_f32_16x16x64_bf16 v[44:47], v[52:55], a[136:143], v1
    v_max_f32 v88, v90, v89
    v_mul_f32 v88, s38, v88
    ds_read_b128 v[84:87], v80 offset:9216
    ds_read_b128 v[80:83], v80 offset:8192
    v_pk_fma_f32 v[28:29], v[28:29], s[38:39], v[88:89] op_sel_hi:[1,1,0] neg_lo:[0,0,1] neg_hi:[0,0,1]
    v_pk_fma_f32 v[30:31], v[30:31], s[38:39], v[88:89] op_sel_hi:[1,1,0] neg_lo:[0,0,1] neg_hi:[0,0,1]
    v_pk_fma_f32 v[32:33], v[32:33], s[38:39], v[88:89] op_sel_hi:[1,1,0] neg_lo:[0,0,1] neg_hi:[0,0,1]
    v_pk_fma_f32 v[34:35], v[34:35], s[38:39], v[88:89] op_sel_hi:[1,1,0] neg_lo:[0,0,1] neg_hi:[0,0,1]
    v_pk_fma_f32 v[36:37], v[36:37], s[38:39], v[88:89] op_sel_hi:[1,1,0] neg_lo:[0,0,1] neg_hi:[0,0,1]
    v_exp_f32 v28, v28
    v_exp_f32 v29, v29
    v_exp_f32 v30, v30
    v_exp_f32 v31, v31
    v_exp_f32 v32, v32
    v_exp_f32 v33, v33
    v_exp_f32 v34, v34
    v_exp_f32 v35, v35
    v_cvt_pk_bf16_f32 v64, v28, v29
    v_cvt_pk_bf16_f32 v65, v30, v31
    v_cvt_pk_bf16_f32 v66, v32, v33
    v_cvt_pk_bf16_f32 v67, v34, v35
    s_waitcnt lgkmcnt(0)
    v_exp_f32 v36, v36
    v_mfma_f32_16x16x32_bf16 v[76:79], v[20:23], v[64:67], 0
    v_exp_f32 v37, v37
    v_mfma_f32_16x16x32_bf16 v[68:71], v[80:83], v[64:67], 0
    v_cvt_pk_bf16_f32 v24, v36, v37
    v_cvt_pk_bf16_f32 v27, v36, v37
    v_mfma_f32_16x16x32_bf16 v[72:75], v[84:87], v[64:67], 0
    v_pk_add_f32 v[40:41], v[40:41], v[42:43]
    v_pk_add_f32 v[44:45], v[44:45], v[46:47]
    v_mfma_f32_16x16x16_bf16 v[76:79], v[20:21], v[24:25], v[76:79]
    v_mov_b64 v[48:49], 0
    v_mov_b64 v[50:51], 0
    v_mov_b64 v[52:53], 0
    v_mov_b64 v[54:55], 0
    s_waitcnt vmcnt(0)
    v_cmp_eq_u32 vcc, -1, v92
    s_cbranch_vccnz adaLN_cond__memory_aug_recurrent_mem_tr__glu_gated_swiglu__prompt_kernel_slow_fixv
adaLN_cond__memory_aug_recurrent_mem_tr__glu_gated_swiglu__prompt_kernel_slow_pv2:
    v_pk_add_f32 v[92:93], v[92:93], v[40:41]
    v_pk_add_f32 v[94:95], v[94:95], v[44:45]
    v_cvt_pk_bf16_f32 v42, v92, v93
    v_cvt_pk_bf16_f32 v43, v94, v95
    v_rcp_f32 v88, v76
    v_mov_b64 v[56:57], 0
    v_mfma_f32_16x16x16_bf16 v[68:71], v[42:43], v[24:25], v[68:71]
    v_mfma_f32_16x16x16_bf16 v[72:75], v[42:43], v[26:27], v[72:75]
    v_mov_b64 v[58:59], 0
    v_mov_b64 v[60:61], 0
    v_mov_b64 v[62:63], 0
    ds_read_b128 v[80:83], v4 offset:20480
    ds_read_b128 v[84:87], v4 offset:21504
    ds_read_b128 v[40:43], v4 offset:22528
    ds_read_b128 v[44:47], v4 offset:23552
    v_pk_mul_f32 v[68:69], v[68:69], v[88:89] op_sel_hi:[1,0]
    v_pk_mul_f32 v[70:71], v[70:71], v[88:89] op_sel_hi:[1,0]
    v_pk_mul_f32 v[72:73], v[72:73], v[88:89] op_sel_hi:[1,0]
    v_pk_mul_f32 v[74:75], v[74:75], v[88:89] op_sel_hi:[1,0]
    v_cvt_pk_bf16_f32 v64, v68, v69
    v_cvt_pk_bf16_f32 v65, v70, v71
    v_cvt_pk_bf16_f32 v66, v72, v73
    v_cvt_pk_bf16_f32 v67, v74, v75
    ds_write_b128 v6, v[64:67]
    s_add_u32 m0, s59, 8192
    s_nop 0
    buffer_load_dwordx4 v0, s[4:7], s70 offen nt lds
    buffer_load_dwordx4 v0, s[4:7], s70 offen offset:1024 nt lds
    s_add_u32 s70, s70, 262144
    v_cmp_le_u32 vcc, 32, v11
    s_waitcnt lgkmcnt(0)
    s_barrier
    ds_read_b128 v[28:31], v7
    ds_read_b128 v[32:35], v7 offset:1024
    s_mov_b32 m0, s59
    s_add_u32 s31, s58, 2048
    buffer_load_dwordx4 v9, s[4:7], s58 offen nt lds
    s_add_u32 m0, s59, 1024
    s_add_u32 s58, s58, 262144
    buffer_load_dwordx4 v9, s[4:7], s31 offen nt lds
    s_waitcnt lgkmcnt(1)
    v_smfmac_f32_16x16x64_bf16 v[48:51], v[28:31], a[144:151], v1
    s_add_u32 s72, s72, 262144
    s_add_u32 s48, s48, 16384
    v_smfmac_f32_16x16x64_bf16 v[52:55], v[28:31], a[152:159], v1
    s_and_b32 s48, s48, 49152
    s_add_u32 s57, s55, s48
    s_waitcnt lgkmcnt(0)
    v_smfmac_f32_16x16x64_bf16 v[48:51], v[32:35], v[80:87], v1
    ds_read_b128 v[80:83], v4 offset:24576
    ds_read_b128 v[84:87], v4 offset:25600
    s_lshl_b32 s31, s48, 1
    s_add_u32 s75, s73, s31
    v_smfmac_f32_16x16x64_bf16 v[52:55], v[32:35], v[40:47], v1
    ds_read_b128 v[72:75], v4 offset:26624
    ds_read_b128 v[76:79], v4 offset:27648
    v_smfmac_f32_16x16x64_bf16 v[56:59], v[28:31], a[160:167], v1
    v_smfmac_f32_16x16x64_bf16 v[60:63], v[28:31], a[168:175], v1
    v_pk_add_f32 v[48:49], v[48:49], v[50:51]
    v_cvt_pk_bf16_f32 v88, v48, v49
    s_nop 1
    v_pk_add_f32 v[52:53], v[52:53], v[54:55]
    v_cvt_pk_bf16_f32 v89, v52, v53
    v_smfmac_f32_16x16x64_bf16 v[56:59], v[32:35], a[176:183], v1
    v_mov_b64 v[48:49], 0
    v_mov_b64 v[50:51], 0
    v_permlane16_swap_b32 v88, v89
    buffer_store_dwordx2 v[88:89], v8, s[4:7], s50 offen sc1
    v_smfmac_f32_16x16x64_bf16 v[60:63], v[32:35], a[184:191], v1
    v_mov_b64 v[52:53], 0
    v_mov_b64 v[54:55], 0
    s_waitcnt lgkmcnt(2)
    v_smfmac_f32_16x16x64_bf16 v[48:51], v[28:31], v[80:87], v1
    ds_read_b128 v[80:83], v4 offset:28672
    ds_read_b128 v[84:87], v4 offset:29696
    s_waitcnt lgkmcnt(2)
    v_smfmac_f32_16x16x64_bf16 v[52:55], v[28:31], v[72:79], v1
    ds_read_b128 v[72:75], v4 offset:30720
    ds_read_b128 v[76:79], v4 offset:31744
    v_pk_add_f32 v[56:57], v[56:57], v[58:59]
    v_cvt_pk_bf16_f32 v90, v56, v57
    v_pk_add_f32 v[60:61], v[60:61], v[62:63]
    v_cvt_pk_bf16_f32 v91, v60, v61
    v_smfmac_f32_16x16x64_bf16 v[48:51], v[32:35], a[192:199], v1
    v_mov_b64 v[56:57], 0
    v_mov_b64 v[58:59], 0
    v_permlane16_swap_b32 v90, v91
    buffer_store_dwordx2 v[90:91], v8, s[4:7], s51 offen sc1
    v_smfmac_f32_16x16x64_bf16 v[52:55], v[32:35], a[200:207], v1
    v_mov_b64 v[60:61], 0
    v_mov_b64 v[62:63], 0
    v_smfmac_f32_16x16x64_bf16 v[56:59], v[28:31], a[208:215], v1
    s_nop 0
    v_smfmac_f32_16x16x64_bf16 v[60:63], v[28:31], a[216:223], v1
    v_pk_add_f32 v[48:49], v[48:49], v[50:51]
    v_cvt_pk_bf16_f32 v92, v48, v49
    s_nop 0
    v_pk_add_f32 v[52:53], v[52:53], v[54:55]
    v_cvt_pk_bf16_f32 v93, v52, v53
    s_waitcnt lgkmcnt(2)
    v_smfmac_f32_16x16x64_bf16 v[56:59], v[32:35], v[80:87], v1
    v_mov_b64 v[48:49], 0
    v_mov_b64 v[50:51], 0
    v_permlane16_swap_b32 v92, v93
    buffer_store_dwordx2 v[92:93], v8, s[4:7], s52 offen sc1
    s_waitcnt lgkmcnt(0)
    v_smfmac_f32_16x16x64_bf16 v[60:63], v[32:35], v[72:79], v1
    v_mov_b64 v[52:53], 0
    v_mov_b64 v[54:55], 0
    v_smfmac_f32_16x16x64_bf16 v[48:51], v[28:31], a[224:231], v1
    v_smfmac_f32_16x16x64_bf16 v[48:51], v[32:35], a[240:247], v1
    v_pk_add_f32 v[56:57], v[56:57], v[58:59]
    v_cvt_pk_bf16_f32 v88, v56, v57
    s_nop 1
    v_pk_add_f32 v[60:61], v[60:61], v[62:63]
    v_smfmac_f32_16x16x64_bf16 v[52:55], v[28:31], a[232:239], v1
    v_cvt_pk_bf16_f32 v89, v60, v61
    s_nop 1
    v_permlane16_swap_b32 v88, v89
    v_smfmac_f32_16x16x64_bf16 v[52:55], v[32:35], a[248:255], v1
    buffer_store_dwordx2 v[88:89], v8, s[4:7], s53 offen sc1
    v_pk_add_f32 v[48:49], v[48:49], v[50:51]
    v_cvt_pk_bf16_f32 v90, v48, v49
    s_nop 4
    v_pk_add_f32 v[52:53], v[52:53], v[54:55]
    v_cvt_pk_bf16_f32 v91, v52, v53
    s_nop 1
    v_permlane16_swap_b32 v90, v91
    buffer_store_dwordx2 v[90:91], v8, s[4:7], s54 offen sc1
    s_add_u32 s47, s74, s31
    s_xor_b32 s31, s31, 65536
    s_add_u32 s65, s68, s31
    s_add_u32 s31, s48, 65536
    s_add_u32 s44, s31, s64
    s_lshl_b32 s31, s48, 4
    s_add_u32 s67, s66, s31
    s_add_u32 s30, s30, 1
    s_and_b32 s31, vcc_lo, 0xffff
    s_ff0_i32_b32 s31, s31
    s_add_u32 s31, s31, s13
    s_max_u32 s16, s16, s31
    s_mov_b32 s13, s16
    s_lshl_b32 s12, s16, 7
    s_add_u32 s12, s12, 303104
    s_add_u32 s31, s30, 5
    s_min_u32 s31, s31, 64
    s_cmp_lt_u32 s16, s31
    s_cselect_b32 s12, s12, 0x40000000
    ds_read_b128 v[88:91], v4 offset:8192
    ds_read_b128 v[92:95], v4 offset:9216
    ds_read_b128 v[80:83], v4 offset:10240
    ds_read_b128 v[84:87], v4 offset:11264
    ds_read_b128 v[72:75], v4 offset:12288
    ds_read_b128 v[76:79], v4 offset:13312
    ds_read_b128 v[64:67], v4 offset:14336
    ds_read_b128 v[68:71], v4 offset:15360
    s_xor_b32 s50, s50, 524288
    s_xor_b32 s51, s51, 524288
    s_xor_b32 s52, s52, 524288
    s_xor_b32 s53, s53, 524288
    s_xor_b32 s54, s54, 524288
    s_cmp_ge_u32 s36, 80
    s_cbranch_scc1 adaLN_cond__memory_aug_recurrent_mem_tr__glu_gated_swiglu__prompt_kernel_slow_nored
adaLN_cond__memory_aug_recurrent_mem_tr__glu_gated_swiglu__prompt_kernel_slow_pollK:
    buffer_load_dwordx4 v[28:31], v0, s[4:7], s60 offen offset:0 sc1
    buffer_load_dwordx4 v[32:35], v0, s[4:7], s60 offen offset:1024 sc1
    buffer_load_dwordx4 v[36:39], v0, s[4:7], s60 offen offset:2048 sc1
    buffer_load_dwordx4 v[40:43], v0, s[4:7], s60 offen offset:3072 sc1
adaLN_cond__memory_aug_recurrent_mem_tr__glu_gated_swiglu__prompt_kernel_slow_pk1:
    s_waitcnt vmcnt(3)
    v_mfma_f32_16x16x32_bf16 v[44:47], v[16:19], v[28:31], 0
    s_waitcnt vmcnt(2)
    v_mfma_f32_16x16x32_bf16 v[44:47], v[16:19], v[32:35], v[44:47]
    s_waitcnt vmcnt(1)
    v_mfma_f32_16x16x32_bf16 v[44:47], v[16:19], v[36:39], v[44:47]
    v_max3_u32 v48, v28, v32, v36
    s_waitcnt vmcnt(0)
    v_mfma_f32_16x16x32_bf16 v[44:47], v[16:19], v[40:43], v[44:47]
    v_max_u32 v48, v48, v40
    s_nop 1
    v_mov_b32_dpp v49, v48 quad_perm:[0,0,0,0] row_mask:0xf bank_mask:0xf
    v_cmp_eq_u32 vcc, -1, v49
    s_nop 0
    s_mov_b64 exec, vcc
    s_cbranch_execnz adaLN_cond__memory_aug_recurrent_mem_tr__glu_gated_swiglu__prompt_kernel_slow_pollK
    s_mov_b64 exec, -1
    v_permlane32_swap_b32 v44, v46
    v_permlane32_swap_b32 v45, v47
    s_nop 0
    v_add_f32_dpp v44, v46, v44 row_ror:8 row_mask:0xf bank_mask:0xf
    v_add_f32_dpp v45, v47, v45 row_ror:8 row_mask:0xf bank_mask:0xf
    v_cvt_pk_bf16_f32 v11, v44, v45
    buffer_store_dword v11, v10, s[4:7], s57 offen sc1
    buffer_store_dword v11, v10, s[4:7], s75 offen sc1
    buffer_store_dword v14, v10, s[4:7], s56 offen sc1
    buffer_store_dword v14, v15, s[4:7], s60 offen sc1
    s_xor_b32 s60, s60, 524288
    s_mov_b32 s56, s57
    s_branch adaLN_cond__memory_aug_recurrent_mem_tr__glu_gated_swiglu__prompt_kernel_slow_end
adaLN_cond__memory_aug_recurrent_mem_tr__glu_gated_swiglu__prompt_kernel_slow_nored:
adaLN_cond__memory_aug_recurrent_mem_tr__glu_gated_swiglu__prompt_kernel_slow_end:
    s_waitcnt lgkmcnt(0)
    s_cmp_lg_u32 s30, 63
    s_cbranch_scc1 adaLN_cond__memory_aug_recurrent_mem_tr__glu_gated_swiglu__prompt_kernel_slow
    s_branch adaLN_cond__memory_aug_recurrent_mem_tr__glu_gated_swiglu__prompt_kernel_fin
adaLN_cond__memory_aug_recurrent_mem_tr__glu_gated_swiglu__prompt_kernel_slow_fixv:
    buffer_load_dwordx4 v[92:95], v0, s[4:7], s67 offen sc1
    s_waitcnt vmcnt(0)
    v_cmp_eq_u32 vcc, -1, v92
    s_cbranch_vccnz adaLN_cond__memory_aug_recurrent_mem_tr__glu_gated_swiglu__prompt_kernel_slow_fixv
    s_branch adaLN_cond__memory_aug_recurrent_mem_tr__glu_gated_swiglu__prompt_kernel_slow_pv2
adaLN_cond__memory_aug_recurrent_mem_tr__glu_gated_swiglu__prompt_kernel_fin:
    s_nop 3
    buffer_store_dword v11, v10, s[4:7], s47 offen sc1
adaLN_cond__memory_aug_recurrent_mem_tr__glu_gated_swiglu__prompt_kernel_exit:
    s_endpgm
adaLN_cond__memory_aug_recurrent_mem_tr__glu_gated_swiglu__prompt_kernel_helper:
    v_mov_b32 v24, -1
    v_mov_b32 v25, -1
    v_mov_b32 v26, -1
    v_mov_b32 v27, -1
    s_cmp_lg_u32 s29, 0
    s_cbranch_scc1 adaLN_cond__memory_aug_recurrent_mem_tr__glu_gated_swiglu__prompt_kernel_helper_nocal
    s_lshl_b32 s31, s28, 7
    s_add_u32 s31, s31, s63
    s_add_u32 s82, s31, 147456
    s_add_u32 s83, s31, 155648
    s_mov_b32 s80, -1
    s_mov_b32 s81, -1
    s_mov_b32 s31, 5
adaLN_cond__memory_aug_recurrent_mem_tr__glu_gated_swiglu__prompt_kernel_helper_cal:
    s_memtime s[76:77]
    s_waitcnt lgkmcnt(0)
    buffer_store_dword v14, v10, s[4:7], s82 offen sc1
    s_waitcnt vmcnt(0)
    s_memtime s[78:79]
    s_waitcnt lgkmcnt(0)
    s_sub_u32 s78, s78, s76
    s_min_u32 s80, s80, s78
    s_memtime s[76:77]
    s_waitcnt lgkmcnt(0)
    buffer_store_dword v14, v10, s[4:7], s83 offen sc1
    s_waitcnt vmcnt(0)
    s_memtime s[78:79]
    s_waitcnt lgkmcnt(0)
    s_sub_u32 s78, s78, s76
    s_min_u32 s81, s81, s78
    s_sub_u32 s31, s31, 1
    s_cmp_lg_u32 s31, 0
    s_cbranch_scc1 adaLN_cond__memory_aug_recurrent_mem_tr__glu_gated_swiglu__prompt_kernel_helper_cal
    s_cmp_lt_u32 s81, s80
    s_cselect_b32 s61, 0x10001, 1
adaLN_cond__memory_aug_recurrent_mem_tr__glu_gated_swiglu__prompt_kernel_helper_nocal:
    s_barrier
    s_load_dwordx2 s[76:77], s[0:1], 8
    v_mov_b32 v40, -1
    v_mov_b32 v41, -1
    v_mov_b32 v42, -1
    v_mov_b32 v43, -1
    s_lshl_b32 s31, s28, 2
    s_add_u32 s31, s31, s29
    s_mul_i32 s32, s31, 2560
    s_add_u32 s78, s32, 1048576
    buffer_store_dwordx4 v[40:43], v0, s[4:7], s78 offen offset:0 sc1
    buffer_store_dwordx4 v[40:43], v0, s[4:7], s78 offen offset:1024 sc1
    buffer_store_dwordx4 v[40:43], v0, s[4:7], s78 offen offset:2048 sc1
    s_add_u32 s78, s32, 1572864
    buffer_store_dwordx4 v[40:43], v0, s[4:7], s78 offen offset:0 sc1
    buffer_store_dwordx4 v[40:43], v0, s[4:7], s78 offen offset:1024 sc1
    buffer_store_dwordx4 v[40:43], v0, s[4:7], s78 offen offset:2048 sc1
    s_lshl_b32 s78, s31, 10
    s_add_u32 s79, s78, 81920
    buffer_store_dwordx4 v[40:43], v0, s[4:7], s79 offen sc1
    s_add_u32 s79, s78, s63
    s_add_u32 s79, s79, 32768
    s_cmp_ge_u32 s31, 96
    s_cselect_b32 s79, 0x40000000, s79
    buffer_store_dwordx4 v[40:43], v0, s[4:7], s79 offen sc1
    s_waitcnt lgkmcnt(0)
    s_mov_b32 s80, s76
    s_and_b32 s81, s77, 0xffff
    s_mov_b32 s82, 10240
    s_mov_b32 s83, 0x20000
    s_cmp_ge_u32 s31, 40
    s_cbranch_scc1 adaLN_cond__memory_aug_recurrent_mem_tr__glu_gated_swiglu__prompt_kernel_nom0
    s_lshl_b32 s78, s31, 6
    v_lshrrev_b32 v44, 4, v0
    v_add_u32 v44, s78, v44
    v_and_b32 v45, 1, v44
    v_bfe_u32 v46, v44, 1, 2
    v_bfe_u32 v47, v44, 3, 4
    v_lshrrev_b32 v48, 7, v44
    v_lshl_add_u32 v47, v45, 4, v47
    v_lshl_add_u32 v47, v48, 5, v47
    v_mul_u32_u24 v46, 2560, v46
    v_lshl_add_u32 v46, v47, 1, v46
    buffer_load_ushort v45, v46, s[80:83], 0 offen
    buffer_load_ushort v47, v46, s[80:83], 0 offen offset:1280
    v_lshlrev_b32 v44, 2, v44
    s_waitcnt vmcnt(0)
    v_lshl_or_b32 v45, v47, 16, v45
    v_min_u32 v45, 0xfffffffe, v45
    s_mov_b32 s78, 65536
    s_cmp_ge_u32 s31, 32
    s_cselect_b32 s79, 8192, 0
    s_add_u32 s79, s79, s63
    s_add_u32 s80, s79, 8192
    buffer_store_dword v45, v44, s[4:7], s78 offen sc1
    buffer_store_dword v45, v44, s[4:7], s79 offen sc1
    buffer_store_dword v45, v44, s[4:7], s80 offen sc1
adaLN_cond__memory_aug_recurrent_mem_tr__glu_gated_swiglu__prompt_kernel_nom0:
    s_add_u32 s31, s66, 0
    s_add_u32 s31, s31, s63
    buffer_store_dwordx4 v[24:27], v0, s[4:7], s31 offen sc1
    s_add_u32 s31, s66, 8192
    s_add_u32 s31, s31, s63
    buffer_store_dwordx4 v[24:27], v0, s[4:7], s31 offen sc1
    s_add_u32 s31, s66, 262144
    s_add_u32 s31, s31, s63
    buffer_store_dwordx4 v[24:27], v0, s[4:7], s31 offen sc1
    s_add_u32 s31, s66, 270336
    s_add_u32 s31, s31, s63
    buffer_store_dwordx4 v[24:27], v0, s[4:7], s31 offen sc1
    s_add_u32 s31, s66, 524288
    s_add_u32 s31, s31, s63
    buffer_store_dwordx4 v[24:27], v0, s[4:7], s31 offen sc1
    s_add_u32 s31, s66, 532480
    s_add_u32 s31, s31, s63
    buffer_store_dwordx4 v[24:27], v0, s[4:7], s31 offen sc1
    s_add_u32 s31, s66, 786432
    s_add_u32 s31, s31, s63
    buffer_store_dwordx4 v[24:27], v0, s[4:7], s31 offen sc1
    s_add_u32 s31, s66, 794624
    s_add_u32 s31, s31, s63
    buffer_store_dwordx4 v[24:27], v0, s[4:7], s31 offen sc1
    s_waitcnt vmcnt(0)
    s_barrier
    s_cmp_lg_u32 s29, 0
    s_cbranch_scc1 adaLN_cond__memory_aug_recurrent_mem_tr__glu_gated_swiglu__prompt_kernel_helper_noib
    v_mov_b32 v44, 132
    v_mov_b32 v45, s61
    s_mov_b64 exec, 1
    buffer_atomic_add v45, v44, s[8:11], 0 offen
    s_mov_b64 exec, -1
adaLN_cond__memory_aug_recurrent_mem_tr__glu_gated_swiglu__prompt_kernel_helper_noib:
    s_add_u32 s31, s33, 0
    s_add_u32 m0, s42, 0
    s_nop 0
    buffer_load_dwordx4 v28, s[20:23], s31 offen nt lds
    s_add_u32 s31, s33, 32768
    s_add_u32 m0, s42, 1024
    s_nop 0
    buffer_load_dwordx4 v28, s[20:23], s31 offen nt lds
    s_add_u32 s31, s33, 65536
    s_add_u32 m0, s42, 2048
    s_nop 0
    buffer_load_dwordx4 v28, s[20:23], s31 offen nt lds
    s_add_u32 s31, s33, 98304
    s_add_u32 m0, s42, 3072
    s_nop 0
    buffer_load_dwordx4 v28, s[20:23], s31 offen nt lds
    s_add_u32 s31, s33, 524288
    s_add_u32 m0, s42, 4096
    s_nop 0
    buffer_load_dwordx4 v28, s[20:23], s31 offen nt lds
    s_add_u32 s31, s33, 557056
    s_add_u32 m0, s42, 5120
    s_nop 0
    buffer_load_dwordx4 v28, s[20:23], s31 offen nt lds
    s_add_u32 s31, s33, 589824
    s_add_u32 m0, s42, 6144
    s_nop 0
    buffer_load_dwordx4 v28, s[20:23], s31 offen nt lds
    s_add_u32 s31, s33, 622592
    s_add_u32 m0, s42, 7168
    s_nop 0
    buffer_load_dwordx4 v28, s[20:23], s31 offen nt lds
    s_add_u32 s31, s33, 1048576
    s_add_u32 m0, s42, 8192
    s_nop 0
    buffer_load_dwordx4 v28, s[20:23], s31 offen nt lds
    s_add_u32 s31, s33, 1081344
    s_add_u32 m0, s42, 9216
    s_nop 0
    buffer_load_dwordx4 v28, s[20:23], s31 offen nt lds
    s_add_u32 s31, s33, 1114112
    s_add_u32 m0, s42, 10240
    s_nop 0
    buffer_load_dwordx4 v28, s[20:23], s31 offen nt lds
    s_add_u32 s31, s33, 1146880
    s_add_u32 m0, s42, 11264
    s_nop 0
    buffer_load_dwordx4 v28, s[20:23], s31 offen nt lds
    s_add_u32 s31, s33, 1572864
    s_add_u32 m0, s42, 12288
    s_nop 0
    buffer_load_dwordx4 v28, s[20:23], s31 offen nt lds
    s_add_u32 s31, s33, 1605632
    s_add_u32 m0, s42, 13312
    s_nop 0
    buffer_load_dwordx4 v28, s[20:23], s31 offen nt lds
    s_add_u32 s31, s33, 1638400
    s_add_u32 m0, s42, 14336
    s_nop 0
    buffer_load_dwordx4 v28, s[20:23], s31 offen nt lds
    s_add_u32 s31, s33, 1671168
    s_add_u32 m0, s42, 15360
    s_nop 0
    buffer_load_dwordx4 v28, s[20:23], s31 offen nt lds
    s_waitcnt vmcnt(12)
    s_barrier
    ds_read_b64_tr_b16 v[128:129], v30 offset:0
    ds_read_b64_tr_b16 v[130:131], v30 offset:512
    ds_read_b64_tr_b16 v[132:133], v30 offset:2048
    ds_read_b64_tr_b16 v[134:135], v30 offset:2560
    ds_read_b64_tr_b16 v[136:137], v30 offset:32
    ds_read_b64_tr_b16 v[138:139], v30 offset:544
    ds_read_b64_tr_b16 v[140:141], v30 offset:2080
    ds_read_b64_tr_b16 v[142:143], v30 offset:2592
    s_waitcnt lgkmcnt(0)
    s_waitcnt vmcnt(8)
    s_barrier
    s_add_u32 s31, s33, 2097152
    s_add_u32 m0, s42, 16384
    s_nop 0
    buffer_load_dwordx4 v28, s[20:23], s31 offen nt lds
    s_add_u32 s31, s33, 2129920
    s_add_u32 m0, s42, 17408
    s_nop 0
    buffer_load_dwordx4 v28, s[20:23], s31 offen nt lds
    s_add_u32 s31, s33, 2162688
    s_add_u32 m0, s42, 18432
    s_nop 0
    buffer_load_dwordx4 v28, s[20:23], s31 offen nt lds
    s_add_u32 s31, s33, 2195456
    s_add_u32 m0, s42, 19456
    s_nop 0
    buffer_load_dwordx4 v28, s[20:23], s31 offen nt lds
    ds_read_b64_tr_b16 v[144:145], v30 offset:4096
    ds_read_b64_tr_b16 v[146:147], v30 offset:4608
    ds_read_b64_tr_b16 v[148:149], v30 offset:6144
    ds_read_b64_tr_b16 v[150:151], v30 offset:6656
    ds_read_b64_tr_b16 v[152:153], v30 offset:4128
    ds_read_b64_tr_b16 v[154:155], v30 offset:4640
    ds_read_b64_tr_b16 v[156:157], v30 offset:6176
    ds_read_b64_tr_b16 v[158:159], v30 offset:6688
    s_waitcnt lgkmcnt(0)
    s_waitcnt vmcnt(8)
    s_barrier
    s_add_u32 s31, s33, 2621440
    s_add_u32 m0, s42, 20480
    s_nop 0
    buffer_load_dwordx4 v28, s[20:23], s31 offen nt lds
    s_add_u32 s31, s33, 2654208
    s_add_u32 m0, s42, 21504
    s_nop 0
    buffer_load_dwordx4 v28, s[20:23], s31 offen nt lds
    s_add_u32 s31, s33, 2686976
    s_add_u32 m0, s42, 22528
    s_nop 0
    buffer_load_dwordx4 v28, s[20:23], s31 offen nt lds
    s_add_u32 s31, s33, 2719744
    s_add_u32 m0, s42, 23552
    s_nop 0
    buffer_load_dwordx4 v28, s[20:23], s31 offen nt lds
    ds_read_b64_tr_b16 v[160:161], v30 offset:8192
    ds_read_b64_tr_b16 v[162:163], v30 offset:8704
    ds_read_b64_tr_b16 v[164:165], v30 offset:10240
    ds_read_b64_tr_b16 v[166:167], v30 offset:10752
    ds_read_b64_tr_b16 v[168:169], v30 offset:8224
    ds_read_b64_tr_b16 v[170:171], v30 offset:8736
    ds_read_b64_tr_b16 v[172:173], v30 offset:10272
    ds_read_b64_tr_b16 v[174:175], v30 offset:10784
    s_waitcnt lgkmcnt(0)
    s_waitcnt vmcnt(8)
    s_barrier
    s_add_u32 s31, s33, 3145728
    s_add_u32 m0, s42, 24576
    s_nop 0
    buffer_load_dwordx4 v28, s[20:23], s31 offen nt lds
    s_add_u32 s31, s33, 3178496
    s_add_u32 m0, s42, 25600
    s_nop 0
    buffer_load_dwordx4 v28, s[20:23], s31 offen nt lds
    s_add_u32 s31, s33, 3211264
    s_add_u32 m0, s42, 26624
    s_nop 0
    buffer_load_dwordx4 v28, s[20:23], s31 offen nt lds
    s_add_u32 s31, s33, 3244032
    s_add_u32 m0, s42, 27648
    s_nop 0
    buffer_load_dwordx4 v28, s[20:23], s31 offen nt lds
    ds_read_b64_tr_b16 v[176:177], v30 offset:12288
    ds_read_b64_tr_b16 v[178:179], v30 offset:12800
    ds_read_b64_tr_b16 v[180:181], v30 offset:14336
    ds_read_b64_tr_b16 v[182:183], v30 offset:14848
    ds_read_b64_tr_b16 v[184:185], v30 offset:12320
    ds_read_b64_tr_b16 v[186:187], v30 offset:12832
    ds_read_b64_tr_b16 v[188:189], v30 offset:14368
    ds_read_b64_tr_b16 v[190:191], v30 offset:14880
    s_waitcnt lgkmcnt(0)
    s_waitcnt vmcnt(8)
    s_barrier
    s_add_u32 s31, s33, 3670016
    s_add_u32 m0, s42, 28672
    s_nop 0
    buffer_load_dwordx4 v28, s[20:23], s31 offen nt lds
    s_add_u32 s31, s33, 3702784
    s_add_u32 m0, s42, 29696
    s_nop 0
    buffer_load_dwordx4 v28, s[20:23], s31 offen nt lds
    s_add_u32 s31, s33, 3735552
    s_add_u32 m0, s42, 30720
    s_nop 0
    buffer_load_dwordx4 v28, s[20:23], s31 offen nt lds
    s_add_u32 s31, s33, 3768320
    s_add_u32 m0, s42, 31744
    s_nop 0
    buffer_load_dwordx4 v28, s[20:23], s31 offen nt lds
    ds_read_b64_tr_b16 v[192:193], v30 offset:16384
    ds_read_b64_tr_b16 v[194:195], v30 offset:16896
    ds_read_b64_tr_b16 v[196:197], v30 offset:18432
    ds_read_b64_tr_b16 v[198:199], v30 offset:18944
    ds_read_b64_tr_b16 v[200:201], v30 offset:16416
    ds_read_b64_tr_b16 v[202:203], v30 offset:16928
    ds_read_b64_tr_b16 v[204:205], v30 offset:18464
    ds_read_b64_tr_b16 v[206:207], v30 offset:18976
    s_waitcnt lgkmcnt(0)
    s_waitcnt vmcnt(8)
    s_barrier
    s_add_u32 s31, s33, 4194304
    s_add_u32 m0, s42, 0
    s_nop 0
    buffer_load_dwordx4 v28, s[20:23], s31 offen nt lds
    s_add_u32 s31, s33, 4227072
    s_add_u32 m0, s42, 1024
    s_nop 0
    buffer_load_dwordx4 v28, s[20:23], s31 offen nt lds
    s_add_u32 s31, s33, 4259840
    s_add_u32 m0, s42, 2048
    s_nop 0
    buffer_load_dwordx4 v28, s[20:23], s31 offen nt lds
    s_add_u32 s31, s33, 4292608
    s_add_u32 m0, s42, 3072
    s_nop 0
    buffer_load_dwordx4 v28, s[20:23], s31 offen nt lds
    ds_read_b64_tr_b16 v[208:209], v30 offset:20480
    ds_read_b64_tr_b16 v[210:211], v30 offset:20992
    ds_read_b64_tr_b16 v[212:213], v30 offset:22528
    ds_read_b64_tr_b16 v[214:215], v30 offset:23040
    ds_read_b64_tr_b16 v[216:217], v30 offset:20512
    ds_read_b64_tr_b16 v[218:219], v30 offset:21024
    ds_read_b64_tr_b16 v[220:221], v30 offset:22560
    ds_read_b64_tr_b16 v[222:223], v30 offset:23072
    s_waitcnt lgkmcnt(0)
    s_waitcnt vmcnt(8)
    s_barrier
    s_add_u32 s31, s33, 4718592
    s_add_u32 m0, s42, 4096
    s_nop 0
    buffer_load_dwordx4 v28, s[20:23], s31 offen nt lds
    s_add_u32 s31, s33, 4751360
    s_add_u32 m0, s42, 5120
    s_nop 0
    buffer_load_dwordx4 v28, s[20:23], s31 offen nt lds
    s_add_u32 s31, s33, 4784128
    s_add_u32 m0, s42, 6144
    s_nop 0
    buffer_load_dwordx4 v28, s[20:23], s31 offen nt lds
    s_add_u32 s31, s33, 4816896
    s_add_u32 m0, s42, 7168
    s_nop 0
    buffer_load_dwordx4 v28, s[20:23], s31 offen nt lds
    ds_read_b64_tr_b16 v[224:225], v30 offset:24576
    ds_read_b64_tr_b16 v[226:227], v30 offset:25088
    ds_read_b64_tr_b16 v[228:229], v30 offset:26624
    ds_read_b64_tr_b16 v[230:231], v30 offset:27136
    ds_read_b64_tr_b16 v[232:233], v30 offset:24608
    ds_read_b64_tr_b16 v[234:235], v30 offset:25120
    ds_read_b64_tr_b16 v[236:237], v30 offset:26656
    ds_read_b64_tr_b16 v[238:239], v30 offset:27168
    s_waitcnt lgkmcnt(0)
    s_waitcnt vmcnt(8)
    s_barrier
    s_add_u32 s31, s33, 0
    s_add_u32 m0, s42, 8192
    s_nop 0
    buffer_load_dwordx4 v28, s[16:19], s31 offen nt lds
    s_add_u32 s31, s33, 32768
    s_add_u32 m0, s42, 9216
    s_nop 0
    buffer_load_dwordx4 v28, s[16:19], s31 offen nt lds
    s_add_u32 s31, s33, 65536
    s_add_u32 m0, s42, 10240
    s_nop 0
    buffer_load_dwordx4 v28, s[16:19], s31 offen nt lds
    s_add_u32 s31, s33, 98304
    s_add_u32 m0, s42, 11264
    s_nop 0
    buffer_load_dwordx4 v28, s[16:19], s31 offen nt lds
    ds_read_b64_tr_b16 v[240:241], v30 offset:28672
    ds_read_b64_tr_b16 v[242:243], v30 offset:29184
    ds_read_b64_tr_b16 v[244:245], v30 offset:30720
    ds_read_b64_tr_b16 v[246:247], v30 offset:31232
    ds_read_b64_tr_b16 v[248:249], v30 offset:28704
    ds_read_b64_tr_b16 v[250:251], v30 offset:29216
    ds_read_b64_tr_b16 v[252:253], v30 offset:30752
    ds_read_b64_tr_b16 v[254:255], v30 offset:31264
    s_waitcnt lgkmcnt(0)
    s_waitcnt vmcnt(8)
    s_barrier
    s_add_u32 s31, s33, 524288
    s_add_u32 m0, s42, 12288
    s_nop 0
    buffer_load_dwordx4 v28, s[16:19], s31 offen nt lds
    s_add_u32 s31, s33, 557056
    s_add_u32 m0, s42, 13312
    s_nop 0
    buffer_load_dwordx4 v28, s[16:19], s31 offen nt lds
    s_add_u32 s31, s33, 589824
    s_add_u32 m0, s42, 14336
    s_nop 0
    buffer_load_dwordx4 v28, s[16:19], s31 offen nt lds
    s_add_u32 s31, s33, 622592
    s_add_u32 m0, s42, 15360
    s_nop 0
    buffer_load_dwordx4 v28, s[16:19], s31 offen nt lds
    ds_read_b64_tr_b16 a[0:1], v30 offset:0
    ds_read_b64_tr_b16 a[2:3], v30 offset:512
    ds_read_b64_tr_b16 a[4:5], v30 offset:2048
    ds_read_b64_tr_b16 a[6:7], v30 offset:2560
    ds_read_b64_tr_b16 a[8:9], v30 offset:32
    ds_read_b64_tr_b16 a[10:11], v30 offset:544
    ds_read_b64_tr_b16 a[12:13], v30 offset:2080
    ds_read_b64_tr_b16 a[14:15], v30 offset:2592
    s_waitcnt lgkmcnt(0)
    s_waitcnt vmcnt(8)
    s_barrier
    s_add_u32 s31, s33, 1048576
    s_add_u32 m0, s42, 16384
    s_nop 0
    buffer_load_dwordx4 v28, s[16:19], s31 offen nt lds
    s_add_u32 s31, s33, 1081344
    s_add_u32 m0, s42, 17408
    s_nop 0
    buffer_load_dwordx4 v28, s[16:19], s31 offen nt lds
    s_add_u32 s31, s33, 1114112
    s_add_u32 m0, s42, 18432
    s_nop 0
    buffer_load_dwordx4 v28, s[16:19], s31 offen nt lds
    s_add_u32 s31, s33, 1146880
    s_add_u32 m0, s42, 19456
    s_nop 0
    buffer_load_dwordx4 v28, s[16:19], s31 offen nt lds
    ds_read_b64_tr_b16 a[16:17], v30 offset:4096
    ds_read_b64_tr_b16 a[18:19], v30 offset:4608
    ds_read_b64_tr_b16 a[20:21], v30 offset:6144
    ds_read_b64_tr_b16 a[22:23], v30 offset:6656
    ds_read_b64_tr_b16 a[24:25], v30 offset:4128
    ds_read_b64_tr_b16 a[26:27], v30 offset:4640
    ds_read_b64_tr_b16 a[28:29], v30 offset:6176
    ds_read_b64_tr_b16 a[30:31], v30 offset:6688
    s_waitcnt lgkmcnt(0)
    s_waitcnt vmcnt(8)
    s_barrier
    s_add_u32 s31, s33, 1572864
    s_add_u32 m0, s42, 20480
    s_nop 0
    buffer_load_dwordx4 v28, s[16:19], s31 offen nt lds
    s_add_u32 s31, s33, 1605632
    s_add_u32 m0, s42, 21504
    s_nop 0
    buffer_load_dwordx4 v28, s[16:19], s31 offen nt lds
    s_add_u32 s31, s33, 1638400
    s_add_u32 m0, s42, 22528
    s_nop 0
    buffer_load_dwordx4 v28, s[16:19], s31 offen nt lds
    s_add_u32 s31, s33, 1671168
    s_add_u32 m0, s42, 23552
    s_nop 0
    buffer_load_dwordx4 v28, s[16:19], s31 offen nt lds
    ds_read_b64_tr_b16 a[32:33], v30 offset:8192
    ds_read_b64_tr_b16 a[34:35], v30 offset:8704
    ds_read_b64_tr_b16 a[36:37], v30 offset:10240
    ds_read_b64_tr_b16 a[38:39], v30 offset:10752
    ds_read_b64_tr_b16 a[40:41], v30 offset:8224
    ds_read_b64_tr_b16 a[42:43], v30 offset:8736
    ds_read_b64_tr_b16 a[44:45], v30 offset:10272
    ds_read_b64_tr_b16 a[46:47], v30 offset:10784
    s_waitcnt lgkmcnt(0)
    s_waitcnt vmcnt(8)
    s_barrier
    s_add_u32 s31, s33, 2097152
    s_add_u32 m0, s42, 24576
    s_nop 0
    buffer_load_dwordx4 v28, s[16:19], s31 offen nt lds
    s_add_u32 s31, s33, 2129920
    s_add_u32 m0, s42, 25600
    s_nop 0
    buffer_load_dwordx4 v28, s[16:19], s31 offen nt lds
    s_add_u32 s31, s33, 2162688
    s_add_u32 m0, s42, 26624
    s_nop 0
    buffer_load_dwordx4 v28, s[16:19], s31 offen nt lds
    s_add_u32 s31, s33, 2195456
    s_add_u32 m0, s42, 27648
    s_nop 0
    buffer_load_dwordx4 v28, s[16:19], s31 offen nt lds
    ds_read_b64_tr_b16 a[48:49], v30 offset:12288
    ds_read_b64_tr_b16 a[50:51], v30 offset:12800
    ds_read_b64_tr_b16 a[52:53], v30 offset:14336
    ds_read_b64_tr_b16 a[54:55], v30 offset:14848
    ds_read_b64_tr_b16 a[56:57], v30 offset:12320
    ds_read_b64_tr_b16 a[58:59], v30 offset:12832
    ds_read_b64_tr_b16 a[60:61], v30 offset:14368
    ds_read_b64_tr_b16 a[62:63], v30 offset:14880
    s_waitcnt lgkmcnt(0)
    s_waitcnt vmcnt(8)
    s_barrier
    s_add_u32 s31, s33, 2621440
    s_add_u32 m0, s42, 28672
    s_nop 0
    buffer_load_dwordx4 v28, s[16:19], s31 offen nt lds
    s_add_u32 s31, s33, 2654208
    s_add_u32 m0, s42, 29696
    s_nop 0
    buffer_load_dwordx4 v28, s[16:19], s31 offen nt lds
    s_add_u32 s31, s33, 2686976
    s_add_u32 m0, s42, 30720
    s_nop 0
    buffer_load_dwordx4 v28, s[16:19], s31 offen nt lds
    s_add_u32 s31, s33, 2719744
    s_add_u32 m0, s42, 31744
    s_nop 0
    buffer_load_dwordx4 v28, s[16:19], s31 offen nt lds
    ds_read_b64_tr_b16 a[64:65], v30 offset:16384
    ds_read_b64_tr_b16 a[66:67], v30 offset:16896
    ds_read_b64_tr_b16 a[68:69], v30 offset:18432
    ds_read_b64_tr_b16 a[70:71], v30 offset:18944
    ds_read_b64_tr_b16 a[72:73], v30 offset:16416
    ds_read_b64_tr_b16 a[74:75], v30 offset:16928
    ds_read_b64_tr_b16 a[76:77], v30 offset:18464
    ds_read_b64_tr_b16 a[78:79], v30 offset:18976
    s_waitcnt lgkmcnt(0)
    s_waitcnt vmcnt(8)
    s_barrier
    s_add_u32 s31, s33, 3145728
    s_add_u32 m0, s42, 0
    s_nop 0
    buffer_load_dwordx4 v28, s[16:19], s31 offen nt lds
    s_add_u32 s31, s33, 3178496
    s_add_u32 m0, s42, 1024
    s_nop 0
    buffer_load_dwordx4 v28, s[16:19], s31 offen nt lds
    s_add_u32 s31, s33, 3211264
    s_add_u32 m0, s42, 2048
    s_nop 0
    buffer_load_dwordx4 v28, s[16:19], s31 offen nt lds
    s_add_u32 s31, s33, 3244032
    s_add_u32 m0, s42, 3072
    s_nop 0
    buffer_load_dwordx4 v28, s[16:19], s31 offen nt lds
    ds_read_b64_tr_b16 a[80:81], v30 offset:20480
    ds_read_b64_tr_b16 a[82:83], v30 offset:20992
    ds_read_b64_tr_b16 a[84:85], v30 offset:22528
    ds_read_b64_tr_b16 a[86:87], v30 offset:23040
    ds_read_b64_tr_b16 a[88:89], v30 offset:20512
    ds_read_b64_tr_b16 a[90:91], v30 offset:21024
    ds_read_b64_tr_b16 a[92:93], v30 offset:22560
    ds_read_b64_tr_b16 a[94:95], v30 offset:23072
    s_waitcnt lgkmcnt(0)
    s_waitcnt vmcnt(8)
    s_barrier
    s_add_u32 s31, s33, 3670016
    s_add_u32 m0, s42, 4096
    s_nop 0
    buffer_load_dwordx4 v28, s[16:19], s31 offen nt lds
    s_add_u32 s31, s33, 3702784
    s_add_u32 m0, s42, 5120
    s_nop 0
    buffer_load_dwordx4 v28, s[16:19], s31 offen nt lds
    s_add_u32 s31, s33, 3735552
    s_add_u32 m0, s42, 6144
    s_nop 0
    buffer_load_dwordx4 v28, s[16:19], s31 offen nt lds
    s_add_u32 s31, s33, 3768320
    s_add_u32 m0, s42, 7168
    s_nop 0
    buffer_load_dwordx4 v28, s[16:19], s31 offen nt lds
    ds_read_b64_tr_b16 a[96:97], v30 offset:24576
    ds_read_b64_tr_b16 a[98:99], v30 offset:25088
    ds_read_b64_tr_b16 a[100:101], v30 offset:26624
    ds_read_b64_tr_b16 a[102:103], v30 offset:27136
    ds_read_b64_tr_b16 a[104:105], v30 offset:24608
    ds_read_b64_tr_b16 a[106:107], v30 offset:25120
    ds_read_b64_tr_b16 a[108:109], v30 offset:26656
    ds_read_b64_tr_b16 a[110:111], v30 offset:27168
    s_waitcnt lgkmcnt(0)
    s_waitcnt vmcnt(8)
    s_barrier
    s_add_u32 s31, s33, 4194304
    s_add_u32 m0, s42, 8192
    s_nop 0
    buffer_load_dwordx4 v28, s[16:19], s31 offen nt lds
    s_add_u32 s31, s33, 4227072
    s_add_u32 m0, s42, 9216
    s_nop 0
    buffer_load_dwordx4 v28, s[16:19], s31 offen nt lds
    s_add_u32 s31, s33, 4259840
    s_add_u32 m0, s42, 10240
    s_nop 0
    buffer_load_dwordx4 v28, s[16:19], s31 offen nt lds
    s_add_u32 s31, s33, 4292608
    s_add_u32 m0, s42, 11264
    s_nop 0
    buffer_load_dwordx4 v28, s[16:19], s31 offen nt lds
    ds_read_b64_tr_b16 a[112:113], v30 offset:28672
    ds_read_b64_tr_b16 a[114:115], v30 offset:29184
    ds_read_b64_tr_b16 a[116:117], v30 offset:30720
    ds_read_b64_tr_b16 a[118:119], v30 offset:31232
    ds_read_b64_tr_b16 a[120:121], v30 offset:28704
    ds_read_b64_tr_b16 a[122:123], v30 offset:29216
    ds_read_b64_tr_b16 a[124:125], v30 offset:30752
    ds_read_b64_tr_b16 a[126:127], v30 offset:31264
    s_waitcnt lgkmcnt(0)
    s_waitcnt vmcnt(8)
    s_barrier
    s_add_u32 s31, s33, 4718592
    s_add_u32 m0, s42, 12288
    s_nop 0
    buffer_load_dwordx4 v28, s[16:19], s31 offen nt lds
    s_add_u32 s31, s33, 4751360
    s_add_u32 m0, s42, 13312
    s_nop 0
    buffer_load_dwordx4 v28, s[16:19], s31 offen nt lds
    s_add_u32 s31, s33, 4784128
    s_add_u32 m0, s42, 14336
    s_nop 0
    buffer_load_dwordx4 v28, s[16:19], s31 offen nt lds
    s_add_u32 s31, s33, 4816896
    s_add_u32 m0, s42, 15360
    s_nop 0
    buffer_load_dwordx4 v28, s[16:19], s31 offen nt lds
    ds_read_b64_tr_b16 a[128:129], v30 offset:0
    ds_read_b64_tr_b16 a[130:131], v30 offset:512
    ds_read_b64_tr_b16 a[132:133], v30 offset:2048
    ds_read_b64_tr_b16 a[134:135], v30 offset:2560
    ds_read_b64_tr_b16 a[136:137], v30 offset:32
    ds_read_b64_tr_b16 a[138:139], v30 offset:544
    ds_read_b64_tr_b16 a[140:141], v30 offset:2080
    ds_read_b64_tr_b16 a[142:143], v30 offset:2592
    s_waitcnt lgkmcnt(0)
    s_waitcnt vmcnt(8)
    s_barrier
    ds_read_b64_tr_b16 a[144:145], v30 offset:4096
    ds_read_b64_tr_b16 a[146:147], v30 offset:4608
    ds_read_b64_tr_b16 a[148:149], v30 offset:6144
    ds_read_b64_tr_b16 a[150:151], v30 offset:6656
    ds_read_b64_tr_b16 a[152:153], v30 offset:4128
    ds_read_b64_tr_b16 a[154:155], v30 offset:4640
    ds_read_b64_tr_b16 a[156:157], v30 offset:6176
    ds_read_b64_tr_b16 a[158:159], v30 offset:6688
    s_waitcnt lgkmcnt(0)
    s_waitcnt vmcnt(4)
    s_barrier
    ds_read_b64_tr_b16 a[160:161], v30 offset:8192
    ds_read_b64_tr_b16 a[162:163], v30 offset:8704
    ds_read_b64_tr_b16 a[164:165], v30 offset:10240
    ds_read_b64_tr_b16 a[166:167], v30 offset:10752
    ds_read_b64_tr_b16 a[168:169], v30 offset:8224
    ds_read_b64_tr_b16 a[170:171], v30 offset:8736
    ds_read_b64_tr_b16 a[172:173], v30 offset:10272
    ds_read_b64_tr_b16 a[174:175], v30 offset:10784
    s_waitcnt lgkmcnt(0)
    s_waitcnt vmcnt(0)
    s_barrier
    ds_read_b64_tr_b16 a[176:177], v30 offset:12288
    ds_read_b64_tr_b16 a[178:179], v30 offset:12800
    ds_read_b64_tr_b16 a[180:181], v30 offset:14336
    ds_read_b64_tr_b16 a[182:183], v30 offset:14848
    ds_read_b64_tr_b16 a[184:185], v30 offset:12320
    ds_read_b64_tr_b16 a[186:187], v30 offset:12832
    ds_read_b64_tr_b16 a[188:189], v30 offset:14368
    ds_read_b64_tr_b16 a[190:191], v30 offset:14880
    s_waitcnt lgkmcnt(0)
    s_barrier
    s_barrier
    v_mov_b32 v34, 128
adaLN_cond__memory_aug_recurrent_mem_tr__glu_gated_swiglu__prompt_kernel_helper_ibw:
    s_sleep 8
    buffer_load_dwordx2 v[32:33], v34, s[8:11], 0 offen sc1
    s_waitcnt vmcnt(0)
    v_readfirstlane_b32 s31, v32
    v_readfirstlane_b32 s32, v33
    s_nop 0
    s_and_b32 s31, s32, 0xffff
    s_cmp_lt_u32 s31, 32
    s_cbranch_scc1 adaLN_cond__memory_aug_recurrent_mem_tr__glu_gated_swiglu__prompt_kernel_helper_ibw
    s_lshr_b32 s32, s32, 16
    s_cmp_ge_u32 s32, 16
    s_cselect_b32 s31, 8192, 0
    s_add_u32 s63, s63, s31
    s_add_u32 s66, s66, s63
    s_mov_b32 s67, s66
    v_mov_b32 v33, 0
adaLN_cond__memory_aug_recurrent_mem_tr__glu_gated_swiglu__prompt_kernel_helper_ibwm:
    buffer_load_dword v32, v33, s[8:11], 0 offen sc1
    s_waitcnt vmcnt(0)
    v_readfirstlane_b32 s31, v32
    s_nop 0
    s_cmp_lt_u32 s31, 1
    s_cbranch_scc1 adaLN_cond__memory_aug_recurrent_mem_tr__glu_gated_swiglu__prompt_kernel_helper_ibwm
    s_lshl_b32 s50, s29, 10
    s_and_b32 s31, s29, 3
    s_lshl_b32 s31, s31, 10
    s_add_u32 s51, s31, 4096
    s_and_b32 s31, s29, 1
    s_lshl_b32 s31, s31, 10
    s_add_u32 s52, s31, 8192
    v_add_u32 v7, s50, v0
    v_add_u32 v9, s51, v0
    v_add_u32 v6, s52, v0
    s_cmp_ge_u32 s52, 8192
    s_cselect_b32 s31, 8192, 0
    s_add_u32 s52, s52, s31
    s_add_u32 s50, s50, s63
    s_add_u32 s51, s51, s63
    s_add_u32 s52, s52, s63
    s_mov_b32 s44, s50
    s_mov_b32 s45, s51
    s_mov_b32 s46, s52
    s_lshl_b32 s31, s29, 9
    s_add_u32 s31, s31, 10240
    v_add_u32 v3, s31, v11
    s_mov_b32 s65, 0x40000000
    s_cmp_eq_u32 s29, 3
    s_mov_b32 s15, 262144
    s_cselect_b32 s15, s15, 0x40000000
adaLN_cond__memory_aug_recurrent_mem_tr__glu_gated_swiglu__prompt_kernel_helper_loop:
    v_mov_b64 v[48:49], 0
    v_mov_b64 v[50:51], 0
    v_mov_b64 v[52:53], 0
    v_mov_b64 v[54:55], 0
    v_mov_b64 v[56:57], 0
    v_mov_b64 v[58:59], 0
    v_mov_b64 v[60:61], 0
    v_mov_b64 v[62:63], 0
adaLN_cond__memory_aug_recurrent_mem_tr__glu_gated_swiglu__prompt_kernel_helper_loop_poll:
    buffer_load_dwordx4 v[32:35], v0, s[4:7], s44 offen sc1
    buffer_load_dwordx4 v[36:39], v0, s[4:7], s45 offen sc1
    s_waitcnt vmcnt(0)
    v_max_u32 v40, v32, v36
    v_cmp_eq_u32 vcc, -1, v40
    s_nop 0
    s_mov_b64 exec, vcc
    s_cbranch_execnz adaLN_cond__memory_aug_recurrent_mem_tr__glu_gated_swiglu__prompt_kernel_helper_loop_poll
    s_mov_b64 exec, -1
    ds_write_b128 v7, v[32:35]
    ds_write_b128 v9, v[36:39]
    s_waitcnt lgkmcnt(0)
    s_barrier
    ds_read_b64_tr_b16 v[64:65], v2 offset:0
    ds_read_b64_tr_b16 v[66:67], v2 offset:512
    ds_read_b64_tr_b16 v[68:69], v2 offset:1024
    ds_read_b64_tr_b16 v[70:71], v2 offset:1536
    ds_read_b64_tr_b16 v[72:73], v2 offset:2048
    ds_read_b64_tr_b16 v[74:75], v2 offset:2560
    ds_read_b64_tr_b16 v[76:77], v2 offset:3072
    ds_read_b64_tr_b16 v[78:79], v2 offset:3584
    ds_read_b64_tr_b16 v[80:81], v2 offset:4096
    ds_read_b64_tr_b16 v[82:83], v2 offset:4608
    ds_read_b64_tr_b16 v[84:85], v2 offset:5120
    ds_read_b64_tr_b16 v[86:87], v2 offset:5632
    ds_read_b64_tr_b16 v[88:89], v2 offset:6144
    ds_read_b64_tr_b16 v[90:91], v2 offset:6656
    s_waitcnt lgkmcnt(12)
    v_smfmac_f32_16x16x64_bf16 v[48:51], v[64:67], v[128:135], v1
    v_smfmac_f32_16x16x64_bf16 v[52:55], v[64:67], v[136:143], v1
    ds_read_b64_tr_b16 v[92:93], v2 offset:7168
    ds_read_b64_tr_b16 v[94:95], v2 offset:7680
    s_waitcnt lgkmcnt(12)
    v_smfmac_f32_16x16x64_bf16 v[48:51], v[68:71], v[144:151], v1
    v_smfmac_f32_16x16x64_bf16 v[52:55], v[68:71], v[152:159], v1
    s_waitcnt lgkmcnt(10)
    v_smfmac_f32_16x16x64_bf16 v[48:51], v[72:75], v[160:167], v1
    v_smfmac_f32_16x16x64_bf16 v[52:55], v[72:75], v[168:175], v1
    s_waitcnt lgkmcnt(8)
    v_smfmac_f32_16x16x64_bf16 v[48:51], v[76:79], v[176:183], v1
    v_smfmac_f32_16x16x64_bf16 v[52:55], v[76:79], v[184:191], v1
    s_waitcnt lgkmcnt(6)
    v_smfmac_f32_16x16x64_bf16 v[48:51], v[80:83], v[192:199], v1
    v_smfmac_f32_16x16x64_bf16 v[52:55], v[80:83], v[200:207], v1
    s_waitcnt lgkmcnt(4)
    v_smfmac_f32_16x16x64_bf16 v[48:51], v[84:87], v[208:215], v1
    v_smfmac_f32_16x16x64_bf16 v[52:55], v[84:87], v[216:223], v1
    s_waitcnt lgkmcnt(2)
    v_smfmac_f32_16x16x64_bf16 v[48:51], v[88:91], v[224:231], v1
    v_smfmac_f32_16x16x64_bf16 v[52:55], v[88:91], v[232:239], v1
    s_waitcnt lgkmcnt(0)
    v_smfmac_f32_16x16x64_bf16 v[48:51], v[92:95], v[240:247], v1
    v_smfmac_f32_16x16x64_bf16 v[52:55], v[92:95], v[248:255], v1
    s_nop 6
    v_pk_add_f32 v[44:45], v[48:49], v[50:51]
    v_pk_add_f32 v[46:47], v[52:53], v[54:55]
    buffer_store_dwordx4 v[44:47], v0, s[4:7], s67 offen sc1
    buffer_store_dwordx4 v[24:27], v0, s[4:7], s65 offen sc1
    s_mov_b32 s65, s67
    s_sub_u32 s31, s30, 1
    s_cmp_ge_u32 s31, 62
    s_cbranch_scc1 adaLN_cond__memory_aug_recurrent_mem_tr__glu_gated_swiglu__prompt_kernel_helper_loop_ns
    s_mov_b64 exec, 1
    buffer_atomic_sub v14, v0, s[4:7], s15 offen
    s_mov_b64 exec, -1
    s_add_u32 s15, s15, 128
adaLN_cond__memory_aug_recurrent_mem_tr__glu_gated_swiglu__prompt_kernel_helper_loop_ns:
    v_smfmac_f32_16x16x64_bf16 v[56:59], v[64:67], a[32:39], v1
    v_smfmac_f32_16x16x64_bf16 v[60:63], v[64:67], a[40:47], v1
    v_smfmac_f32_16x16x64_bf16 v[56:59], v[68:71], a[48:55], v1
    v_smfmac_f32_16x16x64_bf16 v[60:63], v[68:71], a[56:63], v1
    v_smfmac_f32_16x16x64_bf16 v[56:59], v[72:75], a[64:71], v1
    v_smfmac_f32_16x16x64_bf16 v[60:63], v[72:75], a[72:79], v1
    v_smfmac_f32_16x16x64_bf16 v[56:59], v[76:79], a[80:87], v1
    v_smfmac_f32_16x16x64_bf16 v[60:63], v[76:79], a[88:95], v1
    v_smfmac_f32_16x16x64_bf16 v[56:59], v[80:83], a[96:103], v1
    v_smfmac_f32_16x16x64_bf16 v[60:63], v[80:83], a[104:111], v1
    v_smfmac_f32_16x16x64_bf16 v[56:59], v[84:87], a[112:119], v1
    v_smfmac_f32_16x16x64_bf16 v[60:63], v[84:87], a[120:127], v1
    v_smfmac_f32_16x16x64_bf16 v[56:59], v[88:91], a[128:135], v1
    v_smfmac_f32_16x16x64_bf16 v[60:63], v[88:91], a[136:143], v1
    v_smfmac_f32_16x16x64_bf16 v[56:59], v[92:95], a[144:151], v1
    v_smfmac_f32_16x16x64_bf16 v[60:63], v[92:95], a[152:159], v1
adaLN_cond__memory_aug_recurrent_mem_tr__glu_gated_swiglu__prompt_kernel_helper_loop_poll2:
    buffer_load_dwordx4 v[32:35], v0, s[4:7], s46 offen sc1
    s_waitcnt vmcnt(0)
    v_cmp_eq_u32 vcc, -1, v32
    s_nop 0
    s_mov_b64 exec, vcc
    s_cbranch_execnz adaLN_cond__memory_aug_recurrent_mem_tr__glu_gated_swiglu__prompt_kernel_helper_loop_poll2
    s_mov_b64 exec, -1
    ds_write_b128 v6, v[32:35]
    s_waitcnt lgkmcnt(0)
    s_barrier
    ds_read_b64_tr_b16 v[96:97], v2 offset:8192
    ds_read_b64_tr_b16 v[98:99], v2 offset:8704
    ds_read_b64_tr_b16 v[100:101], v2 offset:9216
    ds_read_b64_tr_b16 v[102:103], v2 offset:9728
    s_waitcnt lgkmcnt(2)
    v_smfmac_f32_16x16x64_bf16 v[56:59], v[96:99], a[160:167], v1
    v_smfmac_f32_16x16x64_bf16 v[60:63], v[96:99], a[168:175], v1
    s_waitcnt lgkmcnt(0)
    v_smfmac_f32_16x16x64_bf16 v[56:59], v[100:103], a[176:183], v1
    v_smfmac_f32_16x16x64_bf16 v[60:63], v[100:103], a[184:191], v1
    v_smfmac_f32_16x16x64_bf16 v[48:51], v[96:99], a[0:7], v1
    v_smfmac_f32_16x16x64_bf16 v[52:55], v[96:99], a[8:15], v1
    v_smfmac_f32_16x16x64_bf16 v[48:51], v[100:103], a[16:23], v1
    v_smfmac_f32_16x16x64_bf16 v[52:55], v[100:103], a[24:31], v1
    s_nop 2
    v_pk_add_f32 v[56:57], v[56:57], v[58:59]
    v_cvt_pk_bf16_f32 v44, v56, v57
    v_pk_add_f32 v[60:61], v[60:61], v[62:63]
    v_cvt_pk_bf16_f32 v45, v60, v61
    ds_write2st64_b32 v5, v44, v45 offset0:0 offset1:1
    v_pk_add_f32 v[48:49], v[48:49], v[50:51]
    v_cvt_pk_bf16_f32 v46, v48, v49
    v_pk_add_f32 v[52:53], v[52:53], v[54:55]
    v_cvt_pk_bf16_f32 v47, v52, v53
    buffer_store_dwordx2 v[46:47], v11, s[4:7], s62 offen offset:2048 sc1
    s_waitcnt lgkmcnt(0)
    s_barrier
    ds_read_b64 v[44:45], v3
    s_add_u32 s30, s30, 1
    s_add_u32 s48, s48, 16384
    s_and_b32 s48, s48, 49152
    s_lshl_b32 s31, s48, 1
    s_add_u32 s44, s50, s31
    s_add_u32 s45, s51, s31
    s_add_u32 s46, s52, s31
    s_lshl_b32 s31, s48, 4
    s_add_u32 s67, s66, s31
    s_waitcnt lgkmcnt(0)
    buffer_store_dwordx2 v[44:45], v11, s[4:7], s62 offen sc1
    s_add_u32 s62, s62, 131072
    s_cmp_lt_u32 s30, 63
    s_cbranch_scc1 adaLN_cond__memory_aug_recurrent_mem_tr__glu_gated_swiglu__prompt_kernel_helper_loop_lag
    s_waitcnt vmcnt(0)
    s_barrier
    s_mov_b64 exec, 1
    buffer_atomic_sub v14, v0, s[4:7], s15 offen
    s_mov_b64 exec, -1
    s_add_u32 s15, s15, 128
adaLN_cond__memory_aug_recurrent_mem_tr__glu_gated_swiglu__prompt_kernel_helper_loop_lag:
    s_cmp_lt_u32 s30, 64
    s_cbranch_scc1 adaLN_cond__memory_aug_recurrent_mem_tr__glu_gated_swiglu__prompt_kernel_helper_loop
    s_endpgm
wk_entry:
    v_mov_b32 v1, v16
    s_load_dwordx2 s[88:89], s[0:1], 64
    s_load_dwordx2 s[90:91], s[0:1], 72
    s_load_dwordx2 s[92:93], s[0:1], 80
    s_load_dwordx2 s[94:95], s[0:1], 0
    s_load_dwordx2 s[96:97], s[0:1], 104
    s_waitcnt lgkmcnt(0)
    s_mov_b32 s64, s88
    s_and_b32 s65, s89, 0xffff
    s_mov_b32 s66, 2211840
    s_mov_b32 s67, 0x20000
    s_mov_b32 s68, s90
    s_and_b32 s69, s91, 0xffff
    s_mov_b32 s70, 2211840
    s_mov_b32 s71, 0x20000
    s_mov_b32 s72, s92
    s_and_b32 s73, s93, 0xffff
    s_mov_b32 s74, 2211840
    s_mov_b32 s75, 0x20000
    s_mov_b32 s76, s94
    s_and_b32 s77, s95, 0xffff
    s_mov_b32 s78, 2621440
    s_mov_b32 s79, 0x20000
    s_mov_b32 s80, s96
    s_and_b32 s81, s97, 0xffff
    s_mov_b32 s82, 2621440
    s_mov_b32 s83, 0x20000
    s_mov_b32 s86, 5242880
    s_mov_b32 s87, 0x20000
    s_bfe_u32 s3, s2, 0x10003
    s_lshr_b32 s48, s2, 4
    s_mul_i32 s60, s48, 5
    s_add_u32 s60, s60, s35
    s_sub_u32 s60, s60, 2
    s_add_u32 s48, s48, 80
    s_cmp_eq_u32 s35, 7
    s_cselect_b32 s60, s48, s60
    s_mov_b32 s48, 0
    s_cmp_eq_u32 s3, 0
    s_cbranch_scc1 wk_loop
    s_getpc_b64 s[44:45]
Lfj3:
    s_add_u32 s44, s44, wk_qkv-Lfj3
    s_addc_u32 s45, s45, 0
    s_setpc_b64 s[44:45]
wk_loop:
    s_add_u32 s48, s48, 1
    s_cmp_gt_u32 s48, 3
    s_cbranch_scc1 wk_rank
    s_cmp_ge_u32 s60, 40
    s_cbranch_scc1 wk_nm
    s_lshl_b32 s53, s60, 1
    s_add_u32 s53, s53, s48
    s_add_u32 s53, s53, 38
    s_cmp_eq_u32 s48, 1
    s_cselect_b32 s53, s60, s53
    s_getpc_b64 s[44:45]
Lfj4:
    s_add_u32 s44, s44, wk_mod-Lfj4
    s_addc_u32 s45, s45, 0
    s_setpc_b64 s[44:45]
wk_nm:
    s_mul_i32 s53, s48, 56
    s_add_u32 s53, s53, s60
    s_sub_u32 s53, s53, 96
    s_cmp_ge_u32 s53, 128
    s_cbranch_scc1 wk_rank
    s_getpc_b64 s[44:45]
Lfj5:
    s_add_u32 s44, s44, wk_ln1-Lfj5
    s_addc_u32 s45, s45, 0
    s_setpc_b64 s[44:45]
wk_rank:
    s_cmp_lg_u32 s29, 0
    s_cbranch_scc1 wk_ma_dw
    v_mov_b32 v2, 0
wk_ma_sp:
    buffer_load_dword v3, v2, s[8:11], 0 offen sc1
    s_waitcnt vmcnt(0)
    v_readfirstlane_b32 s37, v3
    s_nop 0
    s_cmp_ge_u32 s37, 1
    s_cbranch_scc1 wk_ma_dw
    s_sleep 4
    s_branch wk_ma_sp
wk_ma_dw:
    s_barrier
wk_pool:
    s_mul_i32 s49, s3, 16
    s_add_u32 s52, s49, s3
    s_cmp_ge_u32 s60, 11
    s_cbranch_scc1 wk_n11
    s_sub_u32 s53, s60, 0
    s_getpc_b64 s[44:45]
Lfj6:
    s_add_u32 s44, s44, wk_att-Lfj6
    s_addc_u32 s45, s45, 0
    s_setpc_b64 s[44:45]
wk_n11:
    s_cmp_ge_u32 s60, 51
    s_cbranch_scc1 wk_n51
    s_sub_u32 s53, s60, 11
    s_getpc_b64 s[44:45]
Lfj7:
    s_add_u32 s44, s44, wk_wo-Lfj7
    s_addc_u32 s45, s45, 0
    s_setpc_b64 s[44:45]
wk_n51:
    s_cmp_ge_u32 s60, 59
    s_cbranch_scc1 wk_n59
    s_sub_u32 s53, s60, 51
    s_getpc_b64 s[44:45]
Lfj8:
    s_add_u32 s44, s44, wk_ln2-Lfj8
    s_addc_u32 s45, s45, 0
    s_setpc_b64 s[44:45]
wk_n59:
    s_cmp_ge_u32 s60, 86
    s_cbranch_scc1 wk_n86
    s_sub_u32 s53, s60, 59
    s_getpc_b64 s[44:45]
Lfj9:
    s_add_u32 s44, s44, wk_up-Lfj9
    s_addc_u32 s45, s45, 0
    s_setpc_b64 s[44:45]
wk_n86:
    s_cmp_ge_u32 s60, 96
    s_cbranch_scc1 wk_n96
    s_sub_u32 s53, s60, 86
    s_getpc_b64 s[44:45]
Lfj10:
    s_add_u32 s44, s44, wk_dn-Lfj10
    s_addc_u32 s45, s45, 0
    s_setpc_b64 s[44:45]
wk_n96:
    s_endpgm
wk_qkv:
    s_mul_i32 s50, s60, 1366
    s_lshr_b32 s50, s50, 16
    s_mul_i32 s51, s50, 48
    s_sub_u32 s51, s60, s51
    s_and_b32 s53, s51, 15
    s_lshr_b32 s54, s51, 4
    s_cmp_eq_u32 s54, 0
    s_cselect_b32 s84, s16, s12
    s_cselect_b32 s85, s17, s13
    s_cmp_eq_u32 s54, 1
    s_cselect_b32 s84, s20, s84
    s_cselect_b32 s85, s21, s85
    v_lshrrev_b32 v6, 3, v1
    s_mov_b32 s43, 128
    v_mul_lo_u32 v6, v6, s43
    v_and_b32 v7, 7, v1
    v_lshrrev_b32 v8, 4, v1
    v_xor_b32 v9, v7, v8
    v_lshl_add_u32 v104, v9, 4, v6
    v_xor_b32 v9, 4, v9
    v_lshl_add_u32 v105, v9, 4, v6
    s_mov_b32 s43, 8192
    v_and_b32 v10, 1, v1
    v_lshlrev_b32 v10, 4, v10
    v_mul_lo_u32 v6, v8, s43
    v_add_u32 v6, v6, v10
    v_bfe_u32 v9, v1, 1, 3
    v_xor_b32 v9, v9, v8
    v_lshl_add_u32 v106, v9, 5, v6
    v_xor_b32 v9, 4, v9
    v_lshl_add_u32 v107, v9, 5, v6
    s_mov_b32 s43, 8192
    v_and_b32 v10, 1, v1
    v_lshlrev_b32 v10, 4, v10
    v_mul_lo_u32 v6, v8, s43
    v_add_u32 v6, v6, v10
    v_bfe_u32 v9, v1, 1, 3
    v_xor_b32 v9, v9, v8
    v_lshl_add_u32 v108, v9, 5, v6
    v_xor_b32 v9, 4, v9
    v_lshl_add_u32 v109, v9, 5, v6
    v_and_b32 v6, 15, v1
    v_lshrrev_b32 v7, 1, v6
    v_xor_b32 v7, v7, v8
    v_lshlrev_b32 v7, 4, v7
    v_lshl_add_u32 v7, v6, 7, v7
    s_lshr_b32 s43, s29, 2
    s_mul_i32 s43, s43, 4096
    s_add_u32 s43, s43, 0
    v_add_u32 v110, s43, v7
    v_xor_b32 v111, 64, v110
    v_bfe_u32 v6, v1, 2, 2
    v_lshl_add_u32 v6, v8, 2, v6
    v_and_b32 v7, 3, v1
    v_lshlrev_b32 v7, 3, v7
    s_and_b32 s43, s29, 3
    s_mul_i32 s43, s43, 2
    s_add_u32 s43, s43, 0
    v_and_b32 v9, 7, v6
    v_xor_b32 v9, s43, v9
    v_lshl_add_u32 v9, v9, 5, v7
    v_lshl_add_u32 v9, v6, 8, v9
    v_add_u32 v112, 4096, v9
    s_and_b32 s43, s29, 3
    s_mul_i32 s43, s43, 2
    s_add_u32 s43, s43, 1
    v_and_b32 v9, 7, v6
    v_xor_b32 v9, s43, v9
    v_lshl_add_u32 v9, v9, 5, v7
    v_lshl_add_u32 v9, v6, 8, v9
    v_add_u32 v113, 4096, v9
    s_and_b32 s43, s29, 3
    s_mul_i32 s43, s43, 2
    s_add_u32 s43, s43, 0
    v_and_b32 v9, 7, v6
    v_xor_b32 v9, s43, v9
    v_lshl_add_u32 v9, v9, 5, v7
    v_lshl_add_u32 v9, v6, 8, v9
    v_add_u32 v114, 20480, v9
    s_and_b32 s43, s29, 3
    s_mul_i32 s43, s43, 2
    s_add_u32 s43, s43, 1
    v_and_b32 v9, 7, v6
    v_xor_b32 v9, s43, v9
    v_lshl_add_u32 v9, v9, 5, v7
    v_lshl_add_u32 v9, v6, 8, v9
    v_add_u32 v115, 20480, v9
    s_mov_b32 s55, 0
    s_lshl_b32 s56, s53, 9
    s_add_u32 s57, s56, 256
    s_mul_i32 s43, s29, 1024
    s_add_u32 s40, s55, s43
    s_mul_i32 s45, s29, 1024
    s_mul_i32 s43, s29, 131072
    s_add_u32 s41, s56, s43
    s_mul_i32 s43, s29, 131072
    s_add_u32 s42, s57, s43
    s_mul_i32 s46, s29, 4096
    s_add_u32 m0, s46, 4096
    s_nop 0
    buffer_load_dwordx4 v106, s[84:87], s41 offen  lds
    s_add_u32 m0, s46, 5120
    s_add_u32 s43, s41, 32768
    buffer_load_dwordx4 v107, s[84:87], s43 offen  lds
    s_add_u32 m0, s46, 6144
    s_add_u32 s43, s41, 65536
    buffer_load_dwordx4 v106, s[84:87], s43 offen  lds
    s_add_u32 m0, s46, 7168
    s_add_u32 s43, s41, 98304
    buffer_load_dwordx4 v107, s[84:87], s43 offen  lds
    s_add_u32 s41, s41, 524288
    s_add_u32 m0, s46, 20480
    s_nop 0
    buffer_load_dwordx4 v108, s[84:87], s42 offen  lds
    s_add_u32 m0, s46, 21504
    s_add_u32 s43, s42, 32768
    buffer_load_dwordx4 v109, s[84:87], s43 offen  lds
    s_add_u32 m0, s46, 22528
    s_add_u32 s43, s42, 65536
    buffer_load_dwordx4 v108, s[84:87], s43 offen  lds
    s_add_u32 m0, s46, 23552
    s_add_u32 s43, s42, 98304
    buffer_load_dwordx4 v109, s[84:87], s43 offen  lds
    s_add_u32 s42, s42, 524288
    s_add_u32 m0, s46, 40960
    s_nop 0
    buffer_load_dwordx4 v106, s[84:87], s41 offen  lds
    s_add_u32 m0, s46, 41984
    s_add_u32 s43, s41, 32768
    buffer_load_dwordx4 v107, s[84:87], s43 offen  lds
    s_add_u32 m0, s46, 43008
    s_add_u32 s43, s41, 65536
    buffer_load_dwordx4 v106, s[84:87], s43 offen  lds
    s_add_u32 m0, s46, 44032
    s_add_u32 s43, s41, 98304
    buffer_load_dwordx4 v107, s[84:87], s43 offen  lds
    s_add_u32 s41, s41, 524288
    s_add_u32 m0, s46, 57344
    s_nop 0
    buffer_load_dwordx4 v108, s[84:87], s42 offen  lds
    s_add_u32 m0, s46, 58368
    s_add_u32 s43, s42, 32768
    buffer_load_dwordx4 v109, s[84:87], s43 offen  lds
    s_add_u32 m0, s46, 59392
    s_add_u32 s43, s42, 65536
    buffer_load_dwordx4 v108, s[84:87], s43 offen  lds
    s_add_u32 m0, s46, 60416
    s_add_u32 s43, s42, 98304
    buffer_load_dwordx4 v109, s[84:87], s43 offen  lds
    s_add_u32 s42, s42, 524288
    s_add_u32 m0, s46, 77824
    s_nop 0
    buffer_load_dwordx4 v106, s[84:87], s41 offen  lds
    s_add_u32 m0, s46, 78848
    s_add_u32 s43, s41, 32768
    buffer_load_dwordx4 v107, s[84:87], s43 offen  lds
    s_add_u32 m0, s46, 79872
    s_add_u32 s43, s41, 65536
    buffer_load_dwordx4 v106, s[84:87], s43 offen  lds
    s_add_u32 m0, s46, 80896
    s_add_u32 s43, s41, 98304
    buffer_load_dwordx4 v107, s[84:87], s43 offen  lds
    s_add_u32 s41, s41, 524288
    s_add_u32 m0, s46, 94208
    s_nop 0
    buffer_load_dwordx4 v108, s[84:87], s42 offen  lds
    s_add_u32 m0, s46, 95232
    s_add_u32 s43, s42, 32768
    buffer_load_dwordx4 v109, s[84:87], s43 offen  lds
    s_add_u32 m0, s46, 96256
    s_add_u32 s43, s42, 65536
    buffer_load_dwordx4 v108, s[84:87], s43 offen  lds
    s_add_u32 m0, s46, 97280
    s_add_u32 s43, s42, 98304
    buffer_load_dwordx4 v109, s[84:87], s43 offen  lds
    s_add_u32 s42, s42, 524288
    s_add_u32 m0, s46, 114688
    s_nop 0
    buffer_load_dwordx4 v106, s[84:87], s41 offen  lds
    s_add_u32 m0, s46, 115712
    s_add_u32 s43, s41, 32768
    buffer_load_dwordx4 v107, s[84:87], s43 offen  lds
    s_add_u32 m0, s46, 116736
    s_add_u32 s43, s41, 65536
    buffer_load_dwordx4 v106, s[84:87], s43 offen  lds
    s_add_u32 m0, s46, 117760
    s_add_u32 s43, s41, 98304
    buffer_load_dwordx4 v107, s[84:87], s43 offen  lds
    s_add_u32 s41, s41, 524288
    s_add_u32 m0, s46, 131072
    s_nop 0
    buffer_load_dwordx4 v108, s[84:87], s42 offen  lds
    s_add_u32 m0, s46, 132096
    s_add_u32 s43, s42, 32768
    buffer_load_dwordx4 v109, s[84:87], s43 offen  lds
    s_add_u32 m0, s46, 133120
    s_add_u32 s43, s42, 65536
    buffer_load_dwordx4 v108, s[84:87], s43 offen  lds
    s_add_u32 m0, s46, 134144
    s_add_u32 s43, s42, 98304
    buffer_load_dwordx4 v109, s[84:87], s43 offen  lds
    s_add_u32 s42, s42, 524288
    s_waitcnt vmcnt(24)
    s_barrier
    ds_read_b64_tr_b16 v[192:193], v112 offset:0
    ds_read_b64_tr_b16 v[194:195], v112 offset:4096
    ds_read_b64_tr_b16 v[196:197], v113 offset:0
    ds_read_b64_tr_b16 v[198:199], v113 offset:4096
    ds_read_b64_tr_b16 v[200:201], v114 offset:0
    ds_read_b64_tr_b16 v[202:203], v114 offset:4096
    ds_read_b64_tr_b16 v[204:205], v115 offset:0
    ds_read_b64_tr_b16 v[206:207], v115 offset:4096
    ds_read_b64_tr_b16 v[208:209], v112 offset:8192
    ds_read_b64_tr_b16 v[210:211], v112 offset:12288
    ds_read_b64_tr_b16 v[212:213], v113 offset:8192
    ds_read_b64_tr_b16 v[214:215], v113 offset:12288
    ds_read_b64_tr_b16 v[216:217], v114 offset:8192
    ds_read_b64_tr_b16 v[218:219], v114 offset:12288
    ds_read_b64_tr_b16 v[220:221], v115 offset:8192
    ds_read_b64_tr_b16 v[222:223], v115 offset:12288
    v_add_u32 v112, 36864, v112
    v_add_u32 v113, 36864, v113
    v_add_u32 v114, 36864, v114
    v_add_u32 v115, 36864, v115
    s_waitcnt lgkmcnt(0)
    s_waitcnt vmcnt(16)
    s_barrier
    s_add_u32 m0, s46, 4096
    s_nop 0
    buffer_load_dwordx4 v106, s[84:87], s41 offen  lds
    s_add_u32 m0, s46, 5120
    s_add_u32 s43, s41, 32768
    buffer_load_dwordx4 v107, s[84:87], s43 offen  lds
    s_add_u32 m0, s46, 6144
    s_add_u32 s43, s41, 65536
    buffer_load_dwordx4 v106, s[84:87], s43 offen  lds
    s_add_u32 m0, s46, 7168
    s_add_u32 s43, s41, 98304
    buffer_load_dwordx4 v107, s[84:87], s43 offen  lds
    s_add_u32 s41, s41, 524288
    s_add_u32 m0, s46, 20480
    s_nop 0
    buffer_load_dwordx4 v108, s[84:87], s42 offen  lds
    s_add_u32 m0, s46, 21504
    s_add_u32 s43, s42, 32768
    buffer_load_dwordx4 v109, s[84:87], s43 offen  lds
    s_add_u32 m0, s46, 22528
    s_add_u32 s43, s42, 65536
    buffer_load_dwordx4 v108, s[84:87], s43 offen  lds
    s_add_u32 m0, s46, 23552
    s_add_u32 s43, s42, 98304
    buffer_load_dwordx4 v109, s[84:87], s43 offen  lds
    s_add_u32 s42, s42, 524288
    ds_read_b64_tr_b16 v[224:225], v112 offset:0
    ds_read_b64_tr_b16 v[226:227], v112 offset:4096
    ds_read_b64_tr_b16 v[228:229], v113 offset:0
    ds_read_b64_tr_b16 v[230:231], v113 offset:4096
    ds_read_b64_tr_b16 v[232:233], v114 offset:0
    ds_read_b64_tr_b16 v[234:235], v114 offset:4096
    ds_read_b64_tr_b16 v[236:237], v115 offset:0
    ds_read_b64_tr_b16 v[238:239], v115 offset:4096
    ds_read_b64_tr_b16 v[240:241], v112 offset:8192
    ds_read_b64_tr_b16 v[242:243], v112 offset:12288
    ds_read_b64_tr_b16 v[244:245], v113 offset:8192
    ds_read_b64_tr_b16 v[246:247], v113 offset:12288
    ds_read_b64_tr_b16 v[248:249], v114 offset:8192
    ds_read_b64_tr_b16 v[250:251], v114 offset:12288
    ds_read_b64_tr_b16 v[252:253], v115 offset:8192
    ds_read_b64_tr_b16 v[254:255], v115 offset:12288
    v_add_u32 v112, 36864, v112
    v_add_u32 v113, 36864, v113
    v_add_u32 v114, 36864, v114
    v_add_u32 v115, 36864, v115
    s_waitcnt lgkmcnt(0)
    s_waitcnt vmcnt(16)
    s_barrier
    s_add_u32 m0, s46, 40960
    s_nop 0
    buffer_load_dwordx4 v106, s[84:87], s41 offen  lds
    s_add_u32 m0, s46, 41984
    s_add_u32 s43, s41, 32768
    buffer_load_dwordx4 v107, s[84:87], s43 offen  lds
    s_add_u32 m0, s46, 43008
    s_add_u32 s43, s41, 65536
    buffer_load_dwordx4 v106, s[84:87], s43 offen  lds
    s_add_u32 m0, s46, 44032
    s_add_u32 s43, s41, 98304
    buffer_load_dwordx4 v107, s[84:87], s43 offen  lds
    s_add_u32 s41, s41, 524288
    s_add_u32 m0, s46, 57344
    s_nop 0
    buffer_load_dwordx4 v108, s[84:87], s42 offen  lds
    s_add_u32 m0, s46, 58368
    s_add_u32 s43, s42, 32768
    buffer_load_dwordx4 v109, s[84:87], s43 offen  lds
    s_add_u32 m0, s46, 59392
    s_add_u32 s43, s42, 65536
    buffer_load_dwordx4 v108, s[84:87], s43 offen  lds
    s_add_u32 m0, s46, 60416
    s_add_u32 s43, s42, 98304
    buffer_load_dwordx4 v109, s[84:87], s43 offen  lds
    s_add_u32 s42, s42, 524288
    ds_read_b64_tr_b16 a[0:1], v112 offset:0
    ds_read_b64_tr_b16 a[2:3], v112 offset:4096
    ds_read_b64_tr_b16 a[4:5], v113 offset:0
    ds_read_b64_tr_b16 a[6:7], v113 offset:4096
    ds_read_b64_tr_b16 a[8:9], v114 offset:0
    ds_read_b64_tr_b16 a[10:11], v114 offset:4096
    ds_read_b64_tr_b16 a[12:13], v115 offset:0
    ds_read_b64_tr_b16 a[14:15], v115 offset:4096
    ds_read_b64_tr_b16 a[16:17], v112 offset:8192
    ds_read_b64_tr_b16 a[18:19], v112 offset:12288
    ds_read_b64_tr_b16 a[20:21], v113 offset:8192
    ds_read_b64_tr_b16 a[22:23], v113 offset:12288
    ds_read_b64_tr_b16 a[24:25], v114 offset:8192
    ds_read_b64_tr_b16 a[26:27], v114 offset:12288
    ds_read_b64_tr_b16 a[28:29], v115 offset:8192
    ds_read_b64_tr_b16 a[30:31], v115 offset:12288
    v_add_u32 v112, 36864, v112
    v_add_u32 v113, 36864, v113
    v_add_u32 v114, 36864, v114
    v_add_u32 v115, 36864, v115
    s_waitcnt lgkmcnt(0)
    s_waitcnt vmcnt(16)
    s_barrier
    s_add_u32 m0, s46, 77824
    s_nop 0
    buffer_load_dwordx4 v106, s[84:87], s41 offen  lds
    s_add_u32 m0, s46, 78848
    s_add_u32 s43, s41, 32768
    buffer_load_dwordx4 v107, s[84:87], s43 offen  lds
    s_add_u32 m0, s46, 79872
    s_add_u32 s43, s41, 65536
    buffer_load_dwordx4 v106, s[84:87], s43 offen  lds
    s_add_u32 m0, s46, 80896
    s_add_u32 s43, s41, 98304
    buffer_load_dwordx4 v107, s[84:87], s43 offen  lds
    s_add_u32 s41, s41, 524288
    s_add_u32 m0, s46, 94208
    s_nop 0
    buffer_load_dwordx4 v108, s[84:87], s42 offen  lds
    s_add_u32 m0, s46, 95232
    s_add_u32 s43, s42, 32768
    buffer_load_dwordx4 v109, s[84:87], s43 offen  lds
    s_add_u32 m0, s46, 96256
    s_add_u32 s43, s42, 65536
    buffer_load_dwordx4 v108, s[84:87], s43 offen  lds
    s_add_u32 m0, s46, 97280
    s_add_u32 s43, s42, 98304
    buffer_load_dwordx4 v109, s[84:87], s43 offen  lds
    s_add_u32 s42, s42, 524288
    ds_read_b64_tr_b16 a[32:33], v112 offset:0
    ds_read_b64_tr_b16 a[34:35], v112 offset:4096
    ds_read_b64_tr_b16 a[36:37], v113 offset:0
    ds_read_b64_tr_b16 a[38:39], v113 offset:4096
    ds_read_b64_tr_b16 a[40:41], v114 offset:0
    ds_read_b64_tr_b16 a[42:43], v114 offset:4096
    ds_read_b64_tr_b16 a[44:45], v115 offset:0
    ds_read_b64_tr_b16 a[46:47], v115 offset:4096
    ds_read_b64_tr_b16 a[48:49], v112 offset:8192
    ds_read_b64_tr_b16 a[50:51], v112 offset:12288
    ds_read_b64_tr_b16 a[52:53], v113 offset:8192
    ds_read_b64_tr_b16 a[54:55], v113 offset:12288
    ds_read_b64_tr_b16 a[56:57], v114 offset:8192
    ds_read_b64_tr_b16 a[58:59], v114 offset:12288
    ds_read_b64_tr_b16 a[60:61], v115 offset:8192
    ds_read_b64_tr_b16 a[62:63], v115 offset:12288
    v_subrev_u32 v112, 110592, v112
    v_subrev_u32 v113, 110592, v113
    v_subrev_u32 v114, 110592, v114
    v_subrev_u32 v115, 110592, v115
    s_waitcnt lgkmcnt(0)
    s_waitcnt vmcnt(16)
    s_barrier
    s_add_u32 m0, s46, 114688
    s_nop 0
    buffer_load_dwordx4 v106, s[84:87], s41 offen  lds
    s_add_u32 m0, s46, 115712
    s_add_u32 s43, s41, 32768
    buffer_load_dwordx4 v107, s[84:87], s43 offen  lds
    s_add_u32 m0, s46, 116736
    s_add_u32 s43, s41, 65536
    buffer_load_dwordx4 v106, s[84:87], s43 offen  lds
    s_add_u32 m0, s46, 117760
    s_add_u32 s43, s41, 98304
    buffer_load_dwordx4 v107, s[84:87], s43 offen  lds
    s_add_u32 s41, s41, 524288
    s_add_u32 m0, s46, 131072
    s_nop 0
    buffer_load_dwordx4 v108, s[84:87], s42 offen  lds
    s_add_u32 m0, s46, 132096
    s_add_u32 s43, s42, 32768
    buffer_load_dwordx4 v109, s[84:87], s43 offen  lds
    s_add_u32 m0, s46, 133120
    s_add_u32 s43, s42, 65536
    buffer_load_dwordx4 v108, s[84:87], s43 offen  lds
    s_add_u32 m0, s46, 134144
    s_add_u32 s43, s42, 98304
    buffer_load_dwordx4 v109, s[84:87], s43 offen  lds
    s_add_u32 s42, s42, 524288
    ds_read_b64_tr_b16 a[64:65], v112 offset:0
    ds_read_b64_tr_b16 a[66:67], v112 offset:4096
    ds_read_b64_tr_b16 a[68:69], v113 offset:0
    ds_read_b64_tr_b16 a[70:71], v113 offset:4096
    ds_read_b64_tr_b16 a[72:73], v114 offset:0
    ds_read_b64_tr_b16 a[74:75], v114 offset:4096
    ds_read_b64_tr_b16 a[76:77], v115 offset:0
    ds_read_b64_tr_b16 a[78:79], v115 offset:4096
    ds_read_b64_tr_b16 a[80:81], v112 offset:8192
    ds_read_b64_tr_b16 a[82:83], v112 offset:12288
    ds_read_b64_tr_b16 a[84:85], v113 offset:8192
    ds_read_b64_tr_b16 a[86:87], v113 offset:12288
    ds_read_b64_tr_b16 a[88:89], v114 offset:8192
    ds_read_b64_tr_b16 a[90:91], v114 offset:12288
    ds_read_b64_tr_b16 a[92:93], v115 offset:8192
    ds_read_b64_tr_b16 a[94:95], v115 offset:12288
    v_add_u32 v112, 36864, v112
    v_add_u32 v113, 36864, v113
    v_add_u32 v114, 36864, v114
    v_add_u32 v115, 36864, v115
    s_waitcnt lgkmcnt(0)
    s_waitcnt vmcnt(16)
    s_barrier
    s_add_u32 m0, s46, 4096
    s_nop 0
    buffer_load_dwordx4 v106, s[84:87], s41 offen  lds
    s_add_u32 m0, s46, 5120
    s_add_u32 s43, s41, 32768
    buffer_load_dwordx4 v107, s[84:87], s43 offen  lds
    s_add_u32 m0, s46, 6144
    s_add_u32 s43, s41, 65536
    buffer_load_dwordx4 v106, s[84:87], s43 offen  lds
    s_add_u32 m0, s46, 7168
    s_add_u32 s43, s41, 98304
    buffer_load_dwordx4 v107, s[84:87], s43 offen  lds
    s_add_u32 s41, s41, 524288
    s_add_u32 m0, s46, 20480
    s_nop 0
    buffer_load_dwordx4 v108, s[84:87], s42 offen  lds
    s_add_u32 m0, s46, 21504
    s_add_u32 s43, s42, 32768
    buffer_load_dwordx4 v109, s[84:87], s43 offen  lds
    s_add_u32 m0, s46, 22528
    s_add_u32 s43, s42, 65536
    buffer_load_dwordx4 v108, s[84:87], s43 offen  lds
    s_add_u32 m0, s46, 23552
    s_add_u32 s43, s42, 98304
    buffer_load_dwordx4 v109, s[84:87], s43 offen  lds
    s_add_u32 s42, s42, 524288
    ds_read_b64_tr_b16 a[96:97], v112 offset:0
    ds_read_b64_tr_b16 a[98:99], v112 offset:4096
    ds_read_b64_tr_b16 a[100:101], v113 offset:0
    ds_read_b64_tr_b16 a[102:103], v113 offset:4096
    ds_read_b64_tr_b16 a[104:105], v114 offset:0
    ds_read_b64_tr_b16 a[106:107], v114 offset:4096
    ds_read_b64_tr_b16 a[108:109], v115 offset:0
    ds_read_b64_tr_b16 a[110:111], v115 offset:4096
    ds_read_b64_tr_b16 a[112:113], v112 offset:8192
    ds_read_b64_tr_b16 a[114:115], v112 offset:12288
    ds_read_b64_tr_b16 a[116:117], v113 offset:8192
    ds_read_b64_tr_b16 a[118:119], v113 offset:12288
    ds_read_b64_tr_b16 a[120:121], v114 offset:8192
    ds_read_b64_tr_b16 a[122:123], v114 offset:12288
    ds_read_b64_tr_b16 a[124:125], v115 offset:8192
    ds_read_b64_tr_b16 a[126:127], v115 offset:12288
    v_add_u32 v112, 36864, v112
    v_add_u32 v113, 36864, v113
    v_add_u32 v114, 36864, v114
    v_add_u32 v115, 36864, v115
    s_waitcnt lgkmcnt(0)
    s_waitcnt vmcnt(16)
    s_barrier
    s_add_u32 m0, s46, 40960
    s_nop 0
    buffer_load_dwordx4 v106, s[84:87], s41 offen  lds
    s_add_u32 m0, s46, 41984
    s_add_u32 s43, s41, 32768
    buffer_load_dwordx4 v107, s[84:87], s43 offen  lds
    s_add_u32 m0, s46, 43008
    s_add_u32 s43, s41, 65536
    buffer_load_dwordx4 v106, s[84:87], s43 offen  lds
    s_add_u32 m0, s46, 44032
    s_add_u32 s43, s41, 98304
    buffer_load_dwordx4 v107, s[84:87], s43 offen  lds
    s_add_u32 s41, s41, 524288
    s_add_u32 m0, s46, 57344
    s_nop 0
    buffer_load_dwordx4 v108, s[84:87], s42 offen  lds
    s_add_u32 m0, s46, 58368
    s_add_u32 s43, s42, 32768
    buffer_load_dwordx4 v109, s[84:87], s43 offen  lds
    s_add_u32 m0, s46, 59392
    s_add_u32 s43, s42, 65536
    buffer_load_dwordx4 v108, s[84:87], s43 offen  lds
    s_add_u32 m0, s46, 60416
    s_add_u32 s43, s42, 98304
    buffer_load_dwordx4 v109, s[84:87], s43 offen  lds
    s_add_u32 s42, s42, 524288
    ds_read_b64_tr_b16 a[128:129], v112 offset:0
    ds_read_b64_tr_b16 a[130:131], v112 offset:4096
    ds_read_b64_tr_b16 a[132:133], v113 offset:0
    ds_read_b64_tr_b16 a[134:135], v113 offset:4096
    ds_read_b64_tr_b16 a[136:137], v114 offset:0
    ds_read_b64_tr_b16 a[138:139], v114 offset:4096
    ds_read_b64_tr_b16 a[140:141], v115 offset:0
    ds_read_b64_tr_b16 a[142:143], v115 offset:4096
    ds_read_b64_tr_b16 a[144:145], v112 offset:8192
    ds_read_b64_tr_b16 a[146:147], v112 offset:12288
    ds_read_b64_tr_b16 a[148:149], v113 offset:8192
    ds_read_b64_tr_b16 a[150:151], v113 offset:12288
    ds_read_b64_tr_b16 a[152:153], v114 offset:8192
    ds_read_b64_tr_b16 a[154:155], v114 offset:12288
    ds_read_b64_tr_b16 a[156:157], v115 offset:8192
    ds_read_b64_tr_b16 a[158:159], v115 offset:12288
    v_add_u32 v112, 36864, v112
    v_add_u32 v113, 36864, v113
    v_add_u32 v114, 36864, v114
    v_add_u32 v115, 36864, v115
    s_waitcnt lgkmcnt(0)
    s_waitcnt vmcnt(16)
    s_barrier
    ds_read_b64_tr_b16 a[160:161], v112 offset:0
    ds_read_b64_tr_b16 a[162:163], v112 offset:4096
    ds_read_b64_tr_b16 a[164:165], v113 offset:0
    ds_read_b64_tr_b16 a[166:167], v113 offset:4096
    ds_read_b64_tr_b16 a[168:169], v114 offset:0
    ds_read_b64_tr_b16 a[170:171], v114 offset:4096
    ds_read_b64_tr_b16 a[172:173], v115 offset:0
    ds_read_b64_tr_b16 a[174:175], v115 offset:4096
    ds_read_b64_tr_b16 a[176:177], v112 offset:8192
    ds_read_b64_tr_b16 a[178:179], v112 offset:12288
    ds_read_b64_tr_b16 a[180:181], v113 offset:8192
    ds_read_b64_tr_b16 a[182:183], v113 offset:12288
    ds_read_b64_tr_b16 a[184:185], v114 offset:8192
    ds_read_b64_tr_b16 a[186:187], v114 offset:12288
    ds_read_b64_tr_b16 a[188:189], v115 offset:8192
    ds_read_b64_tr_b16 a[190:191], v115 offset:12288
    v_subrev_u32 v112, 110592, v112
    v_subrev_u32 v113, 110592, v113
    v_subrev_u32 v114, 110592, v114
    v_subrev_u32 v115, 110592, v115
    s_waitcnt lgkmcnt(0)
    s_waitcnt vmcnt(8)
    s_barrier
    ds_read_b64_tr_b16 a[192:193], v112 offset:0
    ds_read_b64_tr_b16 a[194:195], v112 offset:4096
    ds_read_b64_tr_b16 a[196:197], v113 offset:0
    ds_read_b64_tr_b16 a[198:199], v113 offset:4096
    ds_read_b64_tr_b16 a[200:201], v114 offset:0
    ds_read_b64_tr_b16 a[202:203], v114 offset:4096
    ds_read_b64_tr_b16 a[204:205], v115 offset:0
    ds_read_b64_tr_b16 a[206:207], v115 offset:4096
    ds_read_b64_tr_b16 a[208:209], v112 offset:8192
    ds_read_b64_tr_b16 a[210:211], v112 offset:12288
    ds_read_b64_tr_b16 a[212:213], v113 offset:8192
    ds_read_b64_tr_b16 a[214:215], v113 offset:12288
    ds_read_b64_tr_b16 a[216:217], v114 offset:8192
    ds_read_b64_tr_b16 a[218:219], v114 offset:12288
    ds_read_b64_tr_b16 a[220:221], v115 offset:8192
    ds_read_b64_tr_b16 a[222:223], v115 offset:12288
    v_add_u32 v112, 36864, v112
    v_add_u32 v113, 36864, v113
    v_add_u32 v114, 36864, v114
    v_add_u32 v115, 36864, v115
    s_waitcnt lgkmcnt(0)
    s_waitcnt vmcnt(0)
    s_barrier
    ds_read_b64_tr_b16 a[224:225], v112 offset:0
    ds_read_b64_tr_b16 a[226:227], v112 offset:4096
    ds_read_b64_tr_b16 a[228:229], v113 offset:0
    ds_read_b64_tr_b16 a[230:231], v113 offset:4096
    ds_read_b64_tr_b16 a[232:233], v114 offset:0
    ds_read_b64_tr_b16 a[234:235], v114 offset:4096
    ds_read_b64_tr_b16 a[236:237], v115 offset:0
    ds_read_b64_tr_b16 a[238:239], v115 offset:4096
    ds_read_b64_tr_b16 a[240:241], v112 offset:8192
    ds_read_b64_tr_b16 a[242:243], v112 offset:12288
    ds_read_b64_tr_b16 a[244:245], v113 offset:8192
    ds_read_b64_tr_b16 a[246:247], v113 offset:12288
    ds_read_b64_tr_b16 a[248:249], v114 offset:8192
    ds_read_b64_tr_b16 a[250:251], v114 offset:12288
    ds_read_b64_tr_b16 a[252:253], v115 offset:8192
    ds_read_b64_tr_b16 a[254:255], v115 offset:12288
    v_add_u32 v112, 36864, v112
    v_add_u32 v113, 36864, v113
    v_add_u32 v114, 36864, v114
    v_add_u32 v115, 36864, v115
    s_waitcnt lgkmcnt(0)
    s_cmp_lg_u32 s29, 0
    s_cbranch_scc1 wk_qkv_a_dw
    v_mov_b32 v2, 0
wk_qkv_a_sp:
    buffer_load_dword v3, v2, s[8:11], 0 offen sc1
    s_waitcnt vmcnt(0)
    v_readfirstlane_b32 s37, v3
    s_nop 0
    s_cmp_ge_u32 s37, 1
    s_cbranch_scc1 wk_qkv_a_dw
    s_sleep 4
    s_branch wk_qkv_a_sp
wk_qkv_a_dw:
    s_barrier
    s_mul_i32 s55, s50, 40960
    s_add_u32 s55, s55, 58720256
    s_mov_b32 s56, 0
    s_lshl_b32 s33, s50, 5
    s_lshl_b32 s34, s53, 1
    s_add_u32 s33, s33, s34
    s_lshl_b32 s33, s33, 13
    s_mov_b32 s34, 92274688
    s_mov_b32 s35, 311296
    s_cmp_lg_u32 s54, 2
    s_cselect_b32 s34, 16777216, s34
    s_cselect_b32 s35, 303104, s35
    s_cmp_eq_u32 s54, 1
    s_cselect_b32 s34, 33554432, s34
    s_add_u32 s33, s33, s34
    s_lshl_b32 s31, s29, 11
    s_add_u32 s33, s33, s31
    v_and_b32 v2, 15, v1
    v_lshrrev_b32 v3, 4, v1
    v_lshlrev_b32 v3, 4, v3
    v_lshl_add_u32 v4, v2, 6, v3
    v_lshlrev_b32 v5, 4, v1
    v_lshlrev_b32 v6, 7, v2
    v_mov_b32 v7, -1
    v_lshlrev_b32 v8, 8, v1
    s_lshl_b32 s37, s50, 7
    s_add_u32 s35, s35, s37
    s_mov_b32 s51, 0
    s_mov_b32 s34, 0
    s_cmp_lg_u32 s29, 0
    s_cselect_b32 s35, 0x40000000, s35
    s_mov_b32 s58, 0
    s_mov_b32 s59, 0
    s_lshr_b32 s57, s58, 1
    s_min_u32 s57, s57, 15
    s_add_u32 s58, s58, 1
    s_cmp_lt_u32 s57, s59
    s_cbranch_scc1 wk_qkv_w0_ok
    s_mov_b32 s39, 49280
wk_qkv_w0:
    buffer_load_dword v3, v6, s[4:7], s39 offen sc1
    s_waitcnt vmcnt(0)
    v_cmp_le_u32 vcc, 8, v3
    s_nop 0
    s_and_b32 s59, vcc_lo, 0xffff
    s_ff0_i32_b32 s59, s59
    s_cmp_lt_u32 s57, s59
    s_cbranch_scc1 wk_qkv_w0_ok
    s_sleep 2
    s_branch wk_qkv_w0
wk_qkv_w0_ok:
    s_mul_i32 s57, s29, 4096
    s_add_u32 m0, s57, s56
    s_add_u32 s57, s57, s55
    buffer_load_dwordx4 v104, s[4:7], s57 offen offset:0 sc1 lds
    buffer_load_dwordx4 v105, s[4:7], s57 offen offset:1024 sc1 lds
    buffer_load_dwordx4 v104, s[4:7], s57 offen offset:2048 sc1 lds
    buffer_load_dwordx4 v105, s[4:7], s57 offen offset:3072 sc1 lds
    s_mul_i32 s57, s29, 4096
    s_add_u32 s57, s57, 16384
    s_add_u32 m0, s57, s56
    s_add_u32 s57, s57, s55
    buffer_load_dwordx4 v104, s[4:7], s57 offen offset:0 sc1 lds
    buffer_load_dwordx4 v105, s[4:7], s57 offen offset:1024 sc1 lds
    buffer_load_dwordx4 v104, s[4:7], s57 offen offset:2048 sc1 lds
    buffer_load_dwordx4 v105, s[4:7], s57 offen offset:3072 sc1 lds
    s_mul_i32 s57, s29, 2048
    s_add_u32 s57, s57, 32768
    s_add_u32 m0, s57, s56
    s_add_u32 s57, s57, s55
    buffer_load_dwordx4 v104, s[4:7], s57 offen offset:0 sc1 lds
    buffer_load_dwordx4 v105, s[4:7], s57 offen offset:1024 sc1 lds
    s_add_u32 s57, s55, 81920
    s_cmp_lt_u32 s57, 61341696
    s_cselect_b32 s55, s57, s55
    s_add_u32 s56, s56, 40960
    s_cmp_lt_u32 s56, 163840
    s_cselect_b32 s56, s56, 0
    s_lshr_b32 s57, s58, 1
    s_min_u32 s57, s57, 15
    s_add_u32 s58, s58, 1
    s_cmp_lt_u32 s57, s59
    s_cbranch_scc1 wk_qkv_w1_ok
    s_mov_b32 s39, 49280
wk_qkv_w1:
    buffer_load_dword v3, v6, s[4:7], s39 offen sc1
    s_waitcnt vmcnt(0)
    v_cmp_le_u32 vcc, 8, v3
    s_nop 0
    s_and_b32 s59, vcc_lo, 0xffff
    s_ff0_i32_b32 s59, s59
    s_cmp_lt_u32 s57, s59
    s_cbranch_scc1 wk_qkv_w1_ok
    s_sleep 2
    s_branch wk_qkv_w1
wk_qkv_w1_ok:
    s_mul_i32 s57, s29, 4096
    s_add_u32 m0, s57, s56
    s_add_u32 s57, s57, s55
    buffer_load_dwordx4 v104, s[4:7], s57 offen offset:0 sc1 lds
    buffer_load_dwordx4 v105, s[4:7], s57 offen offset:1024 sc1 lds
    buffer_load_dwordx4 v104, s[4:7], s57 offen offset:2048 sc1 lds
    buffer_load_dwordx4 v105, s[4:7], s57 offen offset:3072 sc1 lds
    s_mul_i32 s57, s29, 4096
    s_add_u32 s57, s57, 16384
    s_add_u32 m0, s57, s56
    s_add_u32 s57, s57, s55
    buffer_load_dwordx4 v104, s[4:7], s57 offen offset:0 sc1 lds
    buffer_load_dwordx4 v105, s[4:7], s57 offen offset:1024 sc1 lds
    buffer_load_dwordx4 v104, s[4:7], s57 offen offset:2048 sc1 lds
    buffer_load_dwordx4 v105, s[4:7], s57 offen offset:3072 sc1 lds
    s_mul_i32 s57, s29, 2048
    s_add_u32 s57, s57, 32768
    s_add_u32 m0, s57, s56
    s_add_u32 s57, s57, s55
    buffer_load_dwordx4 v104, s[4:7], s57 offen offset:0 sc1 lds
    buffer_load_dwordx4 v105, s[4:7], s57 offen offset:1024 sc1 lds
    s_add_u32 s57, s55, 81920
    s_cmp_lt_u32 s57, 61341696
    s_cselect_b32 s55, s57, s55
    s_add_u32 s56, s56, 40960
    s_cmp_lt_u32 s56, 163840
    s_cselect_b32 s56, s56, 0
    s_mov_b32 s32, s33
    s_mov_b32 s33, 0x40000000
    s_cmp_lg_u32 s54, 1
    s_cbranch_scc1 wk_qkv_T
    s_getpc_b64 s[98:99]
Lfj11:
    s_add_u32 s98, s98, wk_qkv_N-Lfj11
    s_addc_u32 s99, s99, 0
    s_setpc_b64 s[98:99]
wk_qkv_T:
    s_waitcnt vmcnt(10)
    s_barrier
    ds_read_b128 v[48:51], v110 offset:0
    ds_read_b128 v[52:55], v110 offset:2048
    ds_read_b128 v[56:59], v111 offset:0
    ds_read_b128 v[60:63], v111 offset:2048
    ds_read_b128 v[64:67], v110 offset:4096
    ds_read_b128 v[68:71], v110 offset:6144
    s_sub_u32 s36, s51, 1
    s_max_i32 s36, s36, s34
    s_sub_u32 s37, s36, s34
    s_bfm_b64 exec, s37, s34
    s_cmp_eq_u32 s37, 0
    s_cselect_b32 s38, 0x40000000, s35
    s_cselect_b64 exec, 1, exec
    s_mov_b32 s34, s36
    buffer_atomic_sub v7, v8, s[4:7], s38 offen
    s_mov_b64 exec, -1
    s_nop 3
    v_cvt_pk_bf16_f32 v80, v16, v17
    v_cvt_pk_bf16_f32 v81, v18, v19
    v_cvt_pk_bf16_f32 v82, v20, v21
    v_cvt_pk_bf16_f32 v83, v22, v23
    v_cvt_pk_bf16_f32 v84, v32, v33
    v_cvt_pk_bf16_f32 v85, v34, v35
    v_cvt_pk_bf16_f32 v86, v36, v37
    v_cvt_pk_bf16_f32 v87, v38, v39
    v_cvt_pk_bf16_f32 v88, v24, v25
    v_cvt_pk_bf16_f32 v89, v26, v27
    v_cvt_pk_bf16_f32 v90, v28, v29
    v_cvt_pk_bf16_f32 v91, v30, v31
    v_cvt_pk_bf16_f32 v92, v40, v41
    v_cvt_pk_bf16_f32 v93, v42, v43
    v_cvt_pk_bf16_f32 v94, v44, v45
    v_cvt_pk_bf16_f32 v95, v46, v47
    s_lshr_b32 s57, s58, 1
    s_min_u32 s57, s57, 15
    s_add_u32 s58, s58, 1
    s_cmp_lt_u32 s57, s59
    s_cbranch_scc1 wk_qkv_T_x_ok
    s_mov_b32 s39, 49280
wk_qkv_T_x:
    buffer_load_dword v3, v6, s[4:7], s39 offen sc1
    s_waitcnt vmcnt(0)
    v_cmp_le_u32 vcc, 8, v3
    s_nop 0
    s_and_b32 s59, vcc_lo, 0xffff
    s_ff0_i32_b32 s59, s59
    s_cmp_lt_u32 s57, s59
    s_cbranch_scc1 wk_qkv_T_x_ok
    s_sleep 2
    s_branch wk_qkv_T_x
wk_qkv_T_x_ok:
    s_add_u32 s36, s33, 8192
    buffer_store_dwordx4 v[80:83], v4, s[4:7], s33 offen offset:0 sc1
    buffer_store_dwordx4 v[84:87], v4, s[4:7], s33 offen offset:1024 sc1
    buffer_store_dwordx4 v[88:91], v4, s[4:7], s36 offen offset:0 sc1
    buffer_store_dwordx4 v[92:95], v4, s[4:7], s36 offen offset:1024 sc1
    s_mov_b32 s33, s32
    s_add_u32 s32, s32, 524288
    s_cmp_lg_u32 s51, 1
    s_cbranch_scc1 wk_qkv_T_nd
    s_waitcnt vmcnt(0)
    s_barrier
    s_sub_u32 s37, s51, s34
    s_bfm_b64 exec, s37, s34
    s_cmp_eq_u32 s37, 0
    s_cselect_b32 s38, 0x40000000, s35
    s_cselect_b64 exec, 1, exec
    s_mov_b32 s34, s51
    buffer_atomic_sub v7, v8, s[4:7], s38 offen
    s_mov_b64 exec, -1
wk_qkv_T_nd:
    ds_read_b128 v[72:75], v111 offset:4096
    ds_read_b128 v[76:79], v111 offset:6144
    s_waitcnt lgkmcnt(6)
    v_mfma_f32_16x16x32_bf16 v[16:19], v[192:195], v[48:51], 0
    v_mfma_f32_16x16x32_bf16 v[20:23], v[196:199], v[48:51], 0
    s_mul_i32 s57, s29, 4096
    v_mfma_f32_16x16x32_bf16 v[24:27], v[200:203], v[48:51], 0
    v_mfma_f32_16x16x32_bf16 v[28:31], v[204:207], v[48:51], 0
    s_add_u32 m0, s57, s56
    v_mfma_f32_16x16x32_bf16 v[32:35], v[192:195], v[52:55], 0
    v_mfma_f32_16x16x32_bf16 v[36:39], v[196:199], v[52:55], 0
    s_add_u32 s57, s57, s55
    v_mfma_f32_16x16x32_bf16 v[40:43], v[200:203], v[52:55], 0
    v_mfma_f32_16x16x32_bf16 v[44:47], v[204:207], v[52:55], 0
    buffer_load_dwordx4 v104, s[4:7], s57 offen offset:0 sc1 lds
    ds_read_b128 v[48:51], v110 offset:8192
    ds_read_b128 v[52:55], v110 offset:10240
    s_waitcnt lgkmcnt(6)
    v_mfma_f32_16x16x32_bf16 v[16:19], v[208:211], v[56:59], v[16:19]
    v_mfma_f32_16x16x32_bf16 v[20:23], v[212:215], v[56:59], v[20:23]
    buffer_load_dwordx4 v105, s[4:7], s57 offen offset:1024 sc1 lds
    v_mfma_f32_16x16x32_bf16 v[24:27], v[216:219], v[56:59], v[24:27]
    v_mfma_f32_16x16x32_bf16 v[28:31], v[220:223], v[56:59], v[28:31]
    buffer_load_dwordx4 v104, s[4:7], s57 offen offset:2048 sc1 lds
    v_mfma_f32_16x16x32_bf16 v[32:35], v[208:211], v[60:63], v[32:35]
    v_mfma_f32_16x16x32_bf16 v[36:39], v[212:215], v[60:63], v[36:39]
    buffer_load_dwordx4 v105, s[4:7], s57 offen offset:3072 sc1 lds
    v_mfma_f32_16x16x32_bf16 v[40:43], v[216:219], v[60:63], v[40:43]
    v_mfma_f32_16x16x32_bf16 v[44:47], v[220:223], v[60:63], v[44:47]
    s_mul_i32 s57, s29, 4096
    ds_read_b128 v[56:59], v111 offset:8192
    ds_read_b128 v[60:63], v111 offset:10240
    s_waitcnt lgkmcnt(6)
    v_mfma_f32_16x16x32_bf16 v[16:19], v[224:227], v[64:67], v[16:19]
    v_mfma_f32_16x16x32_bf16 v[20:23], v[228:231], v[64:67], v[20:23]
    s_add_u32 s57, s57, 16384
    v_mfma_f32_16x16x32_bf16 v[24:27], v[232:235], v[64:67], v[24:27]
    v_mfma_f32_16x16x32_bf16 v[28:31], v[236:239], v[64:67], v[28:31]
    s_add_u32 m0, s57, s56
    v_mfma_f32_16x16x32_bf16 v[32:35], v[224:227], v[68:71], v[32:35]
    v_mfma_f32_16x16x32_bf16 v[36:39], v[228:231], v[68:71], v[36:39]
    s_add_u32 s57, s57, s55
    v_mfma_f32_16x16x32_bf16 v[40:43], v[232:235], v[68:71], v[40:43]
    v_mfma_f32_16x16x32_bf16 v[44:47], v[236:239], v[68:71], v[44:47]
    buffer_load_dwordx4 v104, s[4:7], s57 offen offset:0 sc1 lds
    ds_read_b128 v[64:67], v110 offset:12288
    ds_read_b128 v[68:71], v110 offset:14336
    s_waitcnt lgkmcnt(6)
    v_mfma_f32_16x16x32_bf16 v[16:19], v[240:243], v[72:75], v[16:19]
    v_mfma_f32_16x16x32_bf16 v[20:23], v[244:247], v[72:75], v[20:23]
    buffer_load_dwordx4 v105, s[4:7], s57 offen offset:1024 sc1 lds
    v_mfma_f32_16x16x32_bf16 v[24:27], v[248:251], v[72:75], v[24:27]
    v_mfma_f32_16x16x32_bf16 v[28:31], v[252:255], v[72:75], v[28:31]
    buffer_load_dwordx4 v104, s[4:7], s57 offen offset:2048 sc1 lds
    v_mfma_f32_16x16x32_bf16 v[32:35], v[240:243], v[76:79], v[32:35]
    v_mfma_f32_16x16x32_bf16 v[36:39], v[244:247], v[76:79], v[36:39]
    buffer_load_dwordx4 v105, s[4:7], s57 offen offset:3072 sc1 lds
    v_mfma_f32_16x16x32_bf16 v[40:43], v[248:251], v[76:79], v[40:43]
    v_mfma_f32_16x16x32_bf16 v[44:47], v[252:255], v[76:79], v[44:47]
    s_mul_i32 s57, s29, 2048
    ds_read_b128 v[72:75], v111 offset:12288
    ds_read_b128 v[76:79], v111 offset:14336
    s_waitcnt lgkmcnt(6)
    v_mfma_f32_16x16x32_bf16 v[16:19], a[0:3], v[48:51], v[16:19]
    v_mfma_f32_16x16x32_bf16 v[20:23], a[4:7], v[48:51], v[20:23]
    s_add_u32 s57, s57, 32768
    v_mfma_f32_16x16x32_bf16 v[24:27], a[8:11], v[48:51], v[24:27]
    v_mfma_f32_16x16x32_bf16 v[28:31], a[12:15], v[48:51], v[28:31]
    s_add_u32 m0, s57, s56
    v_mfma_f32_16x16x32_bf16 v[32:35], a[0:3], v[52:55], v[32:35]
    v_mfma_f32_16x16x32_bf16 v[36:39], a[4:7], v[52:55], v[36:39]
    s_add_u32 s57, s57, s55
    v_mfma_f32_16x16x32_bf16 v[40:43], a[8:11], v[52:55], v[40:43]
    v_mfma_f32_16x16x32_bf16 v[44:47], a[12:15], v[52:55], v[44:47]
    buffer_load_dwordx4 v104, s[4:7], s57 offen offset:0 sc1 lds
    ds_read_b128 v[48:51], v110 offset:16384
    ds_read_b128 v[52:55], v110 offset:18432
    s_waitcnt lgkmcnt(6)
    v_mfma_f32_16x16x32_bf16 v[16:19], a[16:19], v[56:59], v[16:19]
    v_mfma_f32_16x16x32_bf16 v[20:23], a[20:23], v[56:59], v[20:23]
    buffer_load_dwordx4 v105, s[4:7], s57 offen offset:1024 sc1 lds
    v_mfma_f32_16x16x32_bf16 v[24:27], a[24:27], v[56:59], v[24:27]
    v_mfma_f32_16x16x32_bf16 v[28:31], a[28:31], v[56:59], v[28:31]
    s_add_u32 s57, s55, 81920
    v_mfma_f32_16x16x32_bf16 v[32:35], a[16:19], v[60:63], v[32:35]
    v_mfma_f32_16x16x32_bf16 v[36:39], a[20:23], v[60:63], v[36:39]
    s_cmp_lt_u32 s57, 61341696
    v_mfma_f32_16x16x32_bf16 v[40:43], a[24:27], v[60:63], v[40:43]
    v_mfma_f32_16x16x32_bf16 v[44:47], a[28:31], v[60:63], v[44:47]
    s_cselect_b32 s55, s57, s55
    ds_read_b128 v[56:59], v111 offset:16384
    ds_read_b128 v[60:63], v111 offset:18432
    s_waitcnt lgkmcnt(6)
    v_mfma_f32_16x16x32_bf16 v[16:19], a[32:35], v[64:67], v[16:19]
    v_mfma_f32_16x16x32_bf16 v[20:23], a[36:39], v[64:67], v[20:23]
    s_add_u32 s56, s56, 40960
    v_mfma_f32_16x16x32_bf16 v[24:27], a[40:43], v[64:67], v[24:27]
    v_mfma_f32_16x16x32_bf16 v[28:31], a[44:47], v[64:67], v[28:31]
    s_cmp_lt_u32 s56, 163840
    v_mfma_f32_16x16x32_bf16 v[32:35], a[32:35], v[68:71], v[32:35]
    v_mfma_f32_16x16x32_bf16 v[36:39], a[36:39], v[68:71], v[36:39]
    s_cselect_b32 s56, s56, 0
    v_mfma_f32_16x16x32_bf16 v[40:43], a[40:43], v[68:71], v[40:43]
    v_mfma_f32_16x16x32_bf16 v[44:47], a[44:47], v[68:71], v[44:47]
    ds_read_b128 v[64:67], v110 offset:20480
    ds_read_b128 v[68:71], v110 offset:22528
    s_waitcnt lgkmcnt(6)
    v_mfma_f32_16x16x32_bf16 v[16:19], a[48:51], v[72:75], v[16:19]
    v_mfma_f32_16x16x32_bf16 v[20:23], a[52:55], v[72:75], v[20:23]
    v_mfma_f32_16x16x32_bf16 v[24:27], a[56:59], v[72:75], v[24:27]
    v_mfma_f32_16x16x32_bf16 v[28:31], a[60:63], v[72:75], v[28:31]
    v_mfma_f32_16x16x32_bf16 v[32:35], a[48:51], v[76:79], v[32:35]
    v_mfma_f32_16x16x32_bf16 v[36:39], a[52:55], v[76:79], v[36:39]
    v_mfma_f32_16x16x32_bf16 v[40:43], a[56:59], v[76:79], v[40:43]
    v_mfma_f32_16x16x32_bf16 v[44:47], a[60:63], v[76:79], v[44:47]
    ds_read_b128 v[72:75], v111 offset:20480
    ds_read_b128 v[76:79], v111 offset:22528
    s_waitcnt lgkmcnt(6)
    v_mfma_f32_16x16x32_bf16 v[16:19], a[64:67], v[48:51], v[16:19]
    v_mfma_f32_16x16x32_bf16 v[20:23], a[68:71], v[48:51], v[20:23]
    v_mfma_f32_16x16x32_bf16 v[24:27], a[72:75], v[48:51], v[24:27]
    v_mfma_f32_16x16x32_bf16 v[28:31], a[76:79], v[48:51], v[28:31]
    v_mfma_f32_16x16x32_bf16 v[32:35], a[64:67], v[52:55], v[32:35]
    v_mfma_f32_16x16x32_bf16 v[36:39], a[68:71], v[52:55], v[36:39]
    v_mfma_f32_16x16x32_bf16 v[40:43], a[72:75], v[52:55], v[40:43]
    v_mfma_f32_16x16x32_bf16 v[44:47], a[76:79], v[52:55], v[44:47]
    ds_read_b128 v[48:51], v110 offset:24576
    ds_read_b128 v[52:55], v110 offset:26624
    s_waitcnt lgkmcnt(6)
    v_mfma_f32_16x16x32_bf16 v[16:19], a[80:83], v[56:59], v[16:19]
    v_mfma_f32_16x16x32_bf16 v[20:23], a[84:87], v[56:59], v[20:23]
    v_mfma_f32_16x16x32_bf16 v[24:27], a[88:91], v[56:59], v[24:27]
    v_mfma_f32_16x16x32_bf16 v[28:31], a[92:95], v[56:59], v[28:31]
    v_mfma_f32_16x16x32_bf16 v[32:35], a[80:83], v[60:63], v[32:35]
    v_mfma_f32_16x16x32_bf16 v[36:39], a[84:87], v[60:63], v[36:39]
    v_mfma_f32_16x16x32_bf16 v[40:43], a[88:91], v[60:63], v[40:43]
    v_mfma_f32_16x16x32_bf16 v[44:47], a[92:95], v[60:63], v[44:47]
    ds_read_b128 v[56:59], v111 offset:24576
    ds_read_b128 v[60:63], v111 offset:26624
    s_waitcnt lgkmcnt(6)
    v_mfma_f32_16x16x32_bf16 v[16:19], a[96:99], v[64:67], v[16:19]
    v_mfma_f32_16x16x32_bf16 v[20:23], a[100:103], v[64:67], v[20:23]
    v_mfma_f32_16x16x32_bf16 v[24:27], a[104:107], v[64:67], v[24:27]
    v_mfma_f32_16x16x32_bf16 v[28:31], a[108:111], v[64:67], v[28:31]
    v_mfma_f32_16x16x32_bf16 v[32:35], a[96:99], v[68:71], v[32:35]
    v_mfma_f32_16x16x32_bf16 v[36:39], a[100:103], v[68:71], v[36:39]
    v_mfma_f32_16x16x32_bf16 v[40:43], a[104:107], v[68:71], v[40:43]
    v_mfma_f32_16x16x32_bf16 v[44:47], a[108:111], v[68:71], v[44:47]
    ds_read_b128 v[64:67], v110 offset:28672
    ds_read_b128 v[68:71], v110 offset:30720
    s_waitcnt lgkmcnt(6)
    v_mfma_f32_16x16x32_bf16 v[16:19], a[112:115], v[72:75], v[16:19]
    v_mfma_f32_16x16x32_bf16 v[20:23], a[116:119], v[72:75], v[20:23]
    v_mfma_f32_16x16x32_bf16 v[24:27], a[120:123], v[72:75], v[24:27]
    v_mfma_f32_16x16x32_bf16 v[28:31], a[124:127], v[72:75], v[28:31]
    v_mfma_f32_16x16x32_bf16 v[32:35], a[112:115], v[76:79], v[32:35]
    v_mfma_f32_16x16x32_bf16 v[36:39], a[116:119], v[76:79], v[36:39]
    v_mfma_f32_16x16x32_bf16 v[40:43], a[120:123], v[76:79], v[40:43]
    v_mfma_f32_16x16x32_bf16 v[44:47], a[124:127], v[76:79], v[44:47]
    ds_read_b128 v[72:75], v111 offset:28672
    ds_read_b128 v[76:79], v111 offset:30720
    s_waitcnt lgkmcnt(6)
    v_mfma_f32_16x16x32_bf16 v[16:19], a[128:131], v[48:51], v[16:19]
    v_mfma_f32_16x16x32_bf16 v[20:23], a[132:135], v[48:51], v[20:23]
    v_mfma_f32_16x16x32_bf16 v[24:27], a[136:139], v[48:51], v[24:27]
    v_mfma_f32_16x16x32_bf16 v[28:31], a[140:143], v[48:51], v[28:31]
    v_mfma_f32_16x16x32_bf16 v[32:35], a[128:131], v[52:55], v[32:35]
    v_mfma_f32_16x16x32_bf16 v[36:39], a[132:135], v[52:55], v[36:39]
    v_mfma_f32_16x16x32_bf16 v[40:43], a[136:139], v[52:55], v[40:43]
    v_mfma_f32_16x16x32_bf16 v[44:47], a[140:143], v[52:55], v[44:47]
    ds_read_b128 v[48:51], v110 offset:32768
    ds_read_b128 v[52:55], v110 offset:34816
    s_waitcnt lgkmcnt(6)
    v_mfma_f32_16x16x32_bf16 v[16:19], a[144:147], v[56:59], v[16:19]
    v_mfma_f32_16x16x32_bf16 v[20:23], a[148:151], v[56:59], v[20:23]
    v_mfma_f32_16x16x32_bf16 v[24:27], a[152:155], v[56:59], v[24:27]
    v_mfma_f32_16x16x32_bf16 v[28:31], a[156:159], v[56:59], v[28:31]
    v_mfma_f32_16x16x32_bf16 v[32:35], a[144:147], v[60:63], v[32:35]
    v_mfma_f32_16x16x32_bf16 v[36:39], a[148:151], v[60:63], v[36:39]
    v_mfma_f32_16x16x32_bf16 v[40:43], a[152:155], v[60:63], v[40:43]
    v_mfma_f32_16x16x32_bf16 v[44:47], a[156:159], v[60:63], v[44:47]
    ds_read_b128 v[56:59], v111 offset:32768
    ds_read_b128 v[60:63], v111 offset:34816
    s_waitcnt lgkmcnt(6)
    v_mfma_f32_16x16x32_bf16 v[16:19], a[160:163], v[64:67], v[16:19]
    v_mfma_f32_16x16x32_bf16 v[20:23], a[164:167], v[64:67], v[20:23]
    v_mfma_f32_16x16x32_bf16 v[24:27], a[168:171], v[64:67], v[24:27]
    v_mfma_f32_16x16x32_bf16 v[28:31], a[172:175], v[64:67], v[28:31]
    v_mfma_f32_16x16x32_bf16 v[32:35], a[160:163], v[68:71], v[32:35]
    v_mfma_f32_16x16x32_bf16 v[36:39], a[164:167], v[68:71], v[36:39]
    v_mfma_f32_16x16x32_bf16 v[40:43], a[168:171], v[68:71], v[40:43]
    v_mfma_f32_16x16x32_bf16 v[44:47], a[172:175], v[68:71], v[44:47]
    ds_read_b128 v[64:67], v110 offset:36864
    ds_read_b128 v[68:71], v110 offset:38912
    s_waitcnt lgkmcnt(6)
    v_mfma_f32_16x16x32_bf16 v[16:19], a[176:179], v[72:75], v[16:19]
    v_mfma_f32_16x16x32_bf16 v[20:23], a[180:183], v[72:75], v[20:23]
    v_mfma_f32_16x16x32_bf16 v[24:27], a[184:187], v[72:75], v[24:27]
    v_mfma_f32_16x16x32_bf16 v[28:31], a[188:191], v[72:75], v[28:31]
    v_mfma_f32_16x16x32_bf16 v[32:35], a[176:179], v[76:79], v[32:35]
    v_mfma_f32_16x16x32_bf16 v[36:39], a[180:183], v[76:79], v[36:39]
    v_mfma_f32_16x16x32_bf16 v[40:43], a[184:187], v[76:79], v[40:43]
    v_mfma_f32_16x16x32_bf16 v[44:47], a[188:191], v[76:79], v[44:47]
    ds_read_b128 v[72:75], v111 offset:36864
    ds_read_b128 v[76:79], v111 offset:38912
    s_waitcnt lgkmcnt(6)
    v_mfma_f32_16x16x32_bf16 v[16:19], a[192:195], v[48:51], v[16:19]
    v_mfma_f32_16x16x32_bf16 v[20:23], a[196:199], v[48:51], v[20:23]
    v_mfma_f32_16x16x32_bf16 v[24:27], a[200:203], v[48:51], v[24:27]
    v_mfma_f32_16x16x32_bf16 v[28:31], a[204:207], v[48:51], v[28:31]
    v_mfma_f32_16x16x32_bf16 v[32:35], a[192:195], v[52:55], v[32:35]
    v_mfma_f32_16x16x32_bf16 v[36:39], a[196:199], v[52:55], v[36:39]
    v_mfma_f32_16x16x32_bf16 v[40:43], a[200:203], v[52:55], v[40:43]
    v_mfma_f32_16x16x32_bf16 v[44:47], a[204:207], v[52:55], v[44:47]
    s_waitcnt lgkmcnt(4)
    v_mfma_f32_16x16x32_bf16 v[16:19], a[208:211], v[56:59], v[16:19]
    v_mfma_f32_16x16x32_bf16 v[20:23], a[212:215], v[56:59], v[20:23]
    v_mfma_f32_16x16x32_bf16 v[24:27], a[216:219], v[56:59], v[24:27]
    v_mfma_f32_16x16x32_bf16 v[28:31], a[220:223], v[56:59], v[28:31]
    v_mfma_f32_16x16x32_bf16 v[32:35], a[208:211], v[60:63], v[32:35]
    v_mfma_f32_16x16x32_bf16 v[36:39], a[212:215], v[60:63], v[36:39]
    v_mfma_f32_16x16x32_bf16 v[40:43], a[216:219], v[60:63], v[40:43]
    v_mfma_f32_16x16x32_bf16 v[44:47], a[220:223], v[60:63], v[44:47]
    s_waitcnt lgkmcnt(2)
    v_mfma_f32_16x16x32_bf16 v[16:19], a[224:227], v[64:67], v[16:19]
    v_mfma_f32_16x16x32_bf16 v[20:23], a[228:231], v[64:67], v[20:23]
    v_mfma_f32_16x16x32_bf16 v[24:27], a[232:235], v[64:67], v[24:27]
    v_mfma_f32_16x16x32_bf16 v[28:31], a[236:239], v[64:67], v[28:31]
    v_mfma_f32_16x16x32_bf16 v[32:35], a[224:227], v[68:71], v[32:35]
    v_mfma_f32_16x16x32_bf16 v[36:39], a[228:231], v[68:71], v[36:39]
    v_mfma_f32_16x16x32_bf16 v[40:43], a[232:235], v[68:71], v[40:43]
    v_mfma_f32_16x16x32_bf16 v[44:47], a[236:239], v[68:71], v[44:47]
    s_waitcnt lgkmcnt(0)
    v_mfma_f32_16x16x32_bf16 v[16:19], a[240:243], v[72:75], v[16:19]
    v_mfma_f32_16x16x32_bf16 v[20:23], a[244:247], v[72:75], v[20:23]
    v_mfma_f32_16x16x32_bf16 v[24:27], a[248:251], v[72:75], v[24:27]
    v_mfma_f32_16x16x32_bf16 v[28:31], a[252:255], v[72:75], v[28:31]
    v_mfma_f32_16x16x32_bf16 v[32:35], a[240:243], v[76:79], v[32:35]
    v_mfma_f32_16x16x32_bf16 v[36:39], a[244:247], v[76:79], v[36:39]
    v_mfma_f32_16x16x32_bf16 v[40:43], a[248:251], v[76:79], v[40:43]
    v_mfma_f32_16x16x32_bf16 v[44:47], a[252:255], v[76:79], v[44:47]
    s_add_u32 s51, s51, 1
    s_and_b32 s57, s51, 3
    s_mov_b32 s57, 40960
    s_cselect_b32 s57, s57, 0xfffe2000
    v_add_u32 v110, s57, v110
    v_add_u32 v111, s57, v111
    s_cmp_lt_u32 s51, 32
    s_cbranch_scc1 wk_qkv_T
    v_cvt_pk_bf16_f32 v80, v16, v17
    v_cvt_pk_bf16_f32 v81, v18, v19
    v_cvt_pk_bf16_f32 v82, v20, v21
    v_cvt_pk_bf16_f32 v83, v22, v23
    v_cvt_pk_bf16_f32 v84, v32, v33
    v_cvt_pk_bf16_f32 v85, v34, v35
    v_cvt_pk_bf16_f32 v86, v36, v37
    v_cvt_pk_bf16_f32 v87, v38, v39
    v_cvt_pk_bf16_f32 v88, v24, v25
    v_cvt_pk_bf16_f32 v89, v26, v27
    v_cvt_pk_bf16_f32 v90, v28, v29
    v_cvt_pk_bf16_f32 v91, v30, v31
    v_cvt_pk_bf16_f32 v92, v40, v41
    v_cvt_pk_bf16_f32 v93, v42, v43
    v_cvt_pk_bf16_f32 v94, v44, v45
    v_cvt_pk_bf16_f32 v95, v46, v47
    s_add_u32 s36, s33, 8192
    buffer_store_dwordx4 v[80:83], v4, s[4:7], s33 offen offset:0 sc1
    buffer_store_dwordx4 v[84:87], v4, s[4:7], s33 offen offset:1024 sc1
    buffer_store_dwordx4 v[88:91], v4, s[4:7], s36 offen offset:0 sc1
    buffer_store_dwordx4 v[92:95], v4, s[4:7], s36 offen offset:1024 sc1
    s_mov_b32 s33, s32
    s_add_u32 s32, s32, 524288
    s_waitcnt vmcnt(0)
    s_barrier
    s_sub_u32 s37, 32, s34
    s_bfm_b64 exec, s37, s34
    s_cmp_eq_u32 s37, 0
    s_cselect_b32 s38, 0x40000000, s35
    s_cselect_b64 exec, 1, exec
    s_mov_b32 s34, 32
    buffer_atomic_sub v7, v8, s[4:7], s38 offen
    s_mov_b64 exec, -1
    s_getpc_b64 s[98:99]
Lfj12:
    s_add_u32 s98, s98, wk_qkv_end-Lfj12
    s_addc_u32 s99, s99, 0
    s_setpc_b64 s[98:99]
wk_qkv_N:
    s_waitcnt vmcnt(10)
    s_barrier
    ds_read_b128 v[48:51], v110 offset:0
    ds_read_b128 v[52:55], v110 offset:2048
    ds_read_b128 v[56:59], v111 offset:0
    ds_read_b128 v[60:63], v111 offset:2048
    ds_read_b128 v[64:67], v110 offset:4096
    ds_read_b128 v[68:71], v110 offset:6144
    s_sub_u32 s36, s51, 1
    s_max_i32 s36, s36, s34
    s_sub_u32 s37, s36, s34
    s_bfm_b64 exec, s37, s34
    s_cmp_eq_u32 s37, 0
    s_cselect_b32 s38, 0x40000000, s35
    s_cselect_b64 exec, 1, exec
    s_mov_b32 s34, s36
    buffer_atomic_sub v7, v8, s[4:7], s38 offen
    s_mov_b64 exec, -1
    s_nop 3
    v_cvt_pk_bf16_f32 v80, v16, v17
    v_cvt_pk_bf16_f32 v81, v18, v19
    v_cvt_pk_bf16_f32 v82, v32, v33
    v_cvt_pk_bf16_f32 v83, v34, v35
    v_cvt_pk_bf16_f32 v84, v20, v21
    v_cvt_pk_bf16_f32 v85, v22, v23
    v_cvt_pk_bf16_f32 v86, v36, v37
    v_cvt_pk_bf16_f32 v87, v38, v39
    v_cvt_pk_bf16_f32 v88, v24, v25
    v_cvt_pk_bf16_f32 v89, v26, v27
    v_cvt_pk_bf16_f32 v90, v40, v41
    v_cvt_pk_bf16_f32 v91, v42, v43
    v_cvt_pk_bf16_f32 v92, v28, v29
    v_cvt_pk_bf16_f32 v93, v30, v31
    v_cvt_pk_bf16_f32 v94, v44, v45
    v_cvt_pk_bf16_f32 v95, v46, v47
    s_lshr_b32 s57, s58, 1
    s_min_u32 s57, s57, 15
    s_add_u32 s58, s58, 1
    s_cmp_lt_u32 s57, s59
    s_cbranch_scc1 wk_qkv_N_x_ok
    s_mov_b32 s39, 49280
wk_qkv_N_x:
    buffer_load_dword v3, v6, s[4:7], s39 offen sc1
    s_waitcnt vmcnt(0)
    v_cmp_le_u32 vcc, 8, v3
    s_nop 0
    s_and_b32 s59, vcc_lo, 0xffff
    s_ff0_i32_b32 s59, s59
    s_cmp_lt_u32 s57, s59
    s_cbranch_scc1 wk_qkv_N_x_ok
    s_sleep 2
    s_branch wk_qkv_N_x
wk_qkv_N_x_ok:
    s_add_u32 s36, s33, 8192
    buffer_store_dwordx4 v[80:83], v5, s[4:7], s33 offen offset:0 sc1
    buffer_store_dwordx4 v[84:87], v5, s[4:7], s33 offen offset:1024 sc1
    buffer_store_dwordx4 v[88:91], v5, s[4:7], s36 offen offset:0 sc1
    buffer_store_dwordx4 v[92:95], v5, s[4:7], s36 offen offset:1024 sc1
    s_mov_b32 s33, s32
    s_add_u32 s32, s32, 524288
    s_cmp_lg_u32 s51, 1
    s_cbranch_scc1 wk_qkv_N_nd
    s_waitcnt vmcnt(0)
    s_barrier
    s_sub_u32 s37, s51, s34
    s_bfm_b64 exec, s37, s34
    s_cmp_eq_u32 s37, 0
    s_cselect_b32 s38, 0x40000000, s35
    s_cselect_b64 exec, 1, exec
    s_mov_b32 s34, s51
    buffer_atomic_sub v7, v8, s[4:7], s38 offen
    s_mov_b64 exec, -1
wk_qkv_N_nd:
    ds_read_b128 v[72:75], v111 offset:4096
    ds_read_b128 v[76:79], v111 offset:6144
    s_waitcnt lgkmcnt(6)
    v_mfma_f32_16x16x32_bf16 v[16:19], v[48:51], v[192:195], 0
    v_mfma_f32_16x16x32_bf16 v[20:23], v[48:51], v[196:199], 0
    s_mul_i32 s57, s29, 4096
    v_mfma_f32_16x16x32_bf16 v[24:27], v[48:51], v[200:203], 0
    v_mfma_f32_16x16x32_bf16 v[28:31], v[48:51], v[204:207], 0
    s_add_u32 m0, s57, s56
    v_mfma_f32_16x16x32_bf16 v[32:35], v[52:55], v[192:195], 0
    v_mfma_f32_16x16x32_bf16 v[36:39], v[52:55], v[196:199], 0
    s_add_u32 s57, s57, s55
    v_mfma_f32_16x16x32_bf16 v[40:43], v[52:55], v[200:203], 0
    v_mfma_f32_16x16x32_bf16 v[44:47], v[52:55], v[204:207], 0
    buffer_load_dwordx4 v104, s[4:7], s57 offen offset:0 sc1 lds
    ds_read_b128 v[48:51], v110 offset:8192
    ds_read_b128 v[52:55], v110 offset:10240
    s_waitcnt lgkmcnt(6)
    v_mfma_f32_16x16x32_bf16 v[16:19], v[56:59], v[208:211], v[16:19]
    v_mfma_f32_16x16x32_bf16 v[20:23], v[56:59], v[212:215], v[20:23]
    buffer_load_dwordx4 v105, s[4:7], s57 offen offset:1024 sc1 lds
    v_mfma_f32_16x16x32_bf16 v[24:27], v[56:59], v[216:219], v[24:27]
    v_mfma_f32_16x16x32_bf16 v[28:31], v[56:59], v[220:223], v[28:31]
    buffer_load_dwordx4 v104, s[4:7], s57 offen offset:2048 sc1 lds
    v_mfma_f32_16x16x32_bf16 v[32:35], v[60:63], v[208:211], v[32:35]
    v_mfma_f32_16x16x32_bf16 v[36:39], v[60:63], v[212:215], v[36:39]
    buffer_load_dwordx4 v105, s[4:7], s57 offen offset:3072 sc1 lds
    v_mfma_f32_16x16x32_bf16 v[40:43], v[60:63], v[216:219], v[40:43]
    v_mfma_f32_16x16x32_bf16 v[44:47], v[60:63], v[220:223], v[44:47]
    s_mul_i32 s57, s29, 4096
    ds_read_b128 v[56:59], v111 offset:8192
    ds_read_b128 v[60:63], v111 offset:10240
    s_waitcnt lgkmcnt(6)
    v_mfma_f32_16x16x32_bf16 v[16:19], v[64:67], v[224:227], v[16:19]
    v_mfma_f32_16x16x32_bf16 v[20:23], v[64:67], v[228:231], v[20:23]
    s_add_u32 s57, s57, 16384
    v_mfma_f32_16x16x32_bf16 v[24:27], v[64:67], v[232:235], v[24:27]
    v_mfma_f32_16x16x32_bf16 v[28:31], v[64:67], v[236:239], v[28:31]
    s_add_u32 m0, s57, s56
    v_mfma_f32_16x16x32_bf16 v[32:35], v[68:71], v[224:227], v[32:35]
    v_mfma_f32_16x16x32_bf16 v[36:39], v[68:71], v[228:231], v[36:39]
    s_add_u32 s57, s57, s55
    v_mfma_f32_16x16x32_bf16 v[40:43], v[68:71], v[232:235], v[40:43]
    v_mfma_f32_16x16x32_bf16 v[44:47], v[68:71], v[236:239], v[44:47]
    buffer_load_dwordx4 v104, s[4:7], s57 offen offset:0 sc1 lds
    ds_read_b128 v[64:67], v110 offset:12288
    ds_read_b128 v[68:71], v110 offset:14336
    s_waitcnt lgkmcnt(6)
    v_mfma_f32_16x16x32_bf16 v[16:19], v[72:75], v[240:243], v[16:19]
    v_mfma_f32_16x16x32_bf16 v[20:23], v[72:75], v[244:247], v[20:23]
    buffer_load_dwordx4 v105, s[4:7], s57 offen offset:1024 sc1 lds
    v_mfma_f32_16x16x32_bf16 v[24:27], v[72:75], v[248:251], v[24:27]
    v_mfma_f32_16x16x32_bf16 v[28:31], v[72:75], v[252:255], v[28:31]
    buffer_load_dwordx4 v104, s[4:7], s57 offen offset:2048 sc1 lds
    v_mfma_f32_16x16x32_bf16 v[32:35], v[76:79], v[240:243], v[32:35]
    v_mfma_f32_16x16x32_bf16 v[36:39], v[76:79], v[244:247], v[36:39]
    buffer_load_dwordx4 v105, s[4:7], s57 offen offset:3072 sc1 lds
    v_mfma_f32_16x16x32_bf16 v[40:43], v[76:79], v[248:251], v[40:43]
    v_mfma_f32_16x16x32_bf16 v[44:47], v[76:79], v[252:255], v[44:47]
    s_mul_i32 s57, s29, 2048
    ds_read_b128 v[72:75], v111 offset:12288
    ds_read_b128 v[76:79], v111 offset:14336
    s_waitcnt lgkmcnt(6)
    v_mfma_f32_16x16x32_bf16 v[16:19], v[48:51], a[0:3], v[16:19]
    v_mfma_f32_16x16x32_bf16 v[20:23], v[48:51], a[4:7], v[20:23]
    s_add_u32 s57, s57, 32768
    v_mfma_f32_16x16x32_bf16 v[24:27], v[48:51], a[8:11], v[24:27]
    v_mfma_f32_16x16x32_bf16 v[28:31], v[48:51], a[12:15], v[28:31]
    s_add_u32 m0, s57, s56
    v_mfma_f32_16x16x32_bf16 v[32:35], v[52:55], a[0:3], v[32:35]
    v_mfma_f32_16x16x32_bf16 v[36:39], v[52:55], a[4:7], v[36:39]
    s_add_u32 s57, s57, s55
    v_mfma_f32_16x16x32_bf16 v[40:43], v[52:55], a[8:11], v[40:43]
    v_mfma_f32_16x16x32_bf16 v[44:47], v[52:55], a[12:15], v[44:47]
    buffer_load_dwordx4 v104, s[4:7], s57 offen offset:0 sc1 lds
    ds_read_b128 v[48:51], v110 offset:16384
    ds_read_b128 v[52:55], v110 offset:18432
    s_waitcnt lgkmcnt(6)
    v_mfma_f32_16x16x32_bf16 v[16:19], v[56:59], a[16:19], v[16:19]
    v_mfma_f32_16x16x32_bf16 v[20:23], v[56:59], a[20:23], v[20:23]
    buffer_load_dwordx4 v105, s[4:7], s57 offen offset:1024 sc1 lds
    v_mfma_f32_16x16x32_bf16 v[24:27], v[56:59], a[24:27], v[24:27]
    v_mfma_f32_16x16x32_bf16 v[28:31], v[56:59], a[28:31], v[28:31]
    s_add_u32 s57, s55, 81920
    v_mfma_f32_16x16x32_bf16 v[32:35], v[60:63], a[16:19], v[32:35]
    v_mfma_f32_16x16x32_bf16 v[36:39], v[60:63], a[20:23], v[36:39]
    s_cmp_lt_u32 s57, 61341696
    v_mfma_f32_16x16x32_bf16 v[40:43], v[60:63], a[24:27], v[40:43]
    v_mfma_f32_16x16x32_bf16 v[44:47], v[60:63], a[28:31], v[44:47]
    s_cselect_b32 s55, s57, s55
    ds_read_b128 v[56:59], v111 offset:16384
    ds_read_b128 v[60:63], v111 offset:18432
    s_waitcnt lgkmcnt(6)
    v_mfma_f32_16x16x32_bf16 v[16:19], v[64:67], a[32:35], v[16:19]
    v_mfma_f32_16x16x32_bf16 v[20:23], v[64:67], a[36:39], v[20:23]
    s_add_u32 s56, s56, 40960
    v_mfma_f32_16x16x32_bf16 v[24:27], v[64:67], a[40:43], v[24:27]
    v_mfma_f32_16x16x32_bf16 v[28:31], v[64:67], a[44:47], v[28:31]
    s_cmp_lt_u32 s56, 163840
    v_mfma_f32_16x16x32_bf16 v[32:35], v[68:71], a[32:35], v[32:35]
    v_mfma_f32_16x16x32_bf16 v[36:39], v[68:71], a[36:39], v[36:39]
    s_cselect_b32 s56, s56, 0
    v_mfma_f32_16x16x32_bf16 v[40:43], v[68:71], a[40:43], v[40:43]
    v_mfma_f32_16x16x32_bf16 v[44:47], v[68:71], a[44:47], v[44:47]
    ds_read_b128 v[64:67], v110 offset:20480
    ds_read_b128 v[68:71], v110 offset:22528
    s_waitcnt lgkmcnt(6)
    v_mfma_f32_16x16x32_bf16 v[16:19], v[72:75], a[48:51], v[16:19]
    v_mfma_f32_16x16x32_bf16 v[20:23], v[72:75], a[52:55], v[20:23]
    v_mfma_f32_16x16x32_bf16 v[24:27], v[72:75], a[56:59], v[24:27]
    v_mfma_f32_16x16x32_bf16 v[28:31], v[72:75], a[60:63], v[28:31]
    v_mfma_f32_16x16x32_bf16 v[32:35], v[76:79], a[48:51], v[32:35]
    v_mfma_f32_16x16x32_bf16 v[36:39], v[76:79], a[52:55], v[36:39]
    v_mfma_f32_16x16x32_bf16 v[40:43], v[76:79], a[56:59], v[40:43]
    v_mfma_f32_16x16x32_bf16 v[44:47], v[76:79], a[60:63], v[44:47]
    ds_read_b128 v[72:75], v111 offset:20480
    ds_read_b128 v[76:79], v111 offset:22528
    s_waitcnt lgkmcnt(6)
    v_mfma_f32_16x16x32_bf16 v[16:19], v[48:51], a[64:67], v[16:19]
    v_mfma_f32_16x16x32_bf16 v[20:23], v[48:51], a[68:71], v[20:23]
    v_mfma_f32_16x16x32_bf16 v[24:27], v[48:51], a[72:75], v[24:27]
    v_mfma_f32_16x16x32_bf16 v[28:31], v[48:51], a[76:79], v[28:31]
    v_mfma_f32_16x16x32_bf16 v[32:35], v[52:55], a[64:67], v[32:35]
    v_mfma_f32_16x16x32_bf16 v[36:39], v[52:55], a[68:71], v[36:39]
    v_mfma_f32_16x16x32_bf16 v[40:43], v[52:55], a[72:75], v[40:43]
    v_mfma_f32_16x16x32_bf16 v[44:47], v[52:55], a[76:79], v[44:47]
    ds_read_b128 v[48:51], v110 offset:24576
    ds_read_b128 v[52:55], v110 offset:26624
    s_waitcnt lgkmcnt(6)
    v_mfma_f32_16x16x32_bf16 v[16:19], v[56:59], a[80:83], v[16:19]
    v_mfma_f32_16x16x32_bf16 v[20:23], v[56:59], a[84:87], v[20:23]
    v_mfma_f32_16x16x32_bf16 v[24:27], v[56:59], a[88:91], v[24:27]
    v_mfma_f32_16x16x32_bf16 v[28:31], v[56:59], a[92:95], v[28:31]
    v_mfma_f32_16x16x32_bf16 v[32:35], v[60:63], a[80:83], v[32:35]
    v_mfma_f32_16x16x32_bf16 v[36:39], v[60:63], a[84:87], v[36:39]
    v_mfma_f32_16x16x32_bf16 v[40:43], v[60:63], a[88:91], v[40:43]
    v_mfma_f32_16x16x32_bf16 v[44:47], v[60:63], a[92:95], v[44:47]
    ds_read_b128 v[56:59], v111 offset:24576
    ds_read_b128 v[60:63], v111 offset:26624
    s_waitcnt lgkmcnt(6)
    v_mfma_f32_16x16x32_bf16 v[16:19], v[64:67], a[96:99], v[16:19]
    v_mfma_f32_16x16x32_bf16 v[20:23], v[64:67], a[100:103], v[20:23]
    v_mfma_f32_16x16x32_bf16 v[24:27], v[64:67], a[104:107], v[24:27]
    v_mfma_f32_16x16x32_bf16 v[28:31], v[64:67], a[108:111], v[28:31]
    v_mfma_f32_16x16x32_bf16 v[32:35], v[68:71], a[96:99], v[32:35]
    v_mfma_f32_16x16x32_bf16 v[36:39], v[68:71], a[100:103], v[36:39]
    v_mfma_f32_16x16x32_bf16 v[40:43], v[68:71], a[104:107], v[40:43]
    v_mfma_f32_16x16x32_bf16 v[44:47], v[68:71], a[108:111], v[44:47]
    ds_read_b128 v[64:67], v110 offset:28672
    ds_read_b128 v[68:71], v110 offset:30720
    s_waitcnt lgkmcnt(6)
    v_mfma_f32_16x16x32_bf16 v[16:19], v[72:75], a[112:115], v[16:19]
    v_mfma_f32_16x16x32_bf16 v[20:23], v[72:75], a[116:119], v[20:23]
    v_mfma_f32_16x16x32_bf16 v[24:27], v[72:75], a[120:123], v[24:27]
    v_mfma_f32_16x16x32_bf16 v[28:31], v[72:75], a[124:127], v[28:31]
    v_mfma_f32_16x16x32_bf16 v[32:35], v[76:79], a[112:115], v[32:35]
    v_mfma_f32_16x16x32_bf16 v[36:39], v[76:79], a[116:119], v[36:39]
    v_mfma_f32_16x16x32_bf16 v[40:43], v[76:79], a[120:123], v[40:43]
    v_mfma_f32_16x16x32_bf16 v[44:47], v[76:79], a[124:127], v[44:47]
    ds_read_b128 v[72:75], v111 offset:28672
    ds_read_b128 v[76:79], v111 offset:30720
    s_waitcnt lgkmcnt(6)
    v_mfma_f32_16x16x32_bf16 v[16:19], v[48:51], a[128:131], v[16:19]
    v_mfma_f32_16x16x32_bf16 v[20:23], v[48:51], a[132:135], v[20:23]
    v_mfma_f32_16x16x32_bf16 v[24:27], v[48:51], a[136:139], v[24:27]
    v_mfma_f32_16x16x32_bf16 v[28:31], v[48:51], a[140:143], v[28:31]
    v_mfma_f32_16x16x32_bf16 v[32:35], v[52:55], a[128:131], v[32:35]
    v_mfma_f32_16x16x32_bf16 v[36:39], v[52:55], a[132:135], v[36:39]
    v_mfma_f32_16x16x32_bf16 v[40:43], v[52:55], a[136:139], v[40:43]
    v_mfma_f32_16x16x32_bf16 v[44:47], v[52:55], a[140:143], v[44:47]
    ds_read_b128 v[48:51], v110 offset:32768
    ds_read_b128 v[52:55], v110 offset:34816
    s_waitcnt lgkmcnt(6)
    v_mfma_f32_16x16x32_bf16 v[16:19], v[56:59], a[144:147], v[16:19]
    v_mfma_f32_16x16x32_bf16 v[20:23], v[56:59], a[148:151], v[20:23]
    v_mfma_f32_16x16x32_bf16 v[24:27], v[56:59], a[152:155], v[24:27]
    v_mfma_f32_16x16x32_bf16 v[28:31], v[56:59], a[156:159], v[28:31]
    v_mfma_f32_16x16x32_bf16 v[32:35], v[60:63], a[144:147], v[32:35]
    v_mfma_f32_16x16x32_bf16 v[36:39], v[60:63], a[148:151], v[36:39]
    v_mfma_f32_16x16x32_bf16 v[40:43], v[60:63], a[152:155], v[40:43]
    v_mfma_f32_16x16x32_bf16 v[44:47], v[60:63], a[156:159], v[44:47]
    ds_read_b128 v[56:59], v111 offset:32768
    ds_read_b128 v[60:63], v111 offset:34816
    s_waitcnt lgkmcnt(6)
    v_mfma_f32_16x16x32_bf16 v[16:19], v[64:67], a[160:163], v[16:19]
    v_mfma_f32_16x16x32_bf16 v[20:23], v[64:67], a[164:167], v[20:23]
    v_mfma_f32_16x16x32_bf16 v[24:27], v[64:67], a[168:171], v[24:27]
    v_mfma_f32_16x16x32_bf16 v[28:31], v[64:67], a[172:175], v[28:31]
    v_mfma_f32_16x16x32_bf16 v[32:35], v[68:71], a[160:163], v[32:35]
    v_mfma_f32_16x16x32_bf16 v[36:39], v[68:71], a[164:167], v[36:39]
    v_mfma_f32_16x16x32_bf16 v[40:43], v[68:71], a[168:171], v[40:43]
    v_mfma_f32_16x16x32_bf16 v[44:47], v[68:71], a[172:175], v[44:47]
    ds_read_b128 v[64:67], v110 offset:36864
    ds_read_b128 v[68:71], v110 offset:38912
    s_waitcnt lgkmcnt(6)
    v_mfma_f32_16x16x32_bf16 v[16:19], v[72:75], a[176:179], v[16:19]
    v_mfma_f32_16x16x32_bf16 v[20:23], v[72:75], a[180:183], v[20:23]
    v_mfma_f32_16x16x32_bf16 v[24:27], v[72:75], a[184:187], v[24:27]
    v_mfma_f32_16x16x32_bf16 v[28:31], v[72:75], a[188:191], v[28:31]
    v_mfma_f32_16x16x32_bf16 v[32:35], v[76:79], a[176:179], v[32:35]
    v_mfma_f32_16x16x32_bf16 v[36:39], v[76:79], a[180:183], v[36:39]
    v_mfma_f32_16x16x32_bf16 v[40:43], v[76:79], a[184:187], v[40:43]
    v_mfma_f32_16x16x32_bf16 v[44:47], v[76:79], a[188:191], v[44:47]
    ds_read_b128 v[72:75], v111 offset:36864
    ds_read_b128 v[76:79], v111 offset:38912
    s_waitcnt lgkmcnt(6)
    v_mfma_f32_16x16x32_bf16 v[16:19], v[48:51], a[192:195], v[16:19]
    v_mfma_f32_16x16x32_bf16 v[20:23], v[48:51], a[196:199], v[20:23]
    v_mfma_f32_16x16x32_bf16 v[24:27], v[48:51], a[200:203], v[24:27]
    v_mfma_f32_16x16x32_bf16 v[28:31], v[48:51], a[204:207], v[28:31]
    v_mfma_f32_16x16x32_bf16 v[32:35], v[52:55], a[192:195], v[32:35]
    v_mfma_f32_16x16x32_bf16 v[36:39], v[52:55], a[196:199], v[36:39]
    v_mfma_f32_16x16x32_bf16 v[40:43], v[52:55], a[200:203], v[40:43]
    v_mfma_f32_16x16x32_bf16 v[44:47], v[52:55], a[204:207], v[44:47]
    s_waitcnt lgkmcnt(4)
    v_mfma_f32_16x16x32_bf16 v[16:19], v[56:59], a[208:211], v[16:19]
    v_mfma_f32_16x16x32_bf16 v[20:23], v[56:59], a[212:215], v[20:23]
    v_mfma_f32_16x16x32_bf16 v[24:27], v[56:59], a[216:219], v[24:27]
    v_mfma_f32_16x16x32_bf16 v[28:31], v[56:59], a[220:223], v[28:31]
    v_mfma_f32_16x16x32_bf16 v[32:35], v[60:63], a[208:211], v[32:35]
    v_mfma_f32_16x16x32_bf16 v[36:39], v[60:63], a[212:215], v[36:39]
    v_mfma_f32_16x16x32_bf16 v[40:43], v[60:63], a[216:219], v[40:43]
    v_mfma_f32_16x16x32_bf16 v[44:47], v[60:63], a[220:223], v[44:47]
    s_waitcnt lgkmcnt(2)
    v_mfma_f32_16x16x32_bf16 v[16:19], v[64:67], a[224:227], v[16:19]
    v_mfma_f32_16x16x32_bf16 v[20:23], v[64:67], a[228:231], v[20:23]
    v_mfma_f32_16x16x32_bf16 v[24:27], v[64:67], a[232:235], v[24:27]
    v_mfma_f32_16x16x32_bf16 v[28:31], v[64:67], a[236:239], v[28:31]
    v_mfma_f32_16x16x32_bf16 v[32:35], v[68:71], a[224:227], v[32:35]
    v_mfma_f32_16x16x32_bf16 v[36:39], v[68:71], a[228:231], v[36:39]
    v_mfma_f32_16x16x32_bf16 v[40:43], v[68:71], a[232:235], v[40:43]
    v_mfma_f32_16x16x32_bf16 v[44:47], v[68:71], a[236:239], v[44:47]
    s_waitcnt lgkmcnt(0)
    v_mfma_f32_16x16x32_bf16 v[16:19], v[72:75], a[240:243], v[16:19]
    v_mfma_f32_16x16x32_bf16 v[20:23], v[72:75], a[244:247], v[20:23]
    v_mfma_f32_16x16x32_bf16 v[24:27], v[72:75], a[248:251], v[24:27]
    v_mfma_f32_16x16x32_bf16 v[28:31], v[72:75], a[252:255], v[28:31]
    v_mfma_f32_16x16x32_bf16 v[32:35], v[76:79], a[240:243], v[32:35]
    v_mfma_f32_16x16x32_bf16 v[36:39], v[76:79], a[244:247], v[36:39]
    v_mfma_f32_16x16x32_bf16 v[40:43], v[76:79], a[248:251], v[40:43]
    v_mfma_f32_16x16x32_bf16 v[44:47], v[76:79], a[252:255], v[44:47]
    s_add_u32 s51, s51, 1
    s_and_b32 s57, s51, 3
    s_mov_b32 s57, 40960
    s_cselect_b32 s57, s57, 0xfffe2000
    v_add_u32 v110, s57, v110
    v_add_u32 v111, s57, v111
    s_cmp_lt_u32 s51, 32
    s_cbranch_scc1 wk_qkv_N
    v_cvt_pk_bf16_f32 v80, v16, v17
    v_cvt_pk_bf16_f32 v81, v18, v19
    v_cvt_pk_bf16_f32 v82, v32, v33
    v_cvt_pk_bf16_f32 v83, v34, v35
    v_cvt_pk_bf16_f32 v84, v20, v21
    v_cvt_pk_bf16_f32 v85, v22, v23
    v_cvt_pk_bf16_f32 v86, v36, v37
    v_cvt_pk_bf16_f32 v87, v38, v39
    v_cvt_pk_bf16_f32 v88, v24, v25
    v_cvt_pk_bf16_f32 v89, v26, v27
    v_cvt_pk_bf16_f32 v90, v40, v41
    v_cvt_pk_bf16_f32 v91, v42, v43
    v_cvt_pk_bf16_f32 v92, v28, v29
    v_cvt_pk_bf16_f32 v93, v30, v31
    v_cvt_pk_bf16_f32 v94, v44, v45
    v_cvt_pk_bf16_f32 v95, v46, v47
    s_add_u32 s36, s33, 8192
    buffer_store_dwordx4 v[80:83], v5, s[4:7], s33 offen offset:0 sc1
    buffer_store_dwordx4 v[84:87], v5, s[4:7], s33 offen offset:1024 sc1
    buffer_store_dwordx4 v[88:91], v5, s[4:7], s36 offen offset:0 sc1
    buffer_store_dwordx4 v[92:95], v5, s[4:7], s36 offen offset:1024 sc1
    s_mov_b32 s33, s32
    s_add_u32 s32, s32, 524288
    s_waitcnt vmcnt(0)
    s_barrier
    s_sub_u32 s37, 32, s34
    s_bfm_b64 exec, s37, s34
    s_cmp_eq_u32 s37, 0
    s_cselect_b32 s38, 0x40000000, s35
    s_cselect_b64 exec, 1, exec
    s_mov_b32 s34, 32
    buffer_atomic_sub v7, v8, s[4:7], s38 offen
    s_mov_b64 exec, -1
wk_qkv_end:
    s_getpc_b64 s[44:45]
Lbj1:
    s_add_u32 s44, s44, wk_pool-Lbj1
    s_addc_u32 s45, s45, -1
    s_setpc_b64 s[44:45]
wk_ln1:
    s_lshl_b32 s30, s53, 2
    s_add_u32 s30, s30, s29
    s_mul_i32 s30, s30, 5120
    v_lshlrev_b32 v4, 2, v1
    s_add_u32 s31, s30, 2560
    buffer_load_dword v16, v4, s[76:79], s30 offen offset:0
    buffer_load_dword v17, v4, s[76:79], s30 offen offset:256
    buffer_load_dword v18, v4, s[76:79], s30 offen offset:512
    buffer_load_dword v19, v4, s[76:79], s30 offen offset:768
    buffer_load_dword v20, v4, s[76:79], s30 offen offset:1024
    buffer_load_dword v21, v4, s[76:79], s30 offen offset:1280
    buffer_load_dword v22, v4, s[76:79], s30 offen offset:1536
    buffer_load_dword v23, v4, s[76:79], s30 offen offset:1792
    buffer_load_dword v24, v4, s[76:79], s30 offen offset:2048
    buffer_load_dword v25, v4, s[76:79], s30 offen offset:2304
    buffer_load_dword v26, v4, s[76:79], s31 offen offset:0
    buffer_load_dword v27, v4, s[76:79], s31 offen offset:256
    buffer_load_dword v28, v4, s[76:79], s31 offen offset:512
    buffer_load_dword v29, v4, s[76:79], s31 offen offset:768
    buffer_load_dword v30, v4, s[76:79], s31 offen offset:1024
    buffer_load_dword v31, v4, s[76:79], s31 offen offset:1280
    buffer_load_dword v32, v4, s[76:79], s31 offen offset:1536
    buffer_load_dword v33, v4, s[76:79], s31 offen offset:1792
    buffer_load_dword v34, v4, s[76:79], s31 offen offset:2048
    buffer_load_dword v35, v4, s[76:79], s31 offen offset:2304
    s_mov_b32 s32, 0x3acccccd
    s_mov_b32 s33, 0x3727c5ac
    s_waitcnt vmcnt(0)
    v_lshlrev_b32 v64, 16, v16
    v_and_b32 v65, 0xffff0000, v16
    v_lshlrev_b32 v66, 16, v17
    v_and_b32 v67, 0xffff0000, v17
    v_lshlrev_b32 v68, 16, v18
    v_and_b32 v69, 0xffff0000, v18
    v_lshlrev_b32 v70, 16, v19
    v_and_b32 v71, 0xffff0000, v19
    v_lshlrev_b32 v72, 16, v20
    v_and_b32 v73, 0xffff0000, v20
    v_add_f32 v8, v64, v65
    v_add_f32 v8, v8, v66
    v_add_f32 v8, v8, v67
    v_add_f32 v8, v8, v68
    v_add_f32 v8, v8, v69
    v_add_f32 v8, v8, v70
    v_add_f32 v8, v8, v71
    v_add_f32 v8, v8, v72
    v_add_f32 v8, v8, v73
    s_nop 1
    v_add_f32_dpp v8, v8, v8 quad_perm:[1,0,3,2] row_mask:0xf bank_mask:0xf
    s_nop 1
    v_add_f32_dpp v8, v8, v8 quad_perm:[2,3,0,1] row_mask:0xf bank_mask:0xf
    s_nop 1
    v_add_f32_dpp v8, v8, v8 row_half_mirror row_mask:0xf bank_mask:0xf
    s_nop 1
    v_add_f32_dpp v8, v8, v8 row_mirror row_mask:0xf bank_mask:0xf
    v_mov_b32 v9, v8
    s_nop 1
    v_permlane16_swap_b32 v8, v9
    v_add_f32 v8, v8, v9
    v_mov_b32 v9, v8
    s_nop 1
    v_permlane32_swap_b32 v8, v9
    v_add_f32 v8, v8, v9
    v_mul_f32 v8, s32, v8
    v_mov_b32 v10, 0
    v_sub_f32 v9, v64, v8
    v_fmac_f32 v10, v9, v9
    v_sub_f32 v9, v65, v8
    v_fmac_f32 v10, v9, v9
    v_sub_f32 v9, v66, v8
    v_fmac_f32 v10, v9, v9
    v_sub_f32 v9, v67, v8
    v_fmac_f32 v10, v9, v9
    v_sub_f32 v9, v68, v8
    v_fmac_f32 v10, v9, v9
    v_sub_f32 v9, v69, v8
    v_fmac_f32 v10, v9, v9
    v_sub_f32 v9, v70, v8
    v_fmac_f32 v10, v9, v9
    v_sub_f32 v9, v71, v8
    v_fmac_f32 v10, v9, v9
    v_sub_f32 v9, v72, v8
    v_fmac_f32 v10, v9, v9
    v_sub_f32 v9, v73, v8
    v_fmac_f32 v10, v9, v9
    s_nop 1
    v_add_f32_dpp v10, v10, v10 quad_perm:[1,0,3,2] row_mask:0xf bank_mask:0xf
    s_nop 1
    v_add_f32_dpp v10, v10, v10 quad_perm:[2,3,0,1] row_mask:0xf bank_mask:0xf
    s_nop 1
    v_add_f32_dpp v10, v10, v10 row_half_mirror row_mask:0xf bank_mask:0xf
    s_nop 1
    v_add_f32_dpp v10, v10, v10 row_mirror row_mask:0xf bank_mask:0xf
    v_mov_b32 v9, v10
    s_nop 1
    v_permlane16_swap_b32 v10, v9
    v_add_f32 v10, v10, v9
    v_mov_b32 v9, v10
    s_nop 1
    v_permlane32_swap_b32 v10, v9
    v_add_f32 v10, v10, v9
    v_mul_f32 v10, s32, v10
    v_cvt_pk_bf16_f32 v7, v8, v10
    v_lshlrev_b32 v8, 16, v7
    v_and_b32 v10, 0xffff0000, v7
    v_add_f32 v10, s33, v10
    v_cvt_pk_bf16_f32 v7, v10, v9
    v_lshlrev_b32 v10, 16, v7
    v_and_b32 v9, 0xffff0000, v7
    v_sqrt_f32 v10, v10
    s_nop 0
    v_cvt_pk_bf16_f32 v7, v10, v9
    v_lshlrev_b32 v10, 16, v7
    v_and_b32 v9, 0xffff0000, v7
    v_rcp_f32 v10, v10
    v_sub_f32 v64, v64, v8
    v_sub_f32 v65, v65, v8
    v_cvt_pk_bf16_f32 v7, v64, v65
    v_lshlrev_b32 v64, 16, v7
    v_and_b32 v65, 0xffff0000, v7
    v_mul_f32 v64, v64, v10
    v_mul_f32 v65, v65, v10
    v_cvt_pk_bf16_f32 v7, v64, v65
    v_lshlrev_b32 v64, 16, v7
    v_and_b32 v65, 0xffff0000, v7
    v_sub_f32 v66, v66, v8
    v_sub_f32 v67, v67, v8
    v_cvt_pk_bf16_f32 v7, v66, v67
    v_lshlrev_b32 v66, 16, v7
    v_and_b32 v67, 0xffff0000, v7
    v_mul_f32 v66, v66, v10
    v_mul_f32 v67, v67, v10
    v_cvt_pk_bf16_f32 v7, v66, v67
    v_lshlrev_b32 v66, 16, v7
    v_and_b32 v67, 0xffff0000, v7
    v_sub_f32 v68, v68, v8
    v_sub_f32 v69, v69, v8
    v_cvt_pk_bf16_f32 v7, v68, v69
    v_lshlrev_b32 v68, 16, v7
    v_and_b32 v69, 0xffff0000, v7
    v_mul_f32 v68, v68, v10
    v_mul_f32 v69, v69, v10
    v_cvt_pk_bf16_f32 v7, v68, v69
    v_lshlrev_b32 v68, 16, v7
    v_and_b32 v69, 0xffff0000, v7
    v_sub_f32 v70, v70, v8
    v_sub_f32 v71, v71, v8
    v_cvt_pk_bf16_f32 v7, v70, v71
    v_lshlrev_b32 v70, 16, v7
    v_and_b32 v71, 0xffff0000, v7
    v_mul_f32 v70, v70, v10
    v_mul_f32 v71, v71, v10
    v_cvt_pk_bf16_f32 v7, v70, v71
    v_lshlrev_b32 v70, 16, v7
    v_and_b32 v71, 0xffff0000, v7
    v_sub_f32 v72, v72, v8
    v_sub_f32 v73, v73, v8
    v_cvt_pk_bf16_f32 v7, v72, v73
    v_lshlrev_b32 v72, 16, v7
    v_and_b32 v73, 0xffff0000, v7
    v_mul_f32 v72, v72, v10
    v_mul_f32 v73, v73, v10
    v_cvt_pk_bf16_f32 v7, v72, v73
    v_lshlrev_b32 v72, 16, v7
    v_and_b32 v73, 0xffff0000, v7
    v_lshlrev_b32 v74, 16, v21
    v_and_b32 v75, 0xffff0000, v21
    v_lshlrev_b32 v76, 16, v22
    v_and_b32 v77, 0xffff0000, v22
    v_lshlrev_b32 v78, 16, v23
    v_and_b32 v79, 0xffff0000, v23
    v_lshlrev_b32 v80, 16, v24
    v_and_b32 v81, 0xffff0000, v24
    v_lshlrev_b32 v82, 16, v25
    v_and_b32 v83, 0xffff0000, v25
    v_add_f32 v8, v74, v75
    v_add_f32 v8, v8, v76
    v_add_f32 v8, v8, v77
    v_add_f32 v8, v8, v78
    v_add_f32 v8, v8, v79
    v_add_f32 v8, v8, v80
    v_add_f32 v8, v8, v81
    v_add_f32 v8, v8, v82
    v_add_f32 v8, v8, v83
    s_nop 1
    v_add_f32_dpp v8, v8, v8 quad_perm:[1,0,3,2] row_mask:0xf bank_mask:0xf
    s_nop 1
    v_add_f32_dpp v8, v8, v8 quad_perm:[2,3,0,1] row_mask:0xf bank_mask:0xf
    s_nop 1
    v_add_f32_dpp v8, v8, v8 row_half_mirror row_mask:0xf bank_mask:0xf
    s_nop 1
    v_add_f32_dpp v8, v8, v8 row_mirror row_mask:0xf bank_mask:0xf
    v_mov_b32 v9, v8
    s_nop 1
    v_permlane16_swap_b32 v8, v9
    v_add_f32 v8, v8, v9
    v_mov_b32 v9, v8
    s_nop 1
    v_permlane32_swap_b32 v8, v9
    v_add_f32 v8, v8, v9
    v_mul_f32 v8, s32, v8
    v_mov_b32 v10, 0
    v_sub_f32 v9, v74, v8
    v_fmac_f32 v10, v9, v9
    v_sub_f32 v9, v75, v8
    v_fmac_f32 v10, v9, v9
    v_sub_f32 v9, v76, v8
    v_fmac_f32 v10, v9, v9
    v_sub_f32 v9, v77, v8
    v_fmac_f32 v10, v9, v9
    v_sub_f32 v9, v78, v8
    v_fmac_f32 v10, v9, v9
    v_sub_f32 v9, v79, v8
    v_fmac_f32 v10, v9, v9
    v_sub_f32 v9, v80, v8
    v_fmac_f32 v10, v9, v9
    v_sub_f32 v9, v81, v8
    v_fmac_f32 v10, v9, v9
    v_sub_f32 v9, v82, v8
    v_fmac_f32 v10, v9, v9
    v_sub_f32 v9, v83, v8
    v_fmac_f32 v10, v9, v9
    s_nop 1
    v_add_f32_dpp v10, v10, v10 quad_perm:[1,0,3,2] row_mask:0xf bank_mask:0xf
    s_nop 1
    v_add_f32_dpp v10, v10, v10 quad_perm:[2,3,0,1] row_mask:0xf bank_mask:0xf
    s_nop 1
    v_add_f32_dpp v10, v10, v10 row_half_mirror row_mask:0xf bank_mask:0xf
    s_nop 1
    v_add_f32_dpp v10, v10, v10 row_mirror row_mask:0xf bank_mask:0xf
    v_mov_b32 v9, v10
    s_nop 1
    v_permlane16_swap_b32 v10, v9
    v_add_f32 v10, v10, v9
    v_mov_b32 v9, v10
    s_nop 1
    v_permlane32_swap_b32 v10, v9
    v_add_f32 v10, v10, v9
    v_mul_f32 v10, s32, v10
    v_cvt_pk_bf16_f32 v7, v8, v10
    v_lshlrev_b32 v8, 16, v7
    v_and_b32 v10, 0xffff0000, v7
    v_add_f32 v10, s33, v10
    v_cvt_pk_bf16_f32 v7, v10, v9
    v_lshlrev_b32 v10, 16, v7
    v_and_b32 v9, 0xffff0000, v7
    v_sqrt_f32 v10, v10
    s_nop 0
    v_cvt_pk_bf16_f32 v7, v10, v9
    v_lshlrev_b32 v10, 16, v7
    v_and_b32 v9, 0xffff0000, v7
    v_rcp_f32 v10, v10
    v_sub_f32 v74, v74, v8
    v_sub_f32 v75, v75, v8
    v_cvt_pk_bf16_f32 v7, v74, v75
    v_lshlrev_b32 v74, 16, v7
    v_and_b32 v75, 0xffff0000, v7
    v_mul_f32 v74, v74, v10
    v_mul_f32 v75, v75, v10
    v_cvt_pk_bf16_f32 v7, v74, v75
    v_lshlrev_b32 v74, 16, v7
    v_and_b32 v75, 0xffff0000, v7
    v_sub_f32 v76, v76, v8
    v_sub_f32 v77, v77, v8
    v_cvt_pk_bf16_f32 v7, v76, v77
    v_lshlrev_b32 v76, 16, v7
    v_and_b32 v77, 0xffff0000, v7
    v_mul_f32 v76, v76, v10
    v_mul_f32 v77, v77, v10
    v_cvt_pk_bf16_f32 v7, v76, v77
    v_lshlrev_b32 v76, 16, v7
    v_and_b32 v77, 0xffff0000, v7
    v_sub_f32 v78, v78, v8
    v_sub_f32 v79, v79, v8
    v_cvt_pk_bf16_f32 v7, v78, v79
    v_lshlrev_b32 v78, 16, v7
    v_and_b32 v79, 0xffff0000, v7
    v_mul_f32 v78, v78, v10
    v_mul_f32 v79, v79, v10
    v_cvt_pk_bf16_f32 v7, v78, v79
    v_lshlrev_b32 v78, 16, v7
    v_and_b32 v79, 0xffff0000, v7
    v_sub_f32 v80, v80, v8
    v_sub_f32 v81, v81, v8
    v_cvt_pk_bf16_f32 v7, v80, v81
    v_lshlrev_b32 v80, 16, v7
    v_and_b32 v81, 0xffff0000, v7
    v_mul_f32 v80, v80, v10
    v_mul_f32 v81, v81, v10
    v_cvt_pk_bf16_f32 v7, v80, v81
    v_lshlrev_b32 v80, 16, v7
    v_and_b32 v81, 0xffff0000, v7
    v_sub_f32 v82, v82, v8
    v_sub_f32 v83, v83, v8
    v_cvt_pk_bf16_f32 v7, v82, v83
    v_lshlrev_b32 v82, 16, v7
    v_and_b32 v83, 0xffff0000, v7
    v_mul_f32 v82, v82, v10
    v_mul_f32 v83, v83, v10
    v_cvt_pk_bf16_f32 v7, v82, v83
    v_lshlrev_b32 v82, 16, v7
    v_and_b32 v83, 0xffff0000, v7
    v_lshlrev_b32 v84, 16, v26
    v_and_b32 v85, 0xffff0000, v26
    v_lshlrev_b32 v86, 16, v27
    v_and_b32 v87, 0xffff0000, v27
    v_lshlrev_b32 v88, 16, v28
    v_and_b32 v89, 0xffff0000, v28
    v_lshlrev_b32 v90, 16, v29
    v_and_b32 v91, 0xffff0000, v29
    v_lshlrev_b32 v92, 16, v30
    v_and_b32 v93, 0xffff0000, v30
    v_add_f32 v8, v84, v85
    v_add_f32 v8, v8, v86
    v_add_f32 v8, v8, v87
    v_add_f32 v8, v8, v88
    v_add_f32 v8, v8, v89
    v_add_f32 v8, v8, v90
    v_add_f32 v8, v8, v91
    v_add_f32 v8, v8, v92
    v_add_f32 v8, v8, v93
    s_nop 1
    v_add_f32_dpp v8, v8, v8 quad_perm:[1,0,3,2] row_mask:0xf bank_mask:0xf
    s_nop 1
    v_add_f32_dpp v8, v8, v8 quad_perm:[2,3,0,1] row_mask:0xf bank_mask:0xf
    s_nop 1
    v_add_f32_dpp v8, v8, v8 row_half_mirror row_mask:0xf bank_mask:0xf
    s_nop 1
    v_add_f32_dpp v8, v8, v8 row_mirror row_mask:0xf bank_mask:0xf
    v_mov_b32 v9, v8
    s_nop 1
    v_permlane16_swap_b32 v8, v9
    v_add_f32 v8, v8, v9
    v_mov_b32 v9, v8
    s_nop 1
    v_permlane32_swap_b32 v8, v9
    v_add_f32 v8, v8, v9
    v_mul_f32 v8, s32, v8
    v_mov_b32 v10, 0
    v_sub_f32 v9, v84, v8
    v_fmac_f32 v10, v9, v9
    v_sub_f32 v9, v85, v8
    v_fmac_f32 v10, v9, v9
    v_sub_f32 v9, v86, v8
    v_fmac_f32 v10, v9, v9
    v_sub_f32 v9, v87, v8
    v_fmac_f32 v10, v9, v9
    v_sub_f32 v9, v88, v8
    v_fmac_f32 v10, v9, v9
    v_sub_f32 v9, v89, v8
    v_fmac_f32 v10, v9, v9
    v_sub_f32 v9, v90, v8
    v_fmac_f32 v10, v9, v9
    v_sub_f32 v9, v91, v8
    v_fmac_f32 v10, v9, v9
    v_sub_f32 v9, v92, v8
    v_fmac_f32 v10, v9, v9
    v_sub_f32 v9, v93, v8
    v_fmac_f32 v10, v9, v9
    s_nop 1
    v_add_f32_dpp v10, v10, v10 quad_perm:[1,0,3,2] row_mask:0xf bank_mask:0xf
    s_nop 1
    v_add_f32_dpp v10, v10, v10 quad_perm:[2,3,0,1] row_mask:0xf bank_mask:0xf
    s_nop 1
    v_add_f32_dpp v10, v10, v10 row_half_mirror row_mask:0xf bank_mask:0xf
    s_nop 1
    v_add_f32_dpp v10, v10, v10 row_mirror row_mask:0xf bank_mask:0xf
    v_mov_b32 v9, v10
    s_nop 1
    v_permlane16_swap_b32 v10, v9
    v_add_f32 v10, v10, v9
    v_mov_b32 v9, v10
    s_nop 1
    v_permlane32_swap_b32 v10, v9
    v_add_f32 v10, v10, v9
    v_mul_f32 v10, s32, v10
    v_cvt_pk_bf16_f32 v7, v8, v10
    v_lshlrev_b32 v8, 16, v7
    v_and_b32 v10, 0xffff0000, v7
    v_add_f32 v10, s33, v10
    v_cvt_pk_bf16_f32 v7, v10, v9
    v_lshlrev_b32 v10, 16, v7
    v_and_b32 v9, 0xffff0000, v7
    v_sqrt_f32 v10, v10
    s_nop 0
    v_cvt_pk_bf16_f32 v7, v10, v9
    v_lshlrev_b32 v10, 16, v7
    v_and_b32 v9, 0xffff0000, v7
    v_rcp_f32 v10, v10
    v_sub_f32 v84, v84, v8
    v_sub_f32 v85, v85, v8
    v_cvt_pk_bf16_f32 v7, v84, v85
    v_lshlrev_b32 v84, 16, v7
    v_and_b32 v85, 0xffff0000, v7
    v_mul_f32 v84, v84, v10
    v_mul_f32 v85, v85, v10
    v_cvt_pk_bf16_f32 v7, v84, v85
    v_lshlrev_b32 v84, 16, v7
    v_and_b32 v85, 0xffff0000, v7
    v_sub_f32 v86, v86, v8
    v_sub_f32 v87, v87, v8
    v_cvt_pk_bf16_f32 v7, v86, v87
    v_lshlrev_b32 v86, 16, v7
    v_and_b32 v87, 0xffff0000, v7
    v_mul_f32 v86, v86, v10
    v_mul_f32 v87, v87, v10
    v_cvt_pk_bf16_f32 v7, v86, v87
    v_lshlrev_b32 v86, 16, v7
    v_and_b32 v87, 0xffff0000, v7
    v_sub_f32 v88, v88, v8
    v_sub_f32 v89, v89, v8
    v_cvt_pk_bf16_f32 v7, v88, v89
    v_lshlrev_b32 v88, 16, v7
    v_and_b32 v89, 0xffff0000, v7
    v_mul_f32 v88, v88, v10
    v_mul_f32 v89, v89, v10
    v_cvt_pk_bf16_f32 v7, v88, v89
    v_lshlrev_b32 v88, 16, v7
    v_and_b32 v89, 0xffff0000, v7
    v_sub_f32 v90, v90, v8
    v_sub_f32 v91, v91, v8
    v_cvt_pk_bf16_f32 v7, v90, v91
    v_lshlrev_b32 v90, 16, v7
    v_and_b32 v91, 0xffff0000, v7
    v_mul_f32 v90, v90, v10
    v_mul_f32 v91, v91, v10
    v_cvt_pk_bf16_f32 v7, v90, v91
    v_lshlrev_b32 v90, 16, v7
    v_and_b32 v91, 0xffff0000, v7
    v_sub_f32 v92, v92, v8
    v_sub_f32 v93, v93, v8
    v_cvt_pk_bf16_f32 v7, v92, v93
    v_lshlrev_b32 v92, 16, v7
    v_and_b32 v93, 0xffff0000, v7
    v_mul_f32 v92, v92, v10
    v_mul_f32 v93, v93, v10
    v_cvt_pk_bf16_f32 v7, v92, v93
    v_lshlrev_b32 v92, 16, v7
    v_and_b32 v93, 0xffff0000, v7
    v_lshlrev_b32 v94, 16, v31
    v_and_b32 v95, 0xffff0000, v31
    v_lshlrev_b32 v96, 16, v32
    v_and_b32 v97, 0xffff0000, v32
    v_lshlrev_b32 v98, 16, v33
    v_and_b32 v99, 0xffff0000, v33
    v_lshlrev_b32 v100, 16, v34
    v_and_b32 v101, 0xffff0000, v34
    v_lshlrev_b32 v102, 16, v35
    v_and_b32 v103, 0xffff0000, v35
    v_add_f32 v8, v94, v95
    v_add_f32 v8, v8, v96
    v_add_f32 v8, v8, v97
    v_add_f32 v8, v8, v98
    v_add_f32 v8, v8, v99
    v_add_f32 v8, v8, v100
    v_add_f32 v8, v8, v101
    v_add_f32 v8, v8, v102
    v_add_f32 v8, v8, v103
    s_nop 1
    v_add_f32_dpp v8, v8, v8 quad_perm:[1,0,3,2] row_mask:0xf bank_mask:0xf
    s_nop 1
    v_add_f32_dpp v8, v8, v8 quad_perm:[2,3,0,1] row_mask:0xf bank_mask:0xf
    s_nop 1
    v_add_f32_dpp v8, v8, v8 row_half_mirror row_mask:0xf bank_mask:0xf
    s_nop 1
    v_add_f32_dpp v8, v8, v8 row_mirror row_mask:0xf bank_mask:0xf
    v_mov_b32 v9, v8
    s_nop 1
    v_permlane16_swap_b32 v8, v9
    v_add_f32 v8, v8, v9
    v_mov_b32 v9, v8
    s_nop 1
    v_permlane32_swap_b32 v8, v9
    v_add_f32 v8, v8, v9
    v_mul_f32 v8, s32, v8
    v_mov_b32 v10, 0
    v_sub_f32 v9, v94, v8
    v_fmac_f32 v10, v9, v9
    v_sub_f32 v9, v95, v8
    v_fmac_f32 v10, v9, v9
    v_sub_f32 v9, v96, v8
    v_fmac_f32 v10, v9, v9
    v_sub_f32 v9, v97, v8
    v_fmac_f32 v10, v9, v9
    v_sub_f32 v9, v98, v8
    v_fmac_f32 v10, v9, v9
    v_sub_f32 v9, v99, v8
    v_fmac_f32 v10, v9, v9
    v_sub_f32 v9, v100, v8
    v_fmac_f32 v10, v9, v9
    v_sub_f32 v9, v101, v8
    v_fmac_f32 v10, v9, v9
    v_sub_f32 v9, v102, v8
    v_fmac_f32 v10, v9, v9
    v_sub_f32 v9, v103, v8
    v_fmac_f32 v10, v9, v9
    s_nop 1
    v_add_f32_dpp v10, v10, v10 quad_perm:[1,0,3,2] row_mask:0xf bank_mask:0xf
    s_nop 1
    v_add_f32_dpp v10, v10, v10 quad_perm:[2,3,0,1] row_mask:0xf bank_mask:0xf
    s_nop 1
    v_add_f32_dpp v10, v10, v10 row_half_mirror row_mask:0xf bank_mask:0xf
    s_nop 1
    v_add_f32_dpp v10, v10, v10 row_mirror row_mask:0xf bank_mask:0xf
    v_mov_b32 v9, v10
    s_nop 1
    v_permlane16_swap_b32 v10, v9
    v_add_f32 v10, v10, v9
    v_mov_b32 v9, v10
    s_nop 1
    v_permlane32_swap_b32 v10, v9
    v_add_f32 v10, v10, v9
    v_mul_f32 v10, s32, v10
    v_cvt_pk_bf16_f32 v7, v8, v10
    v_lshlrev_b32 v8, 16, v7
    v_and_b32 v10, 0xffff0000, v7
    v_add_f32 v10, s33, v10
    v_cvt_pk_bf16_f32 v7, v10, v9
    v_lshlrev_b32 v10, 16, v7
    v_and_b32 v9, 0xffff0000, v7
    v_sqrt_f32 v10, v10
    s_nop 0
    v_cvt_pk_bf16_f32 v7, v10, v9
    v_lshlrev_b32 v10, 16, v7
    v_and_b32 v9, 0xffff0000, v7
    v_rcp_f32 v10, v10
    v_sub_f32 v94, v94, v8
    v_sub_f32 v95, v95, v8
    v_cvt_pk_bf16_f32 v7, v94, v95
    v_lshlrev_b32 v94, 16, v7
    v_and_b32 v95, 0xffff0000, v7
    v_mul_f32 v94, v94, v10
    v_mul_f32 v95, v95, v10
    v_cvt_pk_bf16_f32 v7, v94, v95
    v_lshlrev_b32 v94, 16, v7
    v_and_b32 v95, 0xffff0000, v7
    v_sub_f32 v96, v96, v8
    v_sub_f32 v97, v97, v8
    v_cvt_pk_bf16_f32 v7, v96, v97
    v_lshlrev_b32 v96, 16, v7
    v_and_b32 v97, 0xffff0000, v7
    v_mul_f32 v96, v96, v10
    v_mul_f32 v97, v97, v10
    v_cvt_pk_bf16_f32 v7, v96, v97
    v_lshlrev_b32 v96, 16, v7
    v_and_b32 v97, 0xffff0000, v7
    v_sub_f32 v98, v98, v8
    v_sub_f32 v99, v99, v8
    v_cvt_pk_bf16_f32 v7, v98, v99
    v_lshlrev_b32 v98, 16, v7
    v_and_b32 v99, 0xffff0000, v7
    v_mul_f32 v98, v98, v10
    v_mul_f32 v99, v99, v10
    v_cvt_pk_bf16_f32 v7, v98, v99
    v_lshlrev_b32 v98, 16, v7
    v_and_b32 v99, 0xffff0000, v7
    v_sub_f32 v100, v100, v8
    v_sub_f32 v101, v101, v8
    v_cvt_pk_bf16_f32 v7, v100, v101
    v_lshlrev_b32 v100, 16, v7
    v_and_b32 v101, 0xffff0000, v7
    v_mul_f32 v100, v100, v10
    v_mul_f32 v101, v101, v10
    v_cvt_pk_bf16_f32 v7, v100, v101
    v_lshlrev_b32 v100, 16, v7
    v_and_b32 v101, 0xffff0000, v7
    v_sub_f32 v102, v102, v8
    v_sub_f32 v103, v103, v8
    v_cvt_pk_bf16_f32 v7, v102, v103
    v_lshlrev_b32 v102, 16, v7
    v_and_b32 v103, 0xffff0000, v7
    v_mul_f32 v102, v102, v10
    v_mul_f32 v103, v103, v10
    v_cvt_pk_bf16_f32 v7, v102, v103
    v_lshlrev_b32 v102, 16, v7
    v_and_b32 v103, 0xffff0000, v7
    s_cmp_lg_u32 s48, 1
    s_cbranch_scc1 wk_ln1_m
    s_cmp_lg_u32 s29, 0
    s_cbranch_scc1 wk_ln1_dw
    v_mov_b32 v2, 0
wk_ln1_sp:
    buffer_load_dword v3, v2, s[8:11], 0 offen sc1
    s_waitcnt vmcnt(0)
    v_readfirstlane_b32 s37, v3
    s_nop 0
    s_cmp_ge_u32 s37, 1
    s_cbranch_scc1 wk_ln1_dw
    s_sleep 4
    s_branch wk_ln1_sp
wk_ln1_dw:
    s_barrier
wk_ln1_m:
    v_lshlrev_b32 v3, 3, v1
    s_mov_b32 s34, 0
    s_mov_b32 s35, 2560
    buffer_load_dwordx2 v[16:17], v3, s[4:7], s34 offen offset:0 sc1
    buffer_load_dwordx2 v[26:27], v3, s[4:7], s35 offen offset:0 sc1
    buffer_load_dwordx2 v[18:19], v3, s[4:7], s34 offen offset:512 sc1
    buffer_load_dwordx2 v[28:29], v3, s[4:7], s35 offen offset:512 sc1
    buffer_load_dwordx2 v[20:21], v3, s[4:7], s34 offen offset:1024 sc1
    buffer_load_dwordx2 v[30:31], v3, s[4:7], s35 offen offset:1024 sc1
    buffer_load_dwordx2 v[22:23], v3, s[4:7], s34 offen offset:1536 sc1
    buffer_load_dwordx2 v[32:33], v3, s[4:7], s35 offen offset:1536 sc1
    buffer_load_dwordx2 v[24:25], v3, s[4:7], s34 offen offset:2048 sc1
    buffer_load_dwordx2 v[34:35], v3, s[4:7], s35 offen offset:2048 sc1
    v_bfe_u32 v5, v1, 1, 2
    v_bfe_u32 v6, v1, 3, 1
    v_and_b32 v12, 1, v1
    v_lshl_add_u32 v12, v6, 1, v12
    v_lshl_add_u32 v12, v5, 2, v12
    v_and_b32 v5, 16, v1
    v_add_u32 v12, v12, v5
    v_lshlrev_b32 v12, 2, v12
    v_lshrrev_b32 v5, 5, v1
    v_lshl_add_u32 v12, v5, 9, v12
    s_mul_i32 s38, s29, 5120
    v_add_u32 v12, s38, v12
    v_lshlrev_b32 v13, 4, v1
    v_add_u32 v14, s38, v13
    v_and_b32 v13, 0x1f0, v13
    v_lshl_add_u32 v13, v5, 12, v13
    s_lshr_b32 s30, s53, 1
    s_mul_i32 s30, s30, 40960
    s_and_b32 s31, s53, 1
    s_lshl_b32 s31, s31, 2
    s_add_u32 s31, s31, s29
    s_lshl_b32 s31, s31, 9
    s_add_u32 s30, s30, s31
    s_add_u32 s30, s30, 58720256
    s_waitcnt vmcnt(0)
    v_add_f32 v26, 1.0, v26
    v_add_f32 v27, 1.0, v27
    v_add_f32 v28, 1.0, v28
    v_add_f32 v29, 1.0, v29
    v_add_f32 v30, 1.0, v30
    v_add_f32 v31, 1.0, v31
    v_add_f32 v32, 1.0, v32
    v_add_f32 v33, 1.0, v33
    v_add_f32 v34, 1.0, v34
    v_add_f32 v35, 1.0, v35
    v_cvt_pk_bf16_f32 v7, v26, v27
    v_lshlrev_b32 v26, 16, v7
    v_and_b32 v27, 0xffff0000, v7
    v_cvt_pk_bf16_f32 v7, v28, v29
    v_lshlrev_b32 v28, 16, v7
    v_and_b32 v29, 0xffff0000, v7
    v_cvt_pk_bf16_f32 v7, v30, v31
    v_lshlrev_b32 v30, 16, v7
    v_and_b32 v31, 0xffff0000, v7
    v_cvt_pk_bf16_f32 v7, v32, v33
    v_lshlrev_b32 v32, 16, v7
    v_and_b32 v33, 0xffff0000, v7
    v_cvt_pk_bf16_f32 v7, v34, v35
    v_lshlrev_b32 v34, 16, v7
    v_and_b32 v35, 0xffff0000, v7
    v_pk_mul_f32 v[64:65], v[64:65], v[26:27]
    v_cvt_pk_bf16_f32 v7, v64, v65
    v_lshlrev_b32 v64, 16, v7
    v_and_b32 v65, 0xffff0000, v7
    v_pk_add_f32 v[64:65], v[64:65], v[16:17]
    v_cvt_pk_bf16_f32 v64, v64, v65
    ds_write_b32 v12, v64 offset:0
    v_pk_mul_f32 v[66:67], v[66:67], v[28:29]
    v_cvt_pk_bf16_f32 v7, v66, v67
    v_lshlrev_b32 v66, 16, v7
    v_and_b32 v67, 0xffff0000, v7
    v_pk_add_f32 v[66:67], v[66:67], v[18:19]
    v_cvt_pk_bf16_f32 v66, v66, v67
    ds_write_b32 v12, v66 offset:1024
    v_pk_mul_f32 v[68:69], v[68:69], v[30:31]
    v_cvt_pk_bf16_f32 v7, v68, v69
    v_lshlrev_b32 v68, 16, v7
    v_and_b32 v69, 0xffff0000, v7
    v_pk_add_f32 v[68:69], v[68:69], v[20:21]
    v_cvt_pk_bf16_f32 v68, v68, v69
    ds_write_b32 v12, v68 offset:2048
    v_pk_mul_f32 v[70:71], v[70:71], v[32:33]
    v_cvt_pk_bf16_f32 v7, v70, v71
    v_lshlrev_b32 v70, 16, v7
    v_and_b32 v71, 0xffff0000, v7
    v_pk_add_f32 v[70:71], v[70:71], v[22:23]
    v_cvt_pk_bf16_f32 v70, v70, v71
    ds_write_b32 v12, v70 offset:3072
    v_pk_mul_f32 v[72:73], v[72:73], v[34:35]
    v_cvt_pk_bf16_f32 v7, v72, v73
    v_lshlrev_b32 v72, 16, v7
    v_and_b32 v73, 0xffff0000, v7
    v_pk_add_f32 v[72:73], v[72:73], v[24:25]
    v_cvt_pk_bf16_f32 v72, v72, v73
    ds_write_b32 v12, v72 offset:4096
    v_pk_mul_f32 v[74:75], v[74:75], v[26:27]
    v_cvt_pk_bf16_f32 v7, v74, v75
    v_lshlrev_b32 v74, 16, v7
    v_and_b32 v75, 0xffff0000, v7
    v_pk_add_f32 v[74:75], v[74:75], v[16:17]
    v_cvt_pk_bf16_f32 v74, v74, v75
    ds_write_b32 v12, v74 offset:128
    v_pk_mul_f32 v[76:77], v[76:77], v[28:29]
    v_cvt_pk_bf16_f32 v7, v76, v77
    v_lshlrev_b32 v76, 16, v7
    v_and_b32 v77, 0xffff0000, v7
    v_pk_add_f32 v[76:77], v[76:77], v[18:19]
    v_cvt_pk_bf16_f32 v76, v76, v77
    ds_write_b32 v12, v76 offset:1152
    v_pk_mul_f32 v[78:79], v[78:79], v[30:31]
    v_cvt_pk_bf16_f32 v7, v78, v79
    v_lshlrev_b32 v78, 16, v7
    v_and_b32 v79, 0xffff0000, v7
    v_pk_add_f32 v[78:79], v[78:79], v[20:21]
    v_cvt_pk_bf16_f32 v78, v78, v79
    ds_write_b32 v12, v78 offset:2176
    v_pk_mul_f32 v[80:81], v[80:81], v[32:33]
    v_cvt_pk_bf16_f32 v7, v80, v81
    v_lshlrev_b32 v80, 16, v7
    v_and_b32 v81, 0xffff0000, v7
    v_pk_add_f32 v[80:81], v[80:81], v[22:23]
    v_cvt_pk_bf16_f32 v80, v80, v81
    ds_write_b32 v12, v80 offset:3200
    v_pk_mul_f32 v[82:83], v[82:83], v[34:35]
    v_cvt_pk_bf16_f32 v7, v82, v83
    v_lshlrev_b32 v82, 16, v7
    v_and_b32 v83, 0xffff0000, v7
    v_pk_add_f32 v[82:83], v[82:83], v[24:25]
    v_cvt_pk_bf16_f32 v82, v82, v83
    ds_write_b32 v12, v82 offset:4224
    v_pk_mul_f32 v[84:85], v[84:85], v[26:27]
    v_cvt_pk_bf16_f32 v7, v84, v85
    v_lshlrev_b32 v84, 16, v7
    v_and_b32 v85, 0xffff0000, v7
    v_pk_add_f32 v[84:85], v[84:85], v[16:17]
    v_cvt_pk_bf16_f32 v84, v84, v85
    ds_write_b32 v12, v84 offset:256
    v_pk_mul_f32 v[86:87], v[86:87], v[28:29]
    v_cvt_pk_bf16_f32 v7, v86, v87
    v_lshlrev_b32 v86, 16, v7
    v_and_b32 v87, 0xffff0000, v7
    v_pk_add_f32 v[86:87], v[86:87], v[18:19]
    v_cvt_pk_bf16_f32 v86, v86, v87
    ds_write_b32 v12, v86 offset:1280
    v_pk_mul_f32 v[88:89], v[88:89], v[30:31]
    v_cvt_pk_bf16_f32 v7, v88, v89
    v_lshlrev_b32 v88, 16, v7
    v_and_b32 v89, 0xffff0000, v7
    v_pk_add_f32 v[88:89], v[88:89], v[20:21]
    v_cvt_pk_bf16_f32 v88, v88, v89
    ds_write_b32 v12, v88 offset:2304
    v_pk_mul_f32 v[90:91], v[90:91], v[32:33]
    v_cvt_pk_bf16_f32 v7, v90, v91
    v_lshlrev_b32 v90, 16, v7
    v_and_b32 v91, 0xffff0000, v7
    v_pk_add_f32 v[90:91], v[90:91], v[22:23]
    v_cvt_pk_bf16_f32 v90, v90, v91
    ds_write_b32 v12, v90 offset:3328
    v_pk_mul_f32 v[92:93], v[92:93], v[34:35]
    v_cvt_pk_bf16_f32 v7, v92, v93
    v_lshlrev_b32 v92, 16, v7
    v_and_b32 v93, 0xffff0000, v7
    v_pk_add_f32 v[92:93], v[92:93], v[24:25]
    v_cvt_pk_bf16_f32 v92, v92, v93
    ds_write_b32 v12, v92 offset:4352
    v_pk_mul_f32 v[94:95], v[94:95], v[26:27]
    v_cvt_pk_bf16_f32 v7, v94, v95
    v_lshlrev_b32 v94, 16, v7
    v_and_b32 v95, 0xffff0000, v7
    v_pk_add_f32 v[94:95], v[94:95], v[16:17]
    v_cvt_pk_bf16_f32 v94, v94, v95
    ds_write_b32 v12, v94 offset:384
    v_pk_mul_f32 v[96:97], v[96:97], v[28:29]
    v_cvt_pk_bf16_f32 v7, v96, v97
    v_lshlrev_b32 v96, 16, v7
    v_and_b32 v97, 0xffff0000, v7
    v_pk_add_f32 v[96:97], v[96:97], v[18:19]
    v_cvt_pk_bf16_f32 v96, v96, v97
    ds_write_b32 v12, v96 offset:1408
    v_pk_mul_f32 v[98:99], v[98:99], v[30:31]
    v_cvt_pk_bf16_f32 v7, v98, v99
    v_lshlrev_b32 v98, 16, v7
    v_and_b32 v99, 0xffff0000, v7
    v_pk_add_f32 v[98:99], v[98:99], v[20:21]
    v_cvt_pk_bf16_f32 v98, v98, v99
    ds_write_b32 v12, v98 offset:2432
    v_pk_mul_f32 v[100:101], v[100:101], v[32:33]
    v_cvt_pk_bf16_f32 v7, v100, v101
    v_lshlrev_b32 v100, 16, v7
    v_and_b32 v101, 0xffff0000, v7
    v_pk_add_f32 v[100:101], v[100:101], v[22:23]
    v_cvt_pk_bf16_f32 v100, v100, v101
    ds_write_b32 v12, v100 offset:3456
    v_pk_mul_f32 v[102:103], v[102:103], v[34:35]
    v_cvt_pk_bf16_f32 v7, v102, v103
    v_lshlrev_b32 v102, 16, v7
    v_and_b32 v103, 0xffff0000, v7
    v_pk_add_f32 v[102:103], v[102:103], v[24:25]
    v_cvt_pk_bf16_f32 v102, v102, v103
    ds_write_b32 v12, v102 offset:4480
    s_waitcnt lgkmcnt(0)
    ds_read_b128 v[16:19], v14 offset:0
    ds_read_b128 v[20:23], v14 offset:1024
    ds_read_b128 v[24:27], v14 offset:2048
    ds_read_b128 v[28:31], v14 offset:3072
    ds_read_b128 v[32:35], v14 offset:4096
    s_waitcnt lgkmcnt(0)
    buffer_store_dwordx4 v[16:19], v13, s[4:7], s30 offen sc1
    s_add_u32 s30, s30, 8192
    buffer_store_dwordx4 v[20:23], v13, s[4:7], s30 offen sc1
    s_add_u32 s30, s30, 8192
    buffer_store_dwordx4 v[24:27], v13, s[4:7], s30 offen sc1
    s_add_u32 s30, s30, 8192
    buffer_store_dwordx4 v[28:31], v13, s[4:7], s30 offen sc1
    s_add_u32 s30, s30, 8192
    buffer_store_dwordx4 v[32:35], v13, s[4:7], s30 offen sc1
    s_add_u32 s30, s30, 8192
    s_lshr_b32 s52, s53, 3
    s_waitcnt vmcnt(0) lgkmcnt(0)
    s_barrier
    s_cmp_lg_u32 s29, 0
    s_cbranch_scc1 wk_ln1_sg
    s_lshl_b32 s38, s52, 7
    s_add_u32 s38, s38, 49280
    v_mov_b32 v2, 0
    v_mov_b32 v3, 1
    s_mov_b64 exec, 1
    buffer_atomic_add v3, v2, s[4:7], s38 offen
    s_mov_b64 exec, -1
wk_ln1_sg:
    s_getpc_b64 s[44:45]
Lbj2:
    s_add_u32 s44, s44, wk_loop-Lbj2
    s_addc_u32 s45, s45, -1
    s_setpc_b64 s[44:45]
wk_att:
    s_lshl_b32 s49, s49, 3
    s_add_u32 s49, s49, s53
    s_add_u32 s54, s49, 0
    s_and_b32 s37, s54, 0xfff8
    s_max_u32 s37, s37, 128
    s_sub_u32 s37, s37, 128
    s_add_u32 s54, s54, s37
    s_lshl_b32 s37, s3, 3
    s_add_u32 s54, s54, s37
    s_mov_b32 s50, s54
    v_and_b32 v2, 15, v1
    v_lshrrev_b32 v3, 4, v1
    v_lshlrev_b32 v4, 4, v3
    v_lshl_add_u32 v4, v2, 6, v4
    v_lshlrev_b32 v5, 4, v1
    v_lshlrev_b32 v6, 3, v1
    v_bfe_u32 v10, v1, 2, 2
    v_lshl_add_u32 v10, v3, 2, v10
    v_and_b32 v11, 1, v1
    v_lshlrev_b32 v11, 3, v11
    v_lshl_add_u32 v10, v10, 4, v11
    s_lshl_b32 s38, s29, 11
    v_add_u32 v10, s38, v10
    v_lshlrev_b32 v7, 2, v3
    v_add_u32 v8, 0, v7
    v_cmp_le_u32 s[88:89], v8, v2
    v_add_u32 v8, 1, v7
    v_cmp_le_u32 s[90:91], v8, v2
    v_add_u32 v8, 2, v7
    v_cmp_le_u32 s[92:93], v8, v2
    v_add_u32 v8, 3, v7
    v_cmp_le_u32 s[94:95], v8, v2
    s_mov_b32 s96, -1
    s_mov_b32 s97, 0
    s_mov_b32 s98, 0x3e0293ee
    s_mov_b32 s99, 0x3e0293ee
    v_mov_b32 v40, 0x3f803f80
    v_mov_b32 v41, 0x3f803f80
    v_mov_b32 v42, 0x3f803f80
    v_mov_b32 v43, 0x3f803f80
    v_mov_b32 v44, 0xf149f2ca
    v_mov_b32 v213, 0
    v_mov_b32 v214, 0
    v_lshlrev_b32 v9, 4, v3
    v_lshl_add_u32 v9, v2, 6, v9
    s_mov_b32 s56, -1
    s_mov_b32 s55, s50
    s_cmp_ge_u32 s55, 512
    s_cbranch_scc1 wk_att_p_nl
    s_lshr_b32 s59, s55, 3
    s_cmp_eq_u32 s59, s56
    s_cbranch_scc1 wk_att_p_rdy
    s_cmp_lg_u32 s29, 0
    s_cbranch_scc1 wk_att_p_dw
    s_lshl_b32 s38, s59, 7
    v_mov_b32 v2, 0
    s_add_u32 s39, s38, 303104
wk_att_p_sp0:
    buffer_load_dword v3, v2, s[4:7], s39 offen sc1
    s_waitcnt vmcnt(0)
    v_readfirstlane_b32 s37, v3
    s_nop 0
    s_cmp_ge_u32 s37, 32
    s_cbranch_scc1 wk_att_p_ok0
    s_sleep 6
    s_branch wk_att_p_sp0
wk_att_p_ok0:
    s_add_u32 s39, s38, 311296
wk_att_p_sp1:
    buffer_load_dword v3, v2, s[4:7], s39 offen sc1
    s_waitcnt vmcnt(0)
    v_readfirstlane_b32 s37, v3
    s_nop 0
    s_cmp_ge_u32 s37, 16
    s_cbranch_scc1 wk_att_p_ok1
    s_sleep 6
    s_branch wk_att_p_sp1
wk_att_p_ok1:
wk_att_p_dw:
    s_barrier
    s_mov_b32 s56, s59
wk_att_p_rdy:
    s_lshl_b32 s31, s55, 2
    s_add_u32 s31, s31, s29
    s_lshl_b32 s32, s31, 13
    s_add_u32 s33, s32, 92274688
    s_add_u32 s34, s33, 4096
    s_add_u32 s35, s32, 16777216
    s_add_u32 s36, s35, 4096
    buffer_load_dwordx4 a[0:3], v4, s[4:7], s33 offen offset:0 sc1
    buffer_load_dwordx4 a[32:35], v4, s[4:7], s35 offen offset:0 sc1
    buffer_load_dwordx4 a[16:19], v4, s[4:7], s33 offen offset:1024 sc1
    buffer_load_dwordx4 a[48:51], v4, s[4:7], s35 offen offset:1024 sc1
    buffer_load_dwordx4 a[4:7], v4, s[4:7], s33 offen offset:2048 sc1
    buffer_load_dwordx4 a[36:39], v4, s[4:7], s35 offen offset:2048 sc1
    buffer_load_dwordx4 a[20:23], v4, s[4:7], s33 offen offset:3072 sc1
    buffer_load_dwordx4 a[52:55], v4, s[4:7], s35 offen offset:3072 sc1
    buffer_load_dwordx4 a[8:11], v4, s[4:7], s34 offen offset:0 sc1
    buffer_load_dwordx4 a[40:43], v4, s[4:7], s36 offen offset:0 sc1
    buffer_load_dwordx4 a[24:27], v4, s[4:7], s34 offen offset:1024 sc1
    buffer_load_dwordx4 a[56:59], v4, s[4:7], s36 offen offset:1024 sc1
    buffer_load_dwordx4 a[12:15], v4, s[4:7], s34 offen offset:2048 sc1
    buffer_load_dwordx4 a[44:47], v4, s[4:7], s36 offen offset:2048 sc1
    buffer_load_dwordx4 a[28:31], v4, s[4:7], s34 offen offset:3072 sc1
    buffer_load_dwordx4 a[60:63], v4, s[4:7], s36 offen offset:3072 sc1
    s_add_u32 s39, s32, 33554432
    s_add_u32 s40, s39, 4096
    buffer_load_dwordx4 a[64:67], v5, s[4:7], s39 offen offset:0 sc1
    buffer_load_dwordx4 a[68:71], v5, s[4:7], s39 offen offset:1024 sc1
    buffer_load_dwordx4 a[72:75], v5, s[4:7], s39 offen offset:2048 sc1
    buffer_load_dwordx4 a[76:79], v5, s[4:7], s39 offen offset:3072 sc1
    buffer_load_dwordx4 a[80:83], v5, s[4:7], s40 offen offset:0 sc1
    buffer_load_dwordx4 a[84:87], v5, s[4:7], s40 offen offset:1024 sc1
    buffer_load_dwordx4 a[88:91], v5, s[4:7], s40 offen offset:2048 sc1
    buffer_load_dwordx4 a[92:95], v5, s[4:7], s40 offen offset:3072 sc1
wk_att_p_nl:
    s_waitcnt vmcnt(0)
wk_att0_top:
    v_mfma_f32_16x16x32_bf16 v[144:147], a[32:35], a[0:3], 0
    v_mfma_f32_16x16x32_bf16 v[156:159], a[32:35], a[16:19], 0
    v_mfma_f32_16x16x32_bf16 v[160:163], a[48:51], a[16:19], 0
    v_mfma_f32_16x16x32_bf16 v[144:147], a[36:39], a[4:7], v[144:147]
    v_mfma_f32_16x16x32_bf16 v[156:159], a[36:39], a[20:23], v[156:159]
    v_mfma_f32_16x16x32_bf16 v[160:163], a[52:55], a[20:23], v[160:163]
    v_mfma_f32_16x16x32_bf16 v[144:147], a[40:43], a[8:11], v[144:147]
    v_mfma_f32_16x16x32_bf16 v[156:159], a[40:43], a[24:27], v[156:159]
    v_mfma_f32_16x16x32_bf16 v[160:163], a[56:59], a[24:27], v[160:163]
    v_mfma_f32_16x16x32_bf16 v[144:147], a[44:47], a[12:15], v[144:147]
    v_mfma_f32_16x16x32_bf16 v[156:159], a[44:47], a[28:31], v[156:159]
    v_mfma_f32_16x16x32_bf16 v[160:163], a[60:63], a[28:31], v[160:163]
    v_mov_b32 v210, 0
    v_mov_b32 v211, 0
    s_nop 3
    v_cndmask_b32 v144, v44, v144, s[88:89]
    v_cndmask_b32 v145, v44, v145, s[90:91]
    v_cndmask_b32 v146, v44, v146, s[92:93]
    v_cndmask_b32 v147, v44, v147, s[94:95]
    v_cndmask_b32 v160, v44, v160, s[88:89]
    v_cndmask_b32 v161, v44, v161, s[90:91]
    v_cndmask_b32 v162, v44, v162, s[92:93]
    v_cndmask_b32 v163, v44, v163, s[94:95]
    s_lshr_b32 s52, s54, 3
    s_and_b32 s58, s54, 7
    s_lshr_b32 s58, s58, 1
    s_lshl_b32 s58, s58, 4
    s_add_u32 s50, s49, 11
    s_and_b32 s37, s50, 0xfff8
    s_max_u32 s37, s37, 128
    s_sub_u32 s37, s37, 128
    s_add_u32 s50, s50, s37
    s_lshl_b32 s37, s3, 3
    s_add_u32 s50, s50, s37
    s_min_u32 s55, s50, 511
    s_lshr_b32 s59, s55, 3
    s_cmp_eq_u32 s59, s56
    s_cbranch_scc1 wk_att0_r2
    s_cmp_lg_u32 s29, 0
    s_cbranch_scc1 wk_att0_c_dw
    s_lshl_b32 s38, s59, 7
    v_mov_b32 v2, 0
    s_add_u32 s39, s38, 303104
wk_att0_c_sp0:
    buffer_load_dword v3, v2, s[4:7], s39 offen sc1
    s_waitcnt vmcnt(0)
    v_readfirstlane_b32 s37, v3
    s_nop 0
    s_cmp_ge_u32 s37, 32
    s_cbranch_scc1 wk_att0_c_ok0
    s_sleep 6
    s_branch wk_att0_c_sp0
wk_att0_c_ok0:
    s_add_u32 s39, s38, 311296
wk_att0_c_sp1:
    buffer_load_dword v3, v2, s[4:7], s39 offen sc1
    s_waitcnt vmcnt(0)
    v_readfirstlane_b32 s37, v3
    s_nop 0
    s_cmp_ge_u32 s37, 16
    s_cbranch_scc1 wk_att0_c_ok1
    s_sleep 6
    s_branch wk_att0_c_sp1
wk_att0_c_ok1:
wk_att0_c_dw:
    s_barrier
    s_mov_b32 s56, s59
wk_att0_r2:
    s_lshl_b32 s31, s54, 2
    s_add_u32 s31, s31, s29
    s_lshl_b32 s43, s31, 12
    s_add_u32 s43, s43, 50331648
    s_lshl_b32 s41, s52, 18
    s_and_b32 s42, s31, 31
    s_lshl_b32 s42, s42, 12
    s_add_u32 s41, s41, s42
    s_add_u32 s41, s41, 67108864
    s_add_u32 s42, s41, 131072
    s_cmp_lg_u32 s29, 0
    s_cbranch_scc1 wk_att02_dw
    s_lshl_b32 s39, s52, 7
    s_add_u32 s39, s39, 262144
    v_mov_b32 v2, 0
wk_att02_sp:
    buffer_load_dword v3, v2, s[4:7], s39 offen sc1
    s_waitcnt vmcnt(0)
    v_readfirstlane_b32 s37, v3
    s_nop 0
    s_cmp_ge_u32 s37, 32
    s_cbranch_scc1 wk_att02_dw
    s_sleep 6
    s_branch wk_att02_sp
wk_att02_dw:
    s_barrier
    s_lshl_b32 m0, s29, 11
    s_nop 0
    buffer_load_dwordx4 v5, s[4:7], s43 offen sc1 lds
    buffer_load_dwordx4 v5, s[4:7], s43 offen offset:1024 sc1 lds
    buffer_load_dwordx2 v[32:33], v6, s[4:7], s43 offen offset:2048 sc1
    buffer_load_dwordx2 v[34:35], v6, s[4:7], s43 offen offset:2560 sc1
    buffer_load_dwordx2 v[36:37], v6, s[4:7], s43 offen offset:3072 sc1
    buffer_load_dwordx2 v[38:39], v6, s[4:7], s43 offen offset:3584 sc1
    s_waitcnt vmcnt(4)
    ds_read_b64_tr_b16 v[16:17], v10 offset:0
    ds_read_b64_tr_b16 v[18:19], v10 offset:256
    ds_read_b64_tr_b16 v[20:21], v10 offset:512
    ds_read_b64_tr_b16 v[22:23], v10 offset:768
    ds_read_b64_tr_b16 v[24:25], v10 offset:1024
    ds_read_b64_tr_b16 v[26:27], v10 offset:1280
    ds_read_b64_tr_b16 v[28:29], v10 offset:1536
    ds_read_b64_tr_b16 v[30:31], v10 offset:1792
    s_waitcnt vmcnt(0)
    s_mov_b32 s55, s50
    s_cmp_ge_u32 s55, 512
    s_cbranch_scc1 wk_att0_n_nl
    s_lshr_b32 s59, s55, 3
    s_cmp_eq_u32 s59, s56
    s_cbranch_scc1 wk_att0_n_rdy
    s_cmp_lg_u32 s29, 0
    s_cbranch_scc1 wk_att0_n_dw
    s_lshl_b32 s38, s59, 7
    v_mov_b32 v2, 0
    s_add_u32 s39, s38, 303104
wk_att0_n_sp0:
    buffer_load_dword v3, v2, s[4:7], s39 offen sc1
    s_waitcnt vmcnt(0)
    v_readfirstlane_b32 s37, v3
    s_nop 0
    s_cmp_ge_u32 s37, 32
    s_cbranch_scc1 wk_att0_n_ok0
    s_sleep 6
    s_branch wk_att0_n_sp0
wk_att0_n_ok0:
    s_add_u32 s39, s38, 311296
wk_att0_n_sp1:
    buffer_load_dword v3, v2, s[4:7], s39 offen sc1
    s_waitcnt vmcnt(0)
    v_readfirstlane_b32 s37, v3
    s_nop 0
    s_cmp_ge_u32 s37, 16
    s_cbranch_scc1 wk_att0_n_ok1
    s_sleep 6
    s_branch wk_att0_n_sp1
wk_att0_n_ok1:
wk_att0_n_dw:
    s_barrier
    s_mov_b32 s56, s59
wk_att0_n_rdy:
    s_lshl_b32 s31, s55, 2
    s_add_u32 s31, s31, s29
    s_lshl_b32 s32, s31, 13
    s_add_u32 s33, s32, 92274688
    s_add_u32 s34, s33, 4096
    s_add_u32 s35, s32, 16777216
    s_add_u32 s36, s35, 4096
    buffer_load_dwordx4 a[96:99], v4, s[4:7], s33 offen offset:0 sc1
    buffer_load_dwordx4 a[128:131], v4, s[4:7], s35 offen offset:0 sc1
    buffer_load_dwordx4 a[112:115], v4, s[4:7], s33 offen offset:1024 sc1
    buffer_load_dwordx4 a[144:147], v4, s[4:7], s35 offen offset:1024 sc1
    buffer_load_dwordx4 a[100:103], v4, s[4:7], s33 offen offset:2048 sc1
    buffer_load_dwordx4 a[132:135], v4, s[4:7], s35 offen offset:2048 sc1
    buffer_load_dwordx4 a[116:119], v4, s[4:7], s33 offen offset:3072 sc1
    buffer_load_dwordx4 a[148:151], v4, s[4:7], s35 offen offset:3072 sc1
    buffer_load_dwordx4 a[104:107], v4, s[4:7], s34 offen offset:0 sc1
    buffer_load_dwordx4 a[136:139], v4, s[4:7], s36 offen offset:0 sc1
    buffer_load_dwordx4 a[120:123], v4, s[4:7], s34 offen offset:1024 sc1
    buffer_load_dwordx4 a[152:155], v4, s[4:7], s36 offen offset:1024 sc1
    buffer_load_dwordx4 a[108:111], v4, s[4:7], s34 offen offset:2048 sc1
    buffer_load_dwordx4 a[140:143], v4, s[4:7], s36 offen offset:2048 sc1
    buffer_load_dwordx4 a[124:127], v4, s[4:7], s34 offen offset:3072 sc1
    buffer_load_dwordx4 a[156:159], v4, s[4:7], s36 offen offset:3072 sc1
    s_add_u32 s39, s32, 33554432
    s_add_u32 s40, s39, 4096
    buffer_load_dwordx4 a[160:163], v5, s[4:7], s39 offen offset:0 sc1
    buffer_load_dwordx4 a[164:167], v5, s[4:7], s39 offen offset:1024 sc1
    buffer_load_dwordx4 a[168:171], v5, s[4:7], s39 offen offset:2048 sc1
    buffer_load_dwordx4 a[172:175], v5, s[4:7], s39 offen offset:3072 sc1
    buffer_load_dwordx4 a[176:179], v5, s[4:7], s40 offen offset:0 sc1
    buffer_load_dwordx4 a[180:183], v5, s[4:7], s40 offen offset:1024 sc1
    buffer_load_dwordx4 a[184:187], v5, s[4:7], s40 offen offset:2048 sc1
    buffer_load_dwordx4 a[188:191], v5, s[4:7], s40 offen offset:3072 sc1
wk_att0_n_nl:
    s_waitcnt lgkmcnt(0)
    v_mfma_f32_16x16x32_bf16 v[152:155], v[16:19], a[0:3], 0
    v_mfma_f32_16x16x32_bf16 v[164:167], v[16:19], a[16:19], 0
    v_mfma_f32_16x16x32_bf16 v[152:155], v[20:23], a[4:7], v[152:155]
    v_mfma_f32_16x16x32_bf16 v[164:167], v[20:23], a[20:23], v[164:167]
    v_mfma_f32_16x16x32_bf16 v[152:155], v[24:27], a[8:11], v[152:155]
    v_mfma_f32_16x16x32_bf16 v[164:167], v[24:27], a[24:27], v[164:167]
    v_mfma_f32_16x16x32_bf16 v[152:155], v[28:31], a[12:15], v[152:155]
    v_mfma_f32_16x16x32_bf16 v[164:167], v[28:31], a[28:31], v[164:167]
    s_nop 6
    v_cndmask_b32 v152, v154, v152, s[96:97]
    v_cndmask_b32 v153, v155, v153, s[96:97]
    v_max3_f32 v204, v144, v145, v146
    v_max3_f32 v204, v204, v147, v152
    v_max_f32 v204, v204, v153
    v_mov_b32 v205, v204
    s_nop 1
    v_permlane32_swap_b32 v204, v205
    v_max_f32 v204, v204, v205
    v_mov_b32 v205, v204
    s_nop 1
    v_permlane16_swap_b32 v204, v205
    v_max_f32 v204, v204, v205
    v_mul_f32 v204, s98, v204
    v_pk_fma_f32 v[144:145], v[144:145], s[98:99], v[204:205] op_sel_hi:[1,1,0] neg_lo:[0,0,1] neg_hi:[0,0,1]
    v_pk_fma_f32 v[146:147], v[146:147], s[98:99], v[204:205] op_sel_hi:[1,1,0] neg_lo:[0,0,1] neg_hi:[0,0,1]
    v_pk_fma_f32 v[152:153], v[152:153], s[98:99], v[204:205] op_sel_hi:[1,1,0] neg_lo:[0,0,1] neg_hi:[0,0,1]
    v_exp_f32 v144, v144
    v_exp_f32 v145, v145
    v_exp_f32 v146, v146
    v_exp_f32 v147, v147
    v_exp_f32 v152, v152
    v_exp_f32 v153, v153
    v_cvt_pk_bf16_f32 v208, v144, v145
    v_cvt_pk_bf16_f32 v209, v146, v147
    v_cvt_pk_bf16_f32 v212, v152, v153
    v_cvt_pk_bf16_f32 v215, v152, v153
    v_mfma_f32_16x16x32_bf16 v[200:203], v[40:43], v[208:211], 0
    v_mfma_f32_16x16x32_bf16 v[168:171], a[64:67], v[208:211], 0
    v_mfma_f32_16x16x32_bf16 v[172:175], a[68:71], v[208:211], 0
    v_mfma_f32_16x16x32_bf16 v[176:179], a[72:75], v[208:211], 0
    v_mfma_f32_16x16x32_bf16 v[180:183], a[76:79], v[208:211], 0
    v_mfma_f32_16x16x32_bf16 v[184:187], a[80:83], v[208:211], 0
    v_mfma_f32_16x16x32_bf16 v[188:191], a[84:87], v[208:211], 0
    v_mfma_f32_16x16x32_bf16 v[192:195], a[88:91], v[208:211], 0
    v_mfma_f32_16x16x32_bf16 v[196:199], a[92:95], v[208:211], 0
    v_mfma_f32_16x16x16_bf16 v[200:203], v[40:41], v[212:213], v[200:203]
    v_mfma_f32_16x16x16_bf16 v[168:171], v[32:33], v[212:213], v[168:171]
    v_mfma_f32_16x16x16_bf16 v[172:175], v[32:33], v[214:215], v[172:175]
    v_mfma_f32_16x16x16_bf16 v[176:179], v[34:35], v[212:213], v[176:179]
    v_mfma_f32_16x16x16_bf16 v[180:183], v[34:35], v[214:215], v[180:183]
    v_mfma_f32_16x16x16_bf16 v[184:187], v[36:37], v[212:213], v[184:187]
    v_mfma_f32_16x16x16_bf16 v[188:191], v[36:37], v[214:215], v[188:191]
    v_mfma_f32_16x16x16_bf16 v[192:195], v[38:39], v[212:213], v[192:195]
    v_mfma_f32_16x16x16_bf16 v[196:199], v[38:39], v[214:215], v[196:199]
    v_rcp_f32 v204, v200
    s_nop 0
    v_pk_mul_f32 v[168:169], v[168:169], v[204:205] op_sel_hi:[1,0]
    v_pk_mul_f32 v[170:171], v[170:171], v[204:205] op_sel_hi:[1,0]
    v_pk_mul_f32 v[172:173], v[172:173], v[204:205] op_sel_hi:[1,0]
    v_pk_mul_f32 v[174:175], v[174:175], v[204:205] op_sel_hi:[1,0]
    v_cvt_pk_bf16_f32 v72, v168, v169
    v_cvt_pk_bf16_f32 v73, v170, v171
    v_cvt_pk_bf16_f32 v74, v172, v173
    v_cvt_pk_bf16_f32 v75, v174, v175
    buffer_store_dwordx4 v[72:75], v9, s[4:7], s41 offen offset:0 sc1
    v_pk_mul_f32 v[176:177], v[176:177], v[204:205] op_sel_hi:[1,0]
    v_pk_mul_f32 v[178:179], v[178:179], v[204:205] op_sel_hi:[1,0]
    v_pk_mul_f32 v[180:181], v[180:181], v[204:205] op_sel_hi:[1,0]
    v_pk_mul_f32 v[182:183], v[182:183], v[204:205] op_sel_hi:[1,0]
    v_cvt_pk_bf16_f32 v76, v176, v177
    v_cvt_pk_bf16_f32 v77, v178, v179
    v_cvt_pk_bf16_f32 v78, v180, v181
    v_cvt_pk_bf16_f32 v79, v182, v183
    buffer_store_dwordx4 v[76:79], v9, s[4:7], s41 offen offset:1024 sc1
    v_pk_mul_f32 v[184:185], v[184:185], v[204:205] op_sel_hi:[1,0]
    v_pk_mul_f32 v[186:187], v[186:187], v[204:205] op_sel_hi:[1,0]
    v_pk_mul_f32 v[188:189], v[188:189], v[204:205] op_sel_hi:[1,0]
    v_pk_mul_f32 v[190:191], v[190:191], v[204:205] op_sel_hi:[1,0]
    v_cvt_pk_bf16_f32 v80, v184, v185
    v_cvt_pk_bf16_f32 v81, v186, v187
    v_cvt_pk_bf16_f32 v82, v188, v189
    v_cvt_pk_bf16_f32 v83, v190, v191
    buffer_store_dwordx4 v[80:83], v9, s[4:7], s41 offen offset:2048 sc1
    v_pk_mul_f32 v[192:193], v[192:193], v[204:205] op_sel_hi:[1,0]
    v_pk_mul_f32 v[194:195], v[194:195], v[204:205] op_sel_hi:[1,0]
    v_pk_mul_f32 v[196:197], v[196:197], v[204:205] op_sel_hi:[1,0]
    v_pk_mul_f32 v[198:199], v[198:199], v[204:205] op_sel_hi:[1,0]
    v_cvt_pk_bf16_f32 v84, v192, v193
    v_cvt_pk_bf16_f32 v85, v194, v195
    v_cvt_pk_bf16_f32 v86, v196, v197
    v_cvt_pk_bf16_f32 v87, v198, v199
    buffer_store_dwordx4 v[84:87], v9, s[4:7], s41 offen offset:3072 sc1
    v_cndmask_b32 v164, v166, v164, s[96:97]
    v_cndmask_b32 v165, v167, v165, s[96:97]
    v_max3_f32 v204, v156, v157, v158
    v_max3_f32 v204, v204, v159, v160
    v_max3_f32 v204, v204, v161, v162
    v_max3_f32 v204, v204, v163, v164
    v_max_f32 v204, v204, v165
    v_mov_b32 v205, v204
    s_nop 1
    v_permlane32_swap_b32 v204, v205
    v_max_f32 v204, v204, v205
    v_mov_b32 v205, v204
    s_nop 1
    v_permlane16_swap_b32 v204, v205
    v_max_f32 v204, v204, v205
    v_mul_f32 v204, s98, v204
    v_pk_fma_f32 v[156:157], v[156:157], s[98:99], v[204:205] op_sel_hi:[1,1,0] neg_lo:[0,0,1] neg_hi:[0,0,1]
    v_pk_fma_f32 v[158:159], v[158:159], s[98:99], v[204:205] op_sel_hi:[1,1,0] neg_lo:[0,0,1] neg_hi:[0,0,1]
    v_pk_fma_f32 v[160:161], v[160:161], s[98:99], v[204:205] op_sel_hi:[1,1,0] neg_lo:[0,0,1] neg_hi:[0,0,1]
    v_pk_fma_f32 v[162:163], v[162:163], s[98:99], v[204:205] op_sel_hi:[1,1,0] neg_lo:[0,0,1] neg_hi:[0,0,1]
    v_pk_fma_f32 v[164:165], v[164:165], s[98:99], v[204:205] op_sel_hi:[1,1,0] neg_lo:[0,0,1] neg_hi:[0,0,1]
    v_exp_f32 v156, v156
    v_exp_f32 v157, v157
    v_exp_f32 v158, v158
    v_exp_f32 v159, v159
    v_exp_f32 v160, v160
    v_exp_f32 v161, v161
    v_exp_f32 v162, v162
    v_exp_f32 v163, v163
    v_exp_f32 v164, v164
    v_exp_f32 v165, v165
    v_cvt_pk_bf16_f32 v208, v156, v157
    v_cvt_pk_bf16_f32 v209, v158, v159
    v_cvt_pk_bf16_f32 v210, v160, v161
    v_cvt_pk_bf16_f32 v211, v162, v163
    v_cvt_pk_bf16_f32 v212, v164, v165
    v_cvt_pk_bf16_f32 v215, v164, v165
    v_mfma_f32_16x16x32_bf16 v[200:203], v[40:43], v[208:211], 0
    v_mfma_f32_16x16x32_bf16 v[168:171], a[64:67], v[208:211], 0
    v_mfma_f32_16x16x32_bf16 v[172:175], a[68:71], v[208:211], 0
    v_mfma_f32_16x16x32_bf16 v[176:179], a[72:75], v[208:211], 0
    v_mfma_f32_16x16x32_bf16 v[180:183], a[76:79], v[208:211], 0
    v_mfma_f32_16x16x32_bf16 v[184:187], a[80:83], v[208:211], 0
    v_mfma_f32_16x16x32_bf16 v[188:191], a[84:87], v[208:211], 0
    v_mfma_f32_16x16x32_bf16 v[192:195], a[88:91], v[208:211], 0
    v_mfma_f32_16x16x32_bf16 v[196:199], a[92:95], v[208:211], 0
    v_mfma_f32_16x16x16_bf16 v[200:203], v[40:41], v[212:213], v[200:203]
    v_mfma_f32_16x16x16_bf16 v[168:171], v[32:33], v[212:213], v[168:171]
    v_mfma_f32_16x16x16_bf16 v[172:175], v[32:33], v[214:215], v[172:175]
    v_mfma_f32_16x16x16_bf16 v[176:179], v[34:35], v[212:213], v[176:179]
    v_mfma_f32_16x16x16_bf16 v[180:183], v[34:35], v[214:215], v[180:183]
    v_mfma_f32_16x16x16_bf16 v[184:187], v[36:37], v[212:213], v[184:187]
    v_mfma_f32_16x16x16_bf16 v[188:191], v[36:37], v[214:215], v[188:191]
    v_mfma_f32_16x16x16_bf16 v[192:195], v[38:39], v[212:213], v[192:195]
    v_mfma_f32_16x16x16_bf16 v[196:199], v[38:39], v[214:215], v[196:199]
    v_rcp_f32 v204, v200
    s_nop 0
    v_pk_mul_f32 v[168:169], v[168:169], v[204:205] op_sel_hi:[1,0]
    v_pk_mul_f32 v[170:171], v[170:171], v[204:205] op_sel_hi:[1,0]
    v_pk_mul_f32 v[172:173], v[172:173], v[204:205] op_sel_hi:[1,0]
    v_pk_mul_f32 v[174:175], v[174:175], v[204:205] op_sel_hi:[1,0]
    v_cvt_pk_bf16_f32 v88, v168, v169
    v_cvt_pk_bf16_f32 v89, v170, v171
    v_cvt_pk_bf16_f32 v90, v172, v173
    v_cvt_pk_bf16_f32 v91, v174, v175
    buffer_store_dwordx4 v[88:91], v9, s[4:7], s42 offen offset:0 sc1
    v_pk_mul_f32 v[176:177], v[176:177], v[204:205] op_sel_hi:[1,0]
    v_pk_mul_f32 v[178:179], v[178:179], v[204:205] op_sel_hi:[1,0]
    v_pk_mul_f32 v[180:181], v[180:181], v[204:205] op_sel_hi:[1,0]
    v_pk_mul_f32 v[182:183], v[182:183], v[204:205] op_sel_hi:[1,0]
    v_cvt_pk_bf16_f32 v92, v176, v177
    v_cvt_pk_bf16_f32 v93, v178, v179
    v_cvt_pk_bf16_f32 v94, v180, v181
    v_cvt_pk_bf16_f32 v95, v182, v183
    buffer_store_dwordx4 v[92:95], v9, s[4:7], s42 offen offset:1024 sc1
    v_pk_mul_f32 v[184:185], v[184:185], v[204:205] op_sel_hi:[1,0]
    v_pk_mul_f32 v[186:187], v[186:187], v[204:205] op_sel_hi:[1,0]
    v_pk_mul_f32 v[188:189], v[188:189], v[204:205] op_sel_hi:[1,0]
    v_pk_mul_f32 v[190:191], v[190:191], v[204:205] op_sel_hi:[1,0]
    v_cvt_pk_bf16_f32 v96, v184, v185
    v_cvt_pk_bf16_f32 v97, v186, v187
    v_cvt_pk_bf16_f32 v98, v188, v189
    v_cvt_pk_bf16_f32 v99, v190, v191
    buffer_store_dwordx4 v[96:99], v9, s[4:7], s42 offen offset:2048 sc1
    v_pk_mul_f32 v[192:193], v[192:193], v[204:205] op_sel_hi:[1,0]
    v_pk_mul_f32 v[194:195], v[194:195], v[204:205] op_sel_hi:[1,0]
    v_pk_mul_f32 v[196:197], v[196:197], v[204:205] op_sel_hi:[1,0]
    v_pk_mul_f32 v[198:199], v[198:199], v[204:205] op_sel_hi:[1,0]
    v_cvt_pk_bf16_f32 v100, v192, v193
    v_cvt_pk_bf16_f32 v101, v194, v195
    v_cvt_pk_bf16_f32 v102, v196, v197
    v_cvt_pk_bf16_f32 v103, v198, v199
    buffer_store_dwordx4 v[100:103], v9, s[4:7], s42 offen offset:3072 sc1
    s_waitcnt vmcnt(0) lgkmcnt(0)
    s_barrier
    s_cmp_lg_u32 s29, 0
    s_cbranch_scc1 wk_att0_sg
    s_lshl_b32 s38, s52, 7
    s_add_u32 s38, s38, 270336
    s_add_u32 s38, s38, s58
    v_mov_b32 v2, 0
    v_mov_b32 v3, 1
    s_mov_b64 exec, 1
    buffer_atomic_add v3, v2, s[4:7], s38 offen
    s_mov_b64 exec, -1
wk_att0_sg:
    s_mov_b32 s54, s50
    s_add_u32 s49, s49, 11
    s_cmp_lt_u32 s54, 512
    s_cbranch_scc1 wk_att1_top
    s_endpgm
wk_att1_top:
    v_mfma_f32_16x16x32_bf16 v[144:147], a[128:131], a[96:99], 0
    v_mfma_f32_16x16x32_bf16 v[156:159], a[128:131], a[112:115], 0
    v_mfma_f32_16x16x32_bf16 v[160:163], a[144:147], a[112:115], 0
    v_mfma_f32_16x16x32_bf16 v[144:147], a[132:135], a[100:103], v[144:147]
    v_mfma_f32_16x16x32_bf16 v[156:159], a[132:135], a[116:119], v[156:159]
    v_mfma_f32_16x16x32_bf16 v[160:163], a[148:151], a[116:119], v[160:163]
    v_mfma_f32_16x16x32_bf16 v[144:147], a[136:139], a[104:107], v[144:147]
    v_mfma_f32_16x16x32_bf16 v[156:159], a[136:139], a[120:123], v[156:159]
    v_mfma_f32_16x16x32_bf16 v[160:163], a[152:155], a[120:123], v[160:163]
    v_mfma_f32_16x16x32_bf16 v[144:147], a[140:143], a[108:111], v[144:147]
    v_mfma_f32_16x16x32_bf16 v[156:159], a[140:143], a[124:127], v[156:159]
    v_mfma_f32_16x16x32_bf16 v[160:163], a[156:159], a[124:127], v[160:163]
    v_mov_b32 v210, 0
    v_mov_b32 v211, 0
    s_nop 3
    v_cndmask_b32 v144, v44, v144, s[88:89]
    v_cndmask_b32 v145, v44, v145, s[90:91]
    v_cndmask_b32 v146, v44, v146, s[92:93]
    v_cndmask_b32 v147, v44, v147, s[94:95]
    v_cndmask_b32 v160, v44, v160, s[88:89]
    v_cndmask_b32 v161, v44, v161, s[90:91]
    v_cndmask_b32 v162, v44, v162, s[92:93]
    v_cndmask_b32 v163, v44, v163, s[94:95]
    s_lshr_b32 s52, s54, 3
    s_and_b32 s58, s54, 7
    s_lshr_b32 s58, s58, 1
    s_lshl_b32 s58, s58, 4
    s_add_u32 s50, s49, 11
    s_and_b32 s37, s50, 0xfff8
    s_max_u32 s37, s37, 128
    s_sub_u32 s37, s37, 128
    s_add_u32 s50, s50, s37
    s_lshl_b32 s37, s3, 3
    s_add_u32 s50, s50, s37
    s_min_u32 s55, s50, 511
    s_lshr_b32 s59, s55, 3
    s_cmp_eq_u32 s59, s56
    s_cbranch_scc1 wk_att1_r2
    s_cmp_lg_u32 s29, 0
    s_cbranch_scc1 wk_att1_c_dw
    s_lshl_b32 s38, s59, 7
    v_mov_b32 v2, 0
    s_add_u32 s39, s38, 303104
wk_att1_c_sp0:
    buffer_load_dword v3, v2, s[4:7], s39 offen sc1
    s_waitcnt vmcnt(0)
    v_readfirstlane_b32 s37, v3
    s_nop 0
    s_cmp_ge_u32 s37, 32
    s_cbranch_scc1 wk_att1_c_ok0
    s_sleep 6
    s_branch wk_att1_c_sp0
wk_att1_c_ok0:
    s_add_u32 s39, s38, 311296
wk_att1_c_sp1:
    buffer_load_dword v3, v2, s[4:7], s39 offen sc1
    s_waitcnt vmcnt(0)
    v_readfirstlane_b32 s37, v3
    s_nop 0
    s_cmp_ge_u32 s37, 16
    s_cbranch_scc1 wk_att1_c_ok1
    s_sleep 6
    s_branch wk_att1_c_sp1
wk_att1_c_ok1:
wk_att1_c_dw:
    s_barrier
    s_mov_b32 s56, s59
wk_att1_r2:
    s_lshl_b32 s31, s54, 2
    s_add_u32 s31, s31, s29
    s_lshl_b32 s43, s31, 12
    s_add_u32 s43, s43, 50331648
    s_lshl_b32 s41, s52, 18
    s_and_b32 s42, s31, 31
    s_lshl_b32 s42, s42, 12
    s_add_u32 s41, s41, s42
    s_add_u32 s41, s41, 67108864
    s_add_u32 s42, s41, 131072
    s_cmp_lg_u32 s29, 0
    s_cbranch_scc1 wk_att12_dw
    s_lshl_b32 s39, s52, 7
    s_add_u32 s39, s39, 262144
    v_mov_b32 v2, 0
wk_att12_sp:
    buffer_load_dword v3, v2, s[4:7], s39 offen sc1
    s_waitcnt vmcnt(0)
    v_readfirstlane_b32 s37, v3
    s_nop 0
    s_cmp_ge_u32 s37, 32
    s_cbranch_scc1 wk_att12_dw
    s_sleep 6
    s_branch wk_att12_sp
wk_att12_dw:
    s_barrier
    s_lshl_b32 m0, s29, 11
    s_nop 0
    buffer_load_dwordx4 v5, s[4:7], s43 offen sc1 lds
    buffer_load_dwordx4 v5, s[4:7], s43 offen offset:1024 sc1 lds
    buffer_load_dwordx2 v[32:33], v6, s[4:7], s43 offen offset:2048 sc1
    buffer_load_dwordx2 v[34:35], v6, s[4:7], s43 offen offset:2560 sc1
    buffer_load_dwordx2 v[36:37], v6, s[4:7], s43 offen offset:3072 sc1
    buffer_load_dwordx2 v[38:39], v6, s[4:7], s43 offen offset:3584 sc1
    s_waitcnt vmcnt(4)
    ds_read_b64_tr_b16 v[16:17], v10 offset:0
    ds_read_b64_tr_b16 v[18:19], v10 offset:256
    ds_read_b64_tr_b16 v[20:21], v10 offset:512
    ds_read_b64_tr_b16 v[22:23], v10 offset:768
    ds_read_b64_tr_b16 v[24:25], v10 offset:1024
    ds_read_b64_tr_b16 v[26:27], v10 offset:1280
    ds_read_b64_tr_b16 v[28:29], v10 offset:1536
    ds_read_b64_tr_b16 v[30:31], v10 offset:1792
    s_waitcnt vmcnt(0)
    s_mov_b32 s55, s50
    s_cmp_ge_u32 s55, 512
    s_cbranch_scc1 wk_att1_n_nl
    s_lshr_b32 s59, s55, 3
    s_cmp_eq_u32 s59, s56
    s_cbranch_scc1 wk_att1_n_rdy
    s_cmp_lg_u32 s29, 0
    s_cbranch_scc1 wk_att1_n_dw
    s_lshl_b32 s38, s59, 7
    v_mov_b32 v2, 0
    s_add_u32 s39, s38, 303104
wk_att1_n_sp0:
    buffer_load_dword v3, v2, s[4:7], s39 offen sc1
    s_waitcnt vmcnt(0)
    v_readfirstlane_b32 s37, v3
    s_nop 0
    s_cmp_ge_u32 s37, 32
    s_cbranch_scc1 wk_att1_n_ok0
    s_sleep 6
    s_branch wk_att1_n_sp0
wk_att1_n_ok0:
    s_add_u32 s39, s38, 311296
wk_att1_n_sp1:
    buffer_load_dword v3, v2, s[4:7], s39 offen sc1
    s_waitcnt vmcnt(0)
    v_readfirstlane_b32 s37, v3
    s_nop 0
    s_cmp_ge_u32 s37, 16
    s_cbranch_scc1 wk_att1_n_ok1
    s_sleep 6
    s_branch wk_att1_n_sp1
wk_att1_n_ok1:
wk_att1_n_dw:
    s_barrier
    s_mov_b32 s56, s59
wk_att1_n_rdy:
    s_lshl_b32 s31, s55, 2
    s_add_u32 s31, s31, s29
    s_lshl_b32 s32, s31, 13
    s_add_u32 s33, s32, 92274688
    s_add_u32 s34, s33, 4096
    s_add_u32 s35, s32, 16777216
    s_add_u32 s36, s35, 4096
    buffer_load_dwordx4 a[0:3], v4, s[4:7], s33 offen offset:0 sc1
    buffer_load_dwordx4 a[32:35], v4, s[4:7], s35 offen offset:0 sc1
    buffer_load_dwordx4 a[16:19], v4, s[4:7], s33 offen offset:1024 sc1
    buffer_load_dwordx4 a[48:51], v4, s[4:7], s35 offen offset:1024 sc1
    buffer_load_dwordx4 a[4:7], v4, s[4:7], s33 offen offset:2048 sc1
    buffer_load_dwordx4 a[36:39], v4, s[4:7], s35 offen offset:2048 sc1
    buffer_load_dwordx4 a[20:23], v4, s[4:7], s33 offen offset:3072 sc1
    buffer_load_dwordx4 a[52:55], v4, s[4:7], s35 offen offset:3072 sc1
    buffer_load_dwordx4 a[8:11], v4, s[4:7], s34 offen offset:0 sc1
    buffer_load_dwordx4 a[40:43], v4, s[4:7], s36 offen offset:0 sc1
    buffer_load_dwordx4 a[24:27], v4, s[4:7], s34 offen offset:1024 sc1
    buffer_load_dwordx4 a[56:59], v4, s[4:7], s36 offen offset:1024 sc1
    buffer_load_dwordx4 a[12:15], v4, s[4:7], s34 offen offset:2048 sc1
    buffer_load_dwordx4 a[44:47], v4, s[4:7], s36 offen offset:2048 sc1
    buffer_load_dwordx4 a[28:31], v4, s[4:7], s34 offen offset:3072 sc1
    buffer_load_dwordx4 a[60:63], v4, s[4:7], s36 offen offset:3072 sc1
    s_add_u32 s39, s32, 33554432
    s_add_u32 s40, s39, 4096
    buffer_load_dwordx4 a[64:67], v5, s[4:7], s39 offen offset:0 sc1
    buffer_load_dwordx4 a[68:71], v5, s[4:7], s39 offen offset:1024 sc1
    buffer_load_dwordx4 a[72:75], v5, s[4:7], s39 offen offset:2048 sc1
    buffer_load_dwordx4 a[76:79], v5, s[4:7], s39 offen offset:3072 sc1
    buffer_load_dwordx4 a[80:83], v5, s[4:7], s40 offen offset:0 sc1
    buffer_load_dwordx4 a[84:87], v5, s[4:7], s40 offen offset:1024 sc1
    buffer_load_dwordx4 a[88:91], v5, s[4:7], s40 offen offset:2048 sc1
    buffer_load_dwordx4 a[92:95], v5, s[4:7], s40 offen offset:3072 sc1
wk_att1_n_nl:
    s_waitcnt lgkmcnt(0)
    v_mfma_f32_16x16x32_bf16 v[152:155], v[16:19], a[96:99], 0
    v_mfma_f32_16x16x32_bf16 v[164:167], v[16:19], a[112:115], 0
    v_mfma_f32_16x16x32_bf16 v[152:155], v[20:23], a[100:103], v[152:155]
    v_mfma_f32_16x16x32_bf16 v[164:167], v[20:23], a[116:119], v[164:167]
    v_mfma_f32_16x16x32_bf16 v[152:155], v[24:27], a[104:107], v[152:155]
    v_mfma_f32_16x16x32_bf16 v[164:167], v[24:27], a[120:123], v[164:167]
    v_mfma_f32_16x16x32_bf16 v[152:155], v[28:31], a[108:111], v[152:155]
    v_mfma_f32_16x16x32_bf16 v[164:167], v[28:31], a[124:127], v[164:167]
    s_nop 6
    v_cndmask_b32 v152, v154, v152, s[96:97]
    v_cndmask_b32 v153, v155, v153, s[96:97]
    v_max3_f32 v204, v144, v145, v146
    v_max3_f32 v204, v204, v147, v152
    v_max_f32 v204, v204, v153
    v_mov_b32 v205, v204
    s_nop 1
    v_permlane32_swap_b32 v204, v205
    v_max_f32 v204, v204, v205
    v_mov_b32 v205, v204
    s_nop 1
    v_permlane16_swap_b32 v204, v205
    v_max_f32 v204, v204, v205
    v_mul_f32 v204, s98, v204
    v_pk_fma_f32 v[144:145], v[144:145], s[98:99], v[204:205] op_sel_hi:[1,1,0] neg_lo:[0,0,1] neg_hi:[0,0,1]
    v_pk_fma_f32 v[146:147], v[146:147], s[98:99], v[204:205] op_sel_hi:[1,1,0] neg_lo:[0,0,1] neg_hi:[0,0,1]
    v_pk_fma_f32 v[152:153], v[152:153], s[98:99], v[204:205] op_sel_hi:[1,1,0] neg_lo:[0,0,1] neg_hi:[0,0,1]
    v_exp_f32 v144, v144
    v_exp_f32 v145, v145
    v_exp_f32 v146, v146
    v_exp_f32 v147, v147
    v_exp_f32 v152, v152
    v_exp_f32 v153, v153
    v_cvt_pk_bf16_f32 v208, v144, v145
    v_cvt_pk_bf16_f32 v209, v146, v147
    v_cvt_pk_bf16_f32 v212, v152, v153
    v_cvt_pk_bf16_f32 v215, v152, v153
    v_mfma_f32_16x16x32_bf16 v[200:203], v[40:43], v[208:211], 0
    v_mfma_f32_16x16x32_bf16 v[168:171], a[160:163], v[208:211], 0
    v_mfma_f32_16x16x32_bf16 v[172:175], a[164:167], v[208:211], 0
    v_mfma_f32_16x16x32_bf16 v[176:179], a[168:171], v[208:211], 0
    v_mfma_f32_16x16x32_bf16 v[180:183], a[172:175], v[208:211], 0
    v_mfma_f32_16x16x32_bf16 v[184:187], a[176:179], v[208:211], 0
    v_mfma_f32_16x16x32_bf16 v[188:191], a[180:183], v[208:211], 0
    v_mfma_f32_16x16x32_bf16 v[192:195], a[184:187], v[208:211], 0
    v_mfma_f32_16x16x32_bf16 v[196:199], a[188:191], v[208:211], 0
    v_mfma_f32_16x16x16_bf16 v[200:203], v[40:41], v[212:213], v[200:203]
    v_mfma_f32_16x16x16_bf16 v[168:171], v[32:33], v[212:213], v[168:171]
    v_mfma_f32_16x16x16_bf16 v[172:175], v[32:33], v[214:215], v[172:175]
    v_mfma_f32_16x16x16_bf16 v[176:179], v[34:35], v[212:213], v[176:179]
    v_mfma_f32_16x16x16_bf16 v[180:183], v[34:35], v[214:215], v[180:183]
    v_mfma_f32_16x16x16_bf16 v[184:187], v[36:37], v[212:213], v[184:187]
    v_mfma_f32_16x16x16_bf16 v[188:191], v[36:37], v[214:215], v[188:191]
    v_mfma_f32_16x16x16_bf16 v[192:195], v[38:39], v[212:213], v[192:195]
    v_mfma_f32_16x16x16_bf16 v[196:199], v[38:39], v[214:215], v[196:199]
    v_rcp_f32 v204, v200
    s_nop 0
    v_pk_mul_f32 v[168:169], v[168:169], v[204:205] op_sel_hi:[1,0]
    v_pk_mul_f32 v[170:171], v[170:171], v[204:205] op_sel_hi:[1,0]
    v_pk_mul_f32 v[172:173], v[172:173], v[204:205] op_sel_hi:[1,0]
    v_pk_mul_f32 v[174:175], v[174:175], v[204:205] op_sel_hi:[1,0]
    v_cvt_pk_bf16_f32 v72, v168, v169
    v_cvt_pk_bf16_f32 v73, v170, v171
    v_cvt_pk_bf16_f32 v74, v172, v173
    v_cvt_pk_bf16_f32 v75, v174, v175
    buffer_store_dwordx4 v[72:75], v9, s[4:7], s41 offen offset:0 sc1
    v_pk_mul_f32 v[176:177], v[176:177], v[204:205] op_sel_hi:[1,0]
    v_pk_mul_f32 v[178:179], v[178:179], v[204:205] op_sel_hi:[1,0]
    v_pk_mul_f32 v[180:181], v[180:181], v[204:205] op_sel_hi:[1,0]
    v_pk_mul_f32 v[182:183], v[182:183], v[204:205] op_sel_hi:[1,0]
    v_cvt_pk_bf16_f32 v76, v176, v177
    v_cvt_pk_bf16_f32 v77, v178, v179
    v_cvt_pk_bf16_f32 v78, v180, v181
    v_cvt_pk_bf16_f32 v79, v182, v183
    buffer_store_dwordx4 v[76:79], v9, s[4:7], s41 offen offset:1024 sc1
    v_pk_mul_f32 v[184:185], v[184:185], v[204:205] op_sel_hi:[1,0]
    v_pk_mul_f32 v[186:187], v[186:187], v[204:205] op_sel_hi:[1,0]
    v_pk_mul_f32 v[188:189], v[188:189], v[204:205] op_sel_hi:[1,0]
    v_pk_mul_f32 v[190:191], v[190:191], v[204:205] op_sel_hi:[1,0]
    v_cvt_pk_bf16_f32 v80, v184, v185
    v_cvt_pk_bf16_f32 v81, v186, v187
    v_cvt_pk_bf16_f32 v82, v188, v189
    v_cvt_pk_bf16_f32 v83, v190, v191
    buffer_store_dwordx4 v[80:83], v9, s[4:7], s41 offen offset:2048 sc1
    v_pk_mul_f32 v[192:193], v[192:193], v[204:205] op_sel_hi:[1,0]
    v_pk_mul_f32 v[194:195], v[194:195], v[204:205] op_sel_hi:[1,0]
    v_pk_mul_f32 v[196:197], v[196:197], v[204:205] op_sel_hi:[1,0]
    v_pk_mul_f32 v[198:199], v[198:199], v[204:205] op_sel_hi:[1,0]
    v_cvt_pk_bf16_f32 v84, v192, v193
    v_cvt_pk_bf16_f32 v85, v194, v195
    v_cvt_pk_bf16_f32 v86, v196, v197
    v_cvt_pk_bf16_f32 v87, v198, v199
    buffer_store_dwordx4 v[84:87], v9, s[4:7], s41 offen offset:3072 sc1
    v_cndmask_b32 v164, v166, v164, s[96:97]
    v_cndmask_b32 v165, v167, v165, s[96:97]
    v_max3_f32 v204, v156, v157, v158
    v_max3_f32 v204, v204, v159, v160
    v_max3_f32 v204, v204, v161, v162
    v_max3_f32 v204, v204, v163, v164
    v_max_f32 v204, v204, v165
    v_mov_b32 v205, v204
    s_nop 1
    v_permlane32_swap_b32 v204, v205
    v_max_f32 v204, v204, v205
    v_mov_b32 v205, v204
    s_nop 1
    v_permlane16_swap_b32 v204, v205
    v_max_f32 v204, v204, v205
    v_mul_f32 v204, s98, v204
    v_pk_fma_f32 v[156:157], v[156:157], s[98:99], v[204:205] op_sel_hi:[1,1,0] neg_lo:[0,0,1] neg_hi:[0,0,1]
    v_pk_fma_f32 v[158:159], v[158:159], s[98:99], v[204:205] op_sel_hi:[1,1,0] neg_lo:[0,0,1] neg_hi:[0,0,1]
    v_pk_fma_f32 v[160:161], v[160:161], s[98:99], v[204:205] op_sel_hi:[1,1,0] neg_lo:[0,0,1] neg_hi:[0,0,1]
    v_pk_fma_f32 v[162:163], v[162:163], s[98:99], v[204:205] op_sel_hi:[1,1,0] neg_lo:[0,0,1] neg_hi:[0,0,1]
    v_pk_fma_f32 v[164:165], v[164:165], s[98:99], v[204:205] op_sel_hi:[1,1,0] neg_lo:[0,0,1] neg_hi:[0,0,1]
    v_exp_f32 v156, v156
    v_exp_f32 v157, v157
    v_exp_f32 v158, v158
    v_exp_f32 v159, v159
    v_exp_f32 v160, v160
    v_exp_f32 v161, v161
    v_exp_f32 v162, v162
    v_exp_f32 v163, v163
    v_exp_f32 v164, v164
    v_exp_f32 v165, v165
    v_cvt_pk_bf16_f32 v208, v156, v157
    v_cvt_pk_bf16_f32 v209, v158, v159
    v_cvt_pk_bf16_f32 v210, v160, v161
    v_cvt_pk_bf16_f32 v211, v162, v163
    v_cvt_pk_bf16_f32 v212, v164, v165
    v_cvt_pk_bf16_f32 v215, v164, v165
    v_mfma_f32_16x16x32_bf16 v[200:203], v[40:43], v[208:211], 0
    v_mfma_f32_16x16x32_bf16 v[168:171], a[160:163], v[208:211], 0
    v_mfma_f32_16x16x32_bf16 v[172:175], a[164:167], v[208:211], 0
    v_mfma_f32_16x16x32_bf16 v[176:179], a[168:171], v[208:211], 0
    v_mfma_f32_16x16x32_bf16 v[180:183], a[172:175], v[208:211], 0
    v_mfma_f32_16x16x32_bf16 v[184:187], a[176:179], v[208:211], 0
    v_mfma_f32_16x16x32_bf16 v[188:191], a[180:183], v[208:211], 0
    v_mfma_f32_16x16x32_bf16 v[192:195], a[184:187], v[208:211], 0
    v_mfma_f32_16x16x32_bf16 v[196:199], a[188:191], v[208:211], 0
    v_mfma_f32_16x16x16_bf16 v[200:203], v[40:41], v[212:213], v[200:203]
    v_mfma_f32_16x16x16_bf16 v[168:171], v[32:33], v[212:213], v[168:171]
    v_mfma_f32_16x16x16_bf16 v[172:175], v[32:33], v[214:215], v[172:175]
    v_mfma_f32_16x16x16_bf16 v[176:179], v[34:35], v[212:213], v[176:179]
    v_mfma_f32_16x16x16_bf16 v[180:183], v[34:35], v[214:215], v[180:183]
    v_mfma_f32_16x16x16_bf16 v[184:187], v[36:37], v[212:213], v[184:187]
    v_mfma_f32_16x16x16_bf16 v[188:191], v[36:37], v[214:215], v[188:191]
    v_mfma_f32_16x16x16_bf16 v[192:195], v[38:39], v[212:213], v[192:195]
    v_mfma_f32_16x16x16_bf16 v[196:199], v[38:39], v[214:215], v[196:199]
    v_rcp_f32 v204, v200
    s_nop 0
    v_pk_mul_f32 v[168:169], v[168:169], v[204:205] op_sel_hi:[1,0]
    v_pk_mul_f32 v[170:171], v[170:171], v[204:205] op_sel_hi:[1,0]
    v_pk_mul_f32 v[172:173], v[172:173], v[204:205] op_sel_hi:[1,0]
    v_pk_mul_f32 v[174:175], v[174:175], v[204:205] op_sel_hi:[1,0]
    v_cvt_pk_bf16_f32 v88, v168, v169
    v_cvt_pk_bf16_f32 v89, v170, v171
    v_cvt_pk_bf16_f32 v90, v172, v173
    v_cvt_pk_bf16_f32 v91, v174, v175
    buffer_store_dwordx4 v[88:91], v9, s[4:7], s42 offen offset:0 sc1
    v_pk_mul_f32 v[176:177], v[176:177], v[204:205] op_sel_hi:[1,0]
    v_pk_mul_f32 v[178:179], v[178:179], v[204:205] op_sel_hi:[1,0]
    v_pk_mul_f32 v[180:181], v[180:181], v[204:205] op_sel_hi:[1,0]
    v_pk_mul_f32 v[182:183], v[182:183], v[204:205] op_sel_hi:[1,0]
    v_cvt_pk_bf16_f32 v92, v176, v177
    v_cvt_pk_bf16_f32 v93, v178, v179
    v_cvt_pk_bf16_f32 v94, v180, v181
    v_cvt_pk_bf16_f32 v95, v182, v183
    buffer_store_dwordx4 v[92:95], v9, s[4:7], s42 offen offset:1024 sc1
    v_pk_mul_f32 v[184:185], v[184:185], v[204:205] op_sel_hi:[1,0]
    v_pk_mul_f32 v[186:187], v[186:187], v[204:205] op_sel_hi:[1,0]
    v_pk_mul_f32 v[188:189], v[188:189], v[204:205] op_sel_hi:[1,0]
    v_pk_mul_f32 v[190:191], v[190:191], v[204:205] op_sel_hi:[1,0]
    v_cvt_pk_bf16_f32 v96, v184, v185
    v_cvt_pk_bf16_f32 v97, v186, v187
    v_cvt_pk_bf16_f32 v98, v188, v189
    v_cvt_pk_bf16_f32 v99, v190, v191
    buffer_store_dwordx4 v[96:99], v9, s[4:7], s42 offen offset:2048 sc1
    v_pk_mul_f32 v[192:193], v[192:193], v[204:205] op_sel_hi:[1,0]
    v_pk_mul_f32 v[194:195], v[194:195], v[204:205] op_sel_hi:[1,0]
    v_pk_mul_f32 v[196:197], v[196:197], v[204:205] op_sel_hi:[1,0]
    v_pk_mul_f32 v[198:199], v[198:199], v[204:205] op_sel_hi:[1,0]
    v_cvt_pk_bf16_f32 v100, v192, v193
    v_cvt_pk_bf16_f32 v101, v194, v195
    v_cvt_pk_bf16_f32 v102, v196, v197
    v_cvt_pk_bf16_f32 v103, v198, v199
    buffer_store_dwordx4 v[100:103], v9, s[4:7], s42 offen offset:3072 sc1
    s_waitcnt vmcnt(0) lgkmcnt(0)
    s_barrier
    s_cmp_lg_u32 s29, 0
    s_cbranch_scc1 wk_att1_sg
    s_lshl_b32 s38, s52, 7
    s_add_u32 s38, s38, 270336
    s_add_u32 s38, s38, s58
    v_mov_b32 v2, 0
    v_mov_b32 v3, 1
    s_mov_b64 exec, 1
    buffer_atomic_add v3, v2, s[4:7], s38 offen
    s_mov_b64 exec, -1
wk_att1_sg:
    s_mov_b32 s54, s50
    s_add_u32 s49, s49, 11
    s_cmp_lt_u32 s54, 512
    s_cbranch_scc1 wk_att0_top
    s_endpgm
wk_wo:
    s_lshr_b32 s55, s53, 3
    s_bfe_u32 s56, s53, 0x20001
    s_mul_i32 s58, s56, 1310720
    s_lshl_b32 s59, s55, 8
    s_add_u32 s58, s58, s59
    v_lshrrev_b32 v2, 3, v1
    s_mov_b32 s42, 128
    v_mul_lo_u32 v2, v2, s42
    v_and_b32 v3, 7, v1
    v_lshrrev_b32 v4, 4, v1
    v_xor_b32 v5, v3, v4
    v_lshl_add_u32 v8, v5, 4, v2
    v_xor_b32 v5, 4, v5
    v_lshl_add_u32 v9, v5, 4, v2
    s_mov_b32 s42, 1280
    v_and_b32 v6, 1, v1
    v_lshlrev_b32 v6, 4, v6
    v_mul_lo_u32 v2, v4, s42
    v_add_u32 v2, v2, v6
    v_bfe_u32 v5, v1, 1, 3
    v_xor_b32 v5, v5, v4
    v_lshl_add_u32 v10, v5, 5, v2
    v_xor_b32 v5, 4, v5
    v_lshl_add_u32 v11, v5, 5, v2
    v_and_b32 v2, 15, v1
    v_lshrrev_b32 v3, 1, v2
    v_xor_b32 v3, v3, v4
    v_lshlrev_b32 v3, 4, v3
    v_lshl_add_u32 v3, v2, 7, v3
    s_lshr_b32 s42, s29, 2
    s_mul_i32 s42, s42, 2048
    s_add_u32 s42, s42, 0
    v_add_u32 v12, s42, v3
    v_xor_b32 v13, 64, v12
    v_bfe_u32 v2, v1, 2, 2
    v_lshl_add_u32 v2, v4, 2, v2
    v_and_b32 v3, 3, v1
    v_lshlrev_b32 v3, 3, v3
    s_and_b32 s42, s29, 3
    s_mul_i32 s42, s42, 2
    s_add_u32 s42, s42, 0
    v_and_b32 v5, 7, v2
    v_xor_b32 v5, s42, v5
    v_lshl_add_u32 v5, v5, 5, v3
    v_lshl_add_u32 v5, v2, 8, v5
    v_add_u32 v14, 2048, v5
    s_and_b32 s42, s29, 3
    s_mul_i32 s42, s42, 2
    s_add_u32 s42, s42, 1
    v_and_b32 v5, 7, v2
    v_xor_b32 v5, s42, v5
    v_lshl_add_u32 v5, v5, 5, v3
    v_lshl_add_u32 v5, v2, 8, v5
    v_add_u32 v15, 2048, v5
    s_mov_b32 s57, 0
    s_mul_i32 s42, s29, 0
    s_add_u32 s40, s57, s42
    s_mul_i32 s44, s29, 0
    s_mul_i32 s42, s29, 20480
    s_add_u32 s41, s58, s42
    s_mul_i32 s45, s29, 4096
    v_bfe_u32 v2, v8, 6, 1
    v_lshrrev_b32 v3, 7, v8
    v_and_b32 v8, 48, v8
    v_lshl_add_u32 v8, v2, 10, v8
    v_lshl_add_u32 v8, v3, 6, v8
    v_add_u32 v8, 512, v8
    v_bfe_u32 v2, v9, 6, 1
    v_lshrrev_b32 v3, 7, v9
    v_and_b32 v9, 48, v9
    v_lshl_add_u32 v9, v2, 10, v9
    v_lshl_add_u32 v9, v3, 6, v9
    s_and_b32 s57, s29, 1
    s_cmp_eq_u32 s57, 1
    s_cselect_b64 vcc, -1, 0
    v_cndmask_b32 v20, v8, v9, vcc
    v_cndmask_b32 v21, v9, v8, vcc
    v_add_u32 v22, 0x10000, v12
    v_add_u32 v23, 0x10000, v13
    s_add_u32 m0, s45, 2048
    s_nop 0
    buffer_load_dwordx4 v10, s[24:27], s41 offen  lds
    s_add_u32 m0, s45, 3072
    s_add_u32 s42, s41, 5120
    buffer_load_dwordx4 v11, s[24:27], s42 offen  lds
    s_add_u32 m0, s45, 4096
    s_add_u32 s42, s41, 10240
    buffer_load_dwordx4 v10, s[24:27], s42 offen  lds
    s_add_u32 m0, s45, 5120
    s_add_u32 s42, s41, 15360
    buffer_load_dwordx4 v11, s[24:27], s42 offen  lds
    s_add_u32 s41, s41, 81920
    s_add_u32 m0, s45, 20480
    s_nop 0
    buffer_load_dwordx4 v10, s[24:27], s41 offen  lds
    s_add_u32 m0, s45, 21504
    s_add_u32 s42, s41, 5120
    buffer_load_dwordx4 v11, s[24:27], s42 offen  lds
    s_add_u32 m0, s45, 22528
    s_add_u32 s42, s41, 10240
    buffer_load_dwordx4 v10, s[24:27], s42 offen  lds
    s_add_u32 m0, s45, 23552
    s_add_u32 s42, s41, 15360
    buffer_load_dwordx4 v11, s[24:27], s42 offen  lds
    s_add_u32 s41, s41, 81920
    s_add_u32 m0, s45, 38912
    s_nop 0
    buffer_load_dwordx4 v10, s[24:27], s41 offen  lds
    s_add_u32 m0, s45, 39936
    s_add_u32 s42, s41, 5120
    buffer_load_dwordx4 v11, s[24:27], s42 offen  lds
    s_add_u32 m0, s45, 40960
    s_add_u32 s42, s41, 10240
    buffer_load_dwordx4 v10, s[24:27], s42 offen  lds
    s_add_u32 m0, s45, 41984
    s_add_u32 s42, s41, 15360
    buffer_load_dwordx4 v11, s[24:27], s42 offen  lds
    s_add_u32 s41, s41, 81920
    s_add_u32 m0, s45, 57344
    s_nop 0
    buffer_load_dwordx4 v10, s[24:27], s41 offen  lds
    s_add_u32 m0, s45, 58368
    s_add_u32 s42, s41, 5120
    buffer_load_dwordx4 v11, s[24:27], s42 offen  lds
    s_add_u32 m0, s45, 59392
    s_add_u32 s42, s41, 10240
    buffer_load_dwordx4 v10, s[24:27], s42 offen  lds
    s_add_u32 m0, s45, 60416
    s_add_u32 s42, s41, 15360
    buffer_load_dwordx4 v11, s[24:27], s42 offen  lds
    s_add_u32 s41, s41, 81920
    s_add_u32 m0, s45, 75776
    s_nop 0
    buffer_load_dwordx4 v10, s[24:27], s41 offen  lds
    s_add_u32 m0, s45, 76800
    s_add_u32 s42, s41, 5120
    buffer_load_dwordx4 v11, s[24:27], s42 offen  lds
    s_add_u32 m0, s45, 77824
    s_add_u32 s42, s41, 10240
    buffer_load_dwordx4 v10, s[24:27], s42 offen  lds
    s_add_u32 m0, s45, 78848
    s_add_u32 s42, s41, 15360
    buffer_load_dwordx4 v11, s[24:27], s42 offen  lds
    s_add_u32 s41, s41, 81920
    s_add_u32 m0, s45, 94208
    s_nop 0
    buffer_load_dwordx4 v10, s[24:27], s41 offen  lds
    s_add_u32 m0, s45, 95232
    s_add_u32 s42, s41, 5120
    buffer_load_dwordx4 v11, s[24:27], s42 offen  lds
    s_add_u32 m0, s45, 96256
    s_add_u32 s42, s41, 10240
    buffer_load_dwordx4 v10, s[24:27], s42 offen  lds
    s_add_u32 m0, s45, 97280
    s_add_u32 s42, s41, 15360
    buffer_load_dwordx4 v11, s[24:27], s42 offen  lds
    s_add_u32 s41, s41, 81920
    s_add_u32 m0, s45, 112640
    s_nop 0
    buffer_load_dwordx4 v10, s[24:27], s41 offen  lds
    s_add_u32 m0, s45, 113664
    s_add_u32 s42, s41, 5120
    buffer_load_dwordx4 v11, s[24:27], s42 offen  lds
    s_add_u32 m0, s45, 114688
    s_add_u32 s42, s41, 10240
    buffer_load_dwordx4 v10, s[24:27], s42 offen  lds
    s_add_u32 m0, s45, 115712
    s_add_u32 s42, s41, 15360
    buffer_load_dwordx4 v11, s[24:27], s42 offen  lds
    s_add_u32 s41, s41, 81920
    s_add_u32 m0, s45, 131072
    s_nop 0
    buffer_load_dwordx4 v10, s[24:27], s41 offen  lds
    s_add_u32 m0, s45, 132096
    s_add_u32 s42, s41, 5120
    buffer_load_dwordx4 v11, s[24:27], s42 offen  lds
    s_add_u32 m0, s45, 133120
    s_add_u32 s42, s41, 10240
    buffer_load_dwordx4 v10, s[24:27], s42 offen  lds
    s_add_u32 m0, s45, 134144
    s_add_u32 s42, s41, 15360
    buffer_load_dwordx4 v11, s[24:27], s42 offen  lds
    s_add_u32 s41, s41, 81920
    s_waitcnt vmcnt(28)
    s_barrier
    ds_read_b64_tr_b16 v[80:81], v14 offset:0
    ds_read_b64_tr_b16 v[82:83], v14 offset:4096
    ds_read_b64_tr_b16 v[84:85], v15 offset:0
    ds_read_b64_tr_b16 v[86:87], v15 offset:4096
    ds_read_b64_tr_b16 v[88:89], v14 offset:8192
    ds_read_b64_tr_b16 v[90:91], v14 offset:12288
    ds_read_b64_tr_b16 v[92:93], v15 offset:8192
    ds_read_b64_tr_b16 v[94:95], v15 offset:12288
    v_add_u32 v14, 18432, v14
    v_add_u32 v15, 18432, v15
    s_waitcnt lgkmcnt(0)
    s_waitcnt vmcnt(24)
    s_barrier
    s_add_u32 m0, s45, 2048
    s_nop 0
    buffer_load_dwordx4 v10, s[24:27], s41 offen  lds
    s_add_u32 m0, s45, 3072
    s_add_u32 s42, s41, 5120
    buffer_load_dwordx4 v11, s[24:27], s42 offen  lds
    s_add_u32 m0, s45, 4096
    s_add_u32 s42, s41, 10240
    buffer_load_dwordx4 v10, s[24:27], s42 offen  lds
    s_add_u32 m0, s45, 5120
    s_add_u32 s42, s41, 15360
    buffer_load_dwordx4 v11, s[24:27], s42 offen  lds
    s_add_u32 s41, s41, 81920
    ds_read_b64_tr_b16 v[96:97], v14 offset:0
    ds_read_b64_tr_b16 v[98:99], v14 offset:4096
    ds_read_b64_tr_b16 v[100:101], v15 offset:0
    ds_read_b64_tr_b16 v[102:103], v15 offset:4096
    ds_read_b64_tr_b16 v[104:105], v14 offset:8192
    ds_read_b64_tr_b16 v[106:107], v14 offset:12288
    ds_read_b64_tr_b16 v[108:109], v15 offset:8192
    ds_read_b64_tr_b16 v[110:111], v15 offset:12288
    v_add_u32 v14, 18432, v14
    v_add_u32 v15, 18432, v15
    s_waitcnt lgkmcnt(0)
    s_waitcnt vmcnt(24)
    s_barrier
    s_add_u32 m0, s45, 20480
    s_nop 0
    buffer_load_dwordx4 v10, s[24:27], s41 offen  lds
    s_add_u32 m0, s45, 21504
    s_add_u32 s42, s41, 5120
    buffer_load_dwordx4 v11, s[24:27], s42 offen  lds
    s_add_u32 m0, s45, 22528
    s_add_u32 s42, s41, 10240
    buffer_load_dwordx4 v10, s[24:27], s42 offen  lds
    s_add_u32 m0, s45, 23552
    s_add_u32 s42, s41, 15360
    buffer_load_dwordx4 v11, s[24:27], s42 offen  lds
    s_add_u32 s41, s41, 81920
    ds_read_b64_tr_b16 v[112:113], v14 offset:0
    ds_read_b64_tr_b16 v[114:115], v14 offset:4096
    ds_read_b64_tr_b16 v[116:117], v15 offset:0
    ds_read_b64_tr_b16 v[118:119], v15 offset:4096
    ds_read_b64_tr_b16 v[120:121], v14 offset:8192
    ds_read_b64_tr_b16 v[122:123], v14 offset:12288
    ds_read_b64_tr_b16 v[124:125], v15 offset:8192
    ds_read_b64_tr_b16 v[126:127], v15 offset:12288
    v_add_u32 v14, 18432, v14
    v_add_u32 v15, 18432, v15
    s_waitcnt lgkmcnt(0)
    s_waitcnt vmcnt(24)
    s_barrier
    s_add_u32 m0, s45, 38912
    s_nop 0
    buffer_load_dwordx4 v10, s[24:27], s41 offen  lds
    s_add_u32 m0, s45, 39936
    s_add_u32 s42, s41, 5120
    buffer_load_dwordx4 v11, s[24:27], s42 offen  lds
    s_add_u32 m0, s45, 40960
    s_add_u32 s42, s41, 10240
    buffer_load_dwordx4 v10, s[24:27], s42 offen  lds
    s_add_u32 m0, s45, 41984
    s_add_u32 s42, s41, 15360
    buffer_load_dwordx4 v11, s[24:27], s42 offen  lds
    s_add_u32 s41, s41, 81920
    ds_read_b64_tr_b16 v[128:129], v14 offset:0
    ds_read_b64_tr_b16 v[130:131], v14 offset:4096
    ds_read_b64_tr_b16 v[132:133], v15 offset:0
    ds_read_b64_tr_b16 v[134:135], v15 offset:4096
    ds_read_b64_tr_b16 v[136:137], v14 offset:8192
    ds_read_b64_tr_b16 v[138:139], v14 offset:12288
    ds_read_b64_tr_b16 v[140:141], v15 offset:8192
    ds_read_b64_tr_b16 v[142:143], v15 offset:12288
    v_add_u32 v14, 18432, v14
    v_add_u32 v15, 18432, v15
    s_waitcnt lgkmcnt(0)
    s_waitcnt vmcnt(24)
    s_barrier
    s_add_u32 m0, s45, 57344
    s_nop 0
    buffer_load_dwordx4 v10, s[24:27], s41 offen  lds
    s_add_u32 m0, s45, 58368
    s_add_u32 s42, s41, 5120
    buffer_load_dwordx4 v11, s[24:27], s42 offen  lds
    s_add_u32 m0, s45, 59392
    s_add_u32 s42, s41, 10240
    buffer_load_dwordx4 v10, s[24:27], s42 offen  lds
    s_add_u32 m0, s45, 60416
    s_add_u32 s42, s41, 15360
    buffer_load_dwordx4 v11, s[24:27], s42 offen  lds
    s_add_u32 s41, s41, 81920
    ds_read_b64_tr_b16 v[144:145], v14 offset:0
    ds_read_b64_tr_b16 v[146:147], v14 offset:4096
    ds_read_b64_tr_b16 v[148:149], v15 offset:0
    ds_read_b64_tr_b16 v[150:151], v15 offset:4096
    ds_read_b64_tr_b16 v[152:153], v14 offset:8192
    ds_read_b64_tr_b16 v[154:155], v14 offset:12288
    ds_read_b64_tr_b16 v[156:157], v15 offset:8192
    ds_read_b64_tr_b16 v[158:159], v15 offset:12288
    v_add_u32 v14, 18432, v14
    v_add_u32 v15, 18432, v15
    s_waitcnt lgkmcnt(0)
    s_waitcnt vmcnt(24)
    s_barrier
    s_add_u32 m0, s45, 75776
    s_nop 0
    buffer_load_dwordx4 v10, s[24:27], s41 offen  lds
    s_add_u32 m0, s45, 76800
    s_add_u32 s42, s41, 5120
    buffer_load_dwordx4 v11, s[24:27], s42 offen  lds
    s_add_u32 m0, s45, 77824
    s_add_u32 s42, s41, 10240
    buffer_load_dwordx4 v10, s[24:27], s42 offen  lds
    s_add_u32 m0, s45, 78848
    s_add_u32 s42, s41, 15360
    buffer_load_dwordx4 v11, s[24:27], s42 offen  lds
    s_add_u32 s41, s41, 81920
    ds_read_b64_tr_b16 v[160:161], v14 offset:0
    ds_read_b64_tr_b16 v[162:163], v14 offset:4096
    ds_read_b64_tr_b16 v[164:165], v15 offset:0
    ds_read_b64_tr_b16 v[166:167], v15 offset:4096
    ds_read_b64_tr_b16 v[168:169], v14 offset:8192
    ds_read_b64_tr_b16 v[170:171], v14 offset:12288
    ds_read_b64_tr_b16 v[172:173], v15 offset:8192
    ds_read_b64_tr_b16 v[174:175], v15 offset:12288
    v_add_u32 v14, 18432, v14
    v_add_u32 v15, 18432, v15
    s_waitcnt lgkmcnt(0)
    s_waitcnt vmcnt(24)
    s_barrier
    s_add_u32 m0, s45, 94208
    s_nop 0
    buffer_load_dwordx4 v10, s[24:27], s41 offen  lds
    s_add_u32 m0, s45, 95232
    s_add_u32 s42, s41, 5120
    buffer_load_dwordx4 v11, s[24:27], s42 offen  lds
    s_add_u32 m0, s45, 96256
    s_add_u32 s42, s41, 10240
    buffer_load_dwordx4 v10, s[24:27], s42 offen  lds
    s_add_u32 m0, s45, 97280
    s_add_u32 s42, s41, 15360
    buffer_load_dwordx4 v11, s[24:27], s42 offen  lds
    s_add_u32 s41, s41, 81920
    ds_read_b64_tr_b16 v[176:177], v14 offset:0
    ds_read_b64_tr_b16 v[178:179], v14 offset:4096
    ds_read_b64_tr_b16 v[180:181], v15 offset:0
    ds_read_b64_tr_b16 v[182:183], v15 offset:4096
    ds_read_b64_tr_b16 v[184:185], v14 offset:8192
    ds_read_b64_tr_b16 v[186:187], v14 offset:12288
    ds_read_b64_tr_b16 v[188:189], v15 offset:8192
    ds_read_b64_tr_b16 v[190:191], v15 offset:12288
    v_add_u32 v14, 18432, v14
    v_add_u32 v15, 18432, v15
    s_waitcnt lgkmcnt(0)
    s_waitcnt vmcnt(24)
    s_barrier
    s_add_u32 m0, s45, 112640
    s_nop 0
    buffer_load_dwordx4 v10, s[24:27], s41 offen  lds
    s_add_u32 m0, s45, 113664
    s_add_u32 s42, s41, 5120
    buffer_load_dwordx4 v11, s[24:27], s42 offen  lds
    s_add_u32 m0, s45, 114688
    s_add_u32 s42, s41, 10240
    buffer_load_dwordx4 v10, s[24:27], s42 offen  lds
    s_add_u32 m0, s45, 115712
    s_add_u32 s42, s41, 15360
    buffer_load_dwordx4 v11, s[24:27], s42 offen  lds
    s_add_u32 s41, s41, 81920
    ds_read_b64_tr_b16 v[192:193], v14 offset:0
    ds_read_b64_tr_b16 v[194:195], v14 offset:4096
    ds_read_b64_tr_b16 v[196:197], v15 offset:0
    ds_read_b64_tr_b16 v[198:199], v15 offset:4096
    ds_read_b64_tr_b16 v[200:201], v14 offset:8192
    ds_read_b64_tr_b16 v[202:203], v14 offset:12288
    ds_read_b64_tr_b16 v[204:205], v15 offset:8192
    ds_read_b64_tr_b16 v[206:207], v15 offset:12288
    v_subrev_u32 v14, 129024, v14
    v_subrev_u32 v15, 129024, v15
    s_waitcnt lgkmcnt(0)
    s_waitcnt vmcnt(24)
    s_barrier
    s_add_u32 m0, s45, 131072
    s_nop 0
    buffer_load_dwordx4 v10, s[24:27], s41 offen  lds
    s_add_u32 m0, s45, 132096
    s_add_u32 s42, s41, 5120
    buffer_load_dwordx4 v11, s[24:27], s42 offen  lds
    s_add_u32 m0, s45, 133120
    s_add_u32 s42, s41, 10240
    buffer_load_dwordx4 v10, s[24:27], s42 offen  lds
    s_add_u32 m0, s45, 134144
    s_add_u32 s42, s41, 15360
    buffer_load_dwordx4 v11, s[24:27], s42 offen  lds
    s_add_u32 s41, s41, 81920
    ds_read_b64_tr_b16 v[208:209], v14 offset:0
    ds_read_b64_tr_b16 v[210:211], v14 offset:4096
    ds_read_b64_tr_b16 v[212:213], v15 offset:0
    ds_read_b64_tr_b16 v[214:215], v15 offset:4096
    ds_read_b64_tr_b16 v[216:217], v14 offset:8192
    ds_read_b64_tr_b16 v[218:219], v14 offset:12288
    ds_read_b64_tr_b16 v[220:221], v15 offset:8192
    ds_read_b64_tr_b16 v[222:223], v15 offset:12288
    v_add_u32 v14, 18432, v14
    v_add_u32 v15, 18432, v15
    s_waitcnt lgkmcnt(0)
    s_waitcnt vmcnt(24)
    s_barrier
    ds_read_b64_tr_b16 v[224:225], v14 offset:0
    ds_read_b64_tr_b16 v[226:227], v14 offset:4096
    ds_read_b64_tr_b16 v[228:229], v15 offset:0
    ds_read_b64_tr_b16 v[230:231], v15 offset:4096
    ds_read_b64_tr_b16 v[232:233], v14 offset:8192
    ds_read_b64_tr_b16 v[234:235], v14 offset:12288
    ds_read_b64_tr_b16 v[236:237], v15 offset:8192
    ds_read_b64_tr_b16 v[238:239], v15 offset:12288
    v_add_u32 v14, 18432, v14
    v_add_u32 v15, 18432, v15
    s_waitcnt lgkmcnt(0)
    s_waitcnt vmcnt(20)
    s_barrier
    ds_read_b64_tr_b16 v[240:241], v14 offset:0
    ds_read_b64_tr_b16 v[242:243], v14 offset:4096
    ds_read_b64_tr_b16 v[244:245], v15 offset:0
    ds_read_b64_tr_b16 v[246:247], v15 offset:4096
    ds_read_b64_tr_b16 v[248:249], v14 offset:8192
    ds_read_b64_tr_b16 v[250:251], v14 offset:12288
    ds_read_b64_tr_b16 v[252:253], v15 offset:8192
    ds_read_b64_tr_b16 v[254:255], v15 offset:12288
    v_add_u32 v14, 18432, v14
    v_add_u32 v15, 18432, v15
    s_waitcnt lgkmcnt(0)
    s_waitcnt vmcnt(16)
    s_barrier
    ds_read_b64_tr_b16 a[0:1], v14 offset:0
    ds_read_b64_tr_b16 a[2:3], v14 offset:4096
    ds_read_b64_tr_b16 a[4:5], v15 offset:0
    ds_read_b64_tr_b16 a[6:7], v15 offset:4096
    ds_read_b64_tr_b16 a[8:9], v14 offset:8192
    ds_read_b64_tr_b16 a[10:11], v14 offset:12288
    ds_read_b64_tr_b16 a[12:13], v15 offset:8192
    ds_read_b64_tr_b16 a[14:15], v15 offset:12288
    v_add_u32 v14, 18432, v14
    v_add_u32 v15, 18432, v15
    s_waitcnt lgkmcnt(0)
    s_waitcnt vmcnt(12)
    s_barrier
    ds_read_b64_tr_b16 a[16:17], v14 offset:0
    ds_read_b64_tr_b16 a[18:19], v14 offset:4096
    ds_read_b64_tr_b16 a[20:21], v15 offset:0
    ds_read_b64_tr_b16 a[22:23], v15 offset:4096
    ds_read_b64_tr_b16 a[24:25], v14 offset:8192
    ds_read_b64_tr_b16 a[26:27], v14 offset:12288
    ds_read_b64_tr_b16 a[28:29], v15 offset:8192
    ds_read_b64_tr_b16 a[30:31], v15 offset:12288
    v_add_u32 v14, 18432, v14
    v_add_u32 v15, 18432, v15
    s_waitcnt lgkmcnt(0)
    s_waitcnt vmcnt(8)
    s_barrier
    ds_read_b64_tr_b16 a[32:33], v14 offset:0
    ds_read_b64_tr_b16 a[34:35], v14 offset:4096
    ds_read_b64_tr_b16 a[36:37], v15 offset:0
    ds_read_b64_tr_b16 a[38:39], v15 offset:4096
    ds_read_b64_tr_b16 a[40:41], v14 offset:8192
    ds_read_b64_tr_b16 a[42:43], v14 offset:12288
    ds_read_b64_tr_b16 a[44:45], v15 offset:8192
    ds_read_b64_tr_b16 a[46:47], v15 offset:12288
    v_add_u32 v14, 18432, v14
    v_add_u32 v15, 18432, v15
    s_waitcnt lgkmcnt(0)
    s_waitcnt vmcnt(4)
    s_barrier
    ds_read_b64_tr_b16 a[48:49], v14 offset:0
    ds_read_b64_tr_b16 a[50:51], v14 offset:4096
    ds_read_b64_tr_b16 a[52:53], v15 offset:0
    ds_read_b64_tr_b16 a[54:55], v15 offset:4096
    ds_read_b64_tr_b16 a[56:57], v14 offset:8192
    ds_read_b64_tr_b16 a[58:59], v14 offset:12288
    ds_read_b64_tr_b16 a[60:61], v15 offset:8192
    ds_read_b64_tr_b16 a[62:63], v15 offset:12288
    v_add_u32 v14, 18432, v14
    v_add_u32 v15, 18432, v15
    s_waitcnt lgkmcnt(0)
    s_waitcnt vmcnt(0)
    s_barrier
    ds_read_b64_tr_b16 a[64:65], v14 offset:0
    ds_read_b64_tr_b16 a[66:67], v14 offset:4096
    ds_read_b64_tr_b16 a[68:69], v15 offset:0
    ds_read_b64_tr_b16 a[70:71], v15 offset:4096
    ds_read_b64_tr_b16 a[72:73], v14 offset:8192
    ds_read_b64_tr_b16 a[74:75], v14 offset:12288
    ds_read_b64_tr_b16 a[76:77], v15 offset:8192
    ds_read_b64_tr_b16 a[78:79], v15 offset:12288
    v_subrev_u32 v14, 129024, v14
    v_subrev_u32 v15, 129024, v15
    s_waitcnt lgkmcnt(0)
    s_barrier
    s_lshl_b32 s58, s56, 4
    v_and_b32 v4, 15, v1
    v_lshrrev_b32 v5, 4, v1
    v_lshlrev_b32 v5, 4, v5
    v_lshl_add_u32 v4, v4, 6, v5
    s_lshl_b32 s33, s55, 2
    s_add_u32 s33, s33, s29
    s_lshl_b32 s33, s33, 12
    s_and_b32 s31, s53, 1
    s_lshl_b32 s32, s31, 10
    s_add_u32 s33, s33, s32
    s_mul_i32 s32, s56, 81920
    s_add_u32 s33, s33, s32
    s_add_u32 s59, s33, 109051904
    s_lshl_b32 s56, s56, 15
    s_lshl_b32 s31, s31, 17
    s_add_u32 s56, s56, s31
    s_add_u32 s56, s56, 67108352
wk_wo_loop:
    s_lshl_b32 s55, s52, 18
    s_add_u32 s55, s55, s56
    s_mul_i32 s33, s52, 327680
    s_add_u32 s33, s33, s59
    s_cmp_lg_u32 s29, 0
    s_cbranch_scc1 wk_wo_dw
    s_lshl_b32 s39, s52, 7
    s_add_u32 s39, s39, 270336
    s_add_u32 s39, s39, s58
    v_mov_b32 v2, 0
wk_wo_sp:
    buffer_load_dword v3, v2, s[4:7], s39 offen sc1
    s_waitcnt vmcnt(0)
    v_readfirstlane_b32 s37, v3
    s_nop 0
    s_cmp_ge_u32 s37, 2
    s_cbranch_scc1 wk_wo_dw
    s_sleep 6
    s_branch wk_wo_sp
wk_wo_dw:
    s_barrier
    s_mul_i32 s57, s29, 4096
    s_mov_b32 m0, s57
    s_add_u32 s57, s57, s55
    buffer_load_dwordx4 v8, s[4:7], s57 offen offset:0 sc1 lds
    buffer_load_dwordx4 v9, s[4:7], s57 offen offset:1024 sc1 lds
    buffer_load_dwordx4 v8, s[4:7], s57 offen offset:2048 sc1 lds
    buffer_load_dwordx4 v9, s[4:7], s57 offen offset:3072 sc1 lds
    s_mul_i32 s57, s29, 4096
    s_add_u32 s57, s57, 16384
    s_mov_b32 m0, s57
    s_add_u32 s57, s57, s55
    buffer_load_dwordx4 v8, s[4:7], s57 offen offset:0 sc1 lds
    buffer_load_dwordx4 v9, s[4:7], s57 offen offset:1024 sc1 lds
    buffer_load_dwordx4 v8, s[4:7], s57 offen offset:2048 sc1 lds
    buffer_load_dwordx4 v9, s[4:7], s57 offen offset:3072 sc1 lds
    s_waitcnt vmcnt(4)
    s_barrier
    ds_read_b128 v[40:43], v12 offset:0
    ds_read_b128 v[44:47], v13 offset:0
    ds_read_b128 v[48:51], v12 offset:2048
    ds_read_b128 v[52:55], v13 offset:2048
    ds_read_b128 v[56:59], v12 offset:4096
    ds_read_b128 v[60:63], v13 offset:4096
    ds_read_b128 v[64:67], v12 offset:6144
    ds_read_b128 v[68:71], v13 offset:6144
    s_waitcnt lgkmcnt(7)
    v_mfma_f32_16x16x32_bf16 v[24:27], v[80:83], v[40:43], 0
    v_mfma_f32_16x16x32_bf16 v[28:31], v[84:87], v[40:43], 0
    s_waitcnt lgkmcnt(6)
    v_mfma_f32_16x16x32_bf16 v[32:35], v[88:91], v[44:47], 0
    v_mfma_f32_16x16x32_bf16 v[36:39], v[92:95], v[44:47], 0
    s_waitcnt lgkmcnt(5)
    v_mfma_f32_16x16x32_bf16 v[24:27], v[96:99], v[48:51], v[24:27]
    v_mfma_f32_16x16x32_bf16 v[28:31], v[100:103], v[48:51], v[28:31]
    s_waitcnt lgkmcnt(4)
    v_mfma_f32_16x16x32_bf16 v[32:35], v[104:107], v[52:55], v[32:35]
    v_mfma_f32_16x16x32_bf16 v[36:39], v[108:111], v[52:55], v[36:39]
    ds_read_b128 v[40:43], v12 offset:8192
    ds_read_b128 v[44:47], v13 offset:8192
    ds_read_b128 v[48:51], v12 offset:10240
    ds_read_b128 v[52:55], v13 offset:10240
    s_waitcnt lgkmcnt(7)
    v_mfma_f32_16x16x32_bf16 v[24:27], v[112:115], v[56:59], v[24:27]
    v_mfma_f32_16x16x32_bf16 v[28:31], v[116:119], v[56:59], v[28:31]
    s_waitcnt lgkmcnt(6)
    v_mfma_f32_16x16x32_bf16 v[32:35], v[120:123], v[60:63], v[32:35]
    v_mfma_f32_16x16x32_bf16 v[36:39], v[124:127], v[60:63], v[36:39]
    s_waitcnt lgkmcnt(5)
    v_mfma_f32_16x16x32_bf16 v[24:27], v[128:131], v[64:67], v[24:27]
    v_mfma_f32_16x16x32_bf16 v[28:31], v[132:135], v[64:67], v[28:31]
    s_waitcnt lgkmcnt(4)
    v_mfma_f32_16x16x32_bf16 v[32:35], v[136:139], v[68:71], v[32:35]
    v_mfma_f32_16x16x32_bf16 v[36:39], v[140:143], v[68:71], v[36:39]
    ds_read_b128 v[56:59], v12 offset:12288
    ds_read_b128 v[60:63], v13 offset:12288
    ds_read_b128 v[64:67], v12 offset:14336
    ds_read_b128 v[68:71], v13 offset:14336
    s_waitcnt lgkmcnt(7)
    v_mfma_f32_16x16x32_bf16 v[24:27], v[144:147], v[40:43], v[24:27]
    v_mfma_f32_16x16x32_bf16 v[28:31], v[148:151], v[40:43], v[28:31]
    s_waitcnt lgkmcnt(6)
    v_mfma_f32_16x16x32_bf16 v[32:35], v[152:155], v[44:47], v[32:35]
    v_mfma_f32_16x16x32_bf16 v[36:39], v[156:159], v[44:47], v[36:39]
    s_waitcnt lgkmcnt(5)
    v_mfma_f32_16x16x32_bf16 v[24:27], v[160:163], v[48:51], v[24:27]
    v_mfma_f32_16x16x32_bf16 v[28:31], v[164:167], v[48:51], v[28:31]
    s_waitcnt lgkmcnt(4)
    v_mfma_f32_16x16x32_bf16 v[32:35], v[168:171], v[52:55], v[32:35]
    v_mfma_f32_16x16x32_bf16 v[36:39], v[172:175], v[52:55], v[36:39]
    s_waitcnt vmcnt(0)
    s_barrier
    ds_read_b128 v[40:43], v12 offset:16384
    ds_read_b128 v[44:47], v13 offset:16384
    ds_read_b128 v[48:51], v12 offset:18432
    ds_read_b128 v[52:55], v13 offset:18432
    s_waitcnt lgkmcnt(7)
    v_mfma_f32_16x16x32_bf16 v[24:27], v[176:179], v[56:59], v[24:27]
    v_mfma_f32_16x16x32_bf16 v[28:31], v[180:183], v[56:59], v[28:31]
    s_waitcnt lgkmcnt(6)
    v_mfma_f32_16x16x32_bf16 v[32:35], v[184:187], v[60:63], v[32:35]
    v_mfma_f32_16x16x32_bf16 v[36:39], v[188:191], v[60:63], v[36:39]
    s_waitcnt lgkmcnt(5)
    v_mfma_f32_16x16x32_bf16 v[24:27], v[192:195], v[64:67], v[24:27]
    v_mfma_f32_16x16x32_bf16 v[28:31], v[196:199], v[64:67], v[28:31]
    s_waitcnt lgkmcnt(4)
    v_mfma_f32_16x16x32_bf16 v[32:35], v[200:203], v[68:71], v[32:35]
    v_mfma_f32_16x16x32_bf16 v[36:39], v[204:207], v[68:71], v[36:39]
    ds_read_b128 v[56:59], v12 offset:20480
    ds_read_b128 v[60:63], v13 offset:20480
    ds_read_b128 v[64:67], v12 offset:22528
    ds_read_b128 v[68:71], v13 offset:22528
    s_waitcnt lgkmcnt(7)
    v_mfma_f32_16x16x32_bf16 v[24:27], v[208:211], v[40:43], v[24:27]
    v_mfma_f32_16x16x32_bf16 v[28:31], v[212:215], v[40:43], v[28:31]
    s_waitcnt lgkmcnt(6)
    v_mfma_f32_16x16x32_bf16 v[32:35], v[216:219], v[44:47], v[32:35]
    v_mfma_f32_16x16x32_bf16 v[36:39], v[220:223], v[44:47], v[36:39]
    s_waitcnt lgkmcnt(5)
    v_mfma_f32_16x16x32_bf16 v[24:27], v[224:227], v[48:51], v[24:27]
    v_mfma_f32_16x16x32_bf16 v[28:31], v[228:231], v[48:51], v[28:31]
    s_waitcnt lgkmcnt(4)
    v_mfma_f32_16x16x32_bf16 v[32:35], v[232:235], v[52:55], v[32:35]
    v_mfma_f32_16x16x32_bf16 v[36:39], v[236:239], v[52:55], v[36:39]
    ds_read_b128 v[40:43], v12 offset:24576
    ds_read_b128 v[44:47], v13 offset:24576
    ds_read_b128 v[48:51], v12 offset:26624
    ds_read_b128 v[52:55], v13 offset:26624
    s_waitcnt lgkmcnt(7)
    v_mfma_f32_16x16x32_bf16 v[24:27], v[240:243], v[56:59], v[24:27]
    v_mfma_f32_16x16x32_bf16 v[28:31], v[244:247], v[56:59], v[28:31]
    s_waitcnt lgkmcnt(6)
    v_mfma_f32_16x16x32_bf16 v[32:35], v[248:251], v[60:63], v[32:35]
    v_mfma_f32_16x16x32_bf16 v[36:39], v[252:255], v[60:63], v[36:39]
    s_waitcnt lgkmcnt(5)
    v_mfma_f32_16x16x32_bf16 v[24:27], a[0:3], v[64:67], v[24:27]
    v_mfma_f32_16x16x32_bf16 v[28:31], a[4:7], v[64:67], v[28:31]
    s_waitcnt lgkmcnt(4)
    v_mfma_f32_16x16x32_bf16 v[32:35], a[8:11], v[68:71], v[32:35]
    v_mfma_f32_16x16x32_bf16 v[36:39], a[12:15], v[68:71], v[36:39]
    ds_read_b128 v[56:59], v12 offset:28672
    ds_read_b128 v[60:63], v13 offset:28672
    ds_read_b128 v[64:67], v12 offset:30720
    ds_read_b128 v[68:71], v13 offset:30720
    s_waitcnt lgkmcnt(7)
    v_mfma_f32_16x16x32_bf16 v[24:27], a[16:19], v[40:43], v[24:27]
    v_mfma_f32_16x16x32_bf16 v[28:31], a[20:23], v[40:43], v[28:31]
    s_waitcnt lgkmcnt(6)
    v_mfma_f32_16x16x32_bf16 v[32:35], a[24:27], v[44:47], v[32:35]
    v_mfma_f32_16x16x32_bf16 v[36:39], a[28:31], v[44:47], v[36:39]
    s_waitcnt lgkmcnt(5)
    v_mfma_f32_16x16x32_bf16 v[24:27], a[32:35], v[48:51], v[24:27]
    v_mfma_f32_16x16x32_bf16 v[28:31], a[36:39], v[48:51], v[28:31]
    s_waitcnt lgkmcnt(4)
    v_mfma_f32_16x16x32_bf16 v[32:35], a[40:43], v[52:55], v[32:35]
    v_mfma_f32_16x16x32_bf16 v[36:39], a[44:47], v[52:55], v[36:39]
    s_waitcnt lgkmcnt(3)
    v_mfma_f32_16x16x32_bf16 v[24:27], a[48:51], v[56:59], v[24:27]
    v_mfma_f32_16x16x32_bf16 v[28:31], a[52:55], v[56:59], v[28:31]
    s_waitcnt lgkmcnt(2)
    v_mfma_f32_16x16x32_bf16 v[32:35], a[56:59], v[60:63], v[32:35]
    v_mfma_f32_16x16x32_bf16 v[36:39], a[60:63], v[60:63], v[36:39]
    s_waitcnt lgkmcnt(1)
    v_mfma_f32_16x16x32_bf16 v[24:27], a[64:67], v[64:67], v[24:27]
    v_mfma_f32_16x16x32_bf16 v[28:31], a[68:71], v[64:67], v[28:31]
    s_waitcnt lgkmcnt(0)
    v_mfma_f32_16x16x32_bf16 v[32:35], a[72:75], v[68:71], v[32:35]
    v_mfma_f32_16x16x32_bf16 v[36:39], a[76:79], v[68:71], v[36:39]
    s_nop 6
    v_pk_add_f32 v[24:25], v[24:25], v[32:33]
    v_pk_add_f32 v[26:27], v[26:27], v[34:35]
    v_pk_add_f32 v[28:29], v[28:29], v[36:37]
    v_pk_add_f32 v[30:31], v[30:31], v[38:39]
    buffer_store_dwordx4 v[24:27], v4, s[4:7], s33 offen offset:0 sc1
    buffer_store_dwordx4 v[28:31], v4, s[4:7], s33 offen offset:2048 sc1
    s_waitcnt vmcnt(0) lgkmcnt(0)
    s_barrier
    s_cmp_lg_u32 s29, 0
    s_cbranch_scc1 wk_wo_sg
    s_lshl_b32 s38, s52, 7
    s_add_u32 s38, s38, 278528
    v_mov_b32 v2, 0
    v_mov_b32 v3, 1
    s_mov_b64 exec, 1
    buffer_atomic_add v3, v2, s[4:7], s38 offen
    s_mov_b64 exec, -1
wk_wo_sg:
    s_cmp_lt_u32 s52, 16
    s_cselect_b32 s38, 1, 2
    s_add_u32 s52, s52, s38
    s_cmp_lt_u32 s52, 64
    s_cbranch_scc1 wk_wo_loop
    s_endpgm
wk_ln2:
    s_cmp_lg_u32 s29, 0
    s_cbranch_scc1 wk_ln2_mb_dw
    v_mov_b32 v2, 140
wk_ln2_mb_sp:
    buffer_load_dword v3, v2, s[8:11], 0 offen sc1
    s_waitcnt vmcnt(0)
    v_readfirstlane_b32 s37, v3
    s_nop 0
    s_cmp_ge_u32 s37, 80
    s_cbranch_scc1 wk_ln2_mb_dw
    s_sleep 4
    s_branch wk_ln2_mb_sp
wk_ln2_mb_dw:
    s_barrier
    v_lshlrev_b32 v10, 4, v1
    v_and_b32 v11, 0x1f0, v10
    v_lshrrev_b32 v12, 1, v10
    v_lshrrev_b32 v13, 1, v11
    s_mov_b32 s32, 5120
    buffer_load_dwordx4 v[16:19], v10, s[4:7], s32 offen offset:0 sc1
    buffer_load_dwordx4 v[20:23], v10, s[4:7], s32 offen offset:1024 sc1
    buffer_load_dwordx4 v[24:27], v11, s[4:7], s32 offen offset:2048 sc1
    s_mov_b32 s32, 7680
    buffer_load_dwordx4 v[28:31], v10, s[4:7], s32 offen offset:0 sc1
    buffer_load_dwordx4 v[32:35], v10, s[4:7], s32 offen offset:1024 sc1
    buffer_load_dwordx4 v[36:39], v11, s[4:7], s32 offen offset:2048 sc1
    s_mov_b32 s32, 10240
    buffer_load_dwordx4 v[40:43], v10, s[4:7], s32 offen offset:0 sc1
    buffer_load_dwordx4 v[44:47], v10, s[4:7], s32 offen offset:1024 sc1
    buffer_load_dwordx4 v[48:51], v11, s[4:7], s32 offen offset:2048 sc1
    s_lshl_b32 s30, s53, 2
    s_add_u32 s30, s30, s29
    v_lshrrev_b32 v4, 2, v1
    v_and_b32 v5, 3, v1
    v_lshlrev_b32 v5, 4, v5
    v_lshl_add_u32 v14, v4, 11, v5
    v_and_b32 v4, 7, v4
    v_lshl_add_u32 v15, v4, 11, v5
    v_lshrrev_b32 v4, 5, v1
    v_mul_u32_u24 v4, 81920, v4
    v_add_u32 v15, v15, v4
    v_lshrrev_b32 v4, 4, v1
    v_lshl_add_u32 v8, v4, 12, v5
    v_bfe_u32 v4, v1, 3, 1
    v_lshl_add_u32 v8, v4, 6, v8
    v_bfe_u32 v4, v1, 2, 1
    v_lshl_add_u32 v8, v4, 3, v8
    v_and_b32 v9, 0x1fff, v8
    s_lshr_b32 s56, s30, 4
    s_lshl_b32 s56, s56, 10
    s_and_b32 s57, s30, 15
    s_lshl_b32 s57, s57, 6
    s_add_u32 s56, s56, s57
    s_add_u32 s56, s56, 109051904
    s_lshl_b32 s57, s30, 7
    s_add_u32 s57, s57, 64487424
    s_mul_i32 s58, s30, 1280
    s_waitcnt vmcnt(0)
    v_add_f32 v40, 1.0, v40
    v_add_f32 v41, 1.0, v41
    v_add_f32 v42, 1.0, v42
    v_add_f32 v43, 1.0, v43
    v_add_f32 v44, 1.0, v44
    v_add_f32 v45, 1.0, v45
    v_add_f32 v46, 1.0, v46
    v_add_f32 v47, 1.0, v47
    v_add_f32 v48, 1.0, v48
    v_add_f32 v49, 1.0, v49
    v_add_f32 v50, 1.0, v50
    v_add_f32 v51, 1.0, v51
    v_cvt_pk_bf16_f32 v7, v40, v41
    v_lshlrev_b32 v40, 16, v7
    v_and_b32 v41, 0xffff0000, v7
    v_cvt_pk_bf16_f32 v7, v42, v43
    v_lshlrev_b32 v42, 16, v7
    v_and_b32 v43, 0xffff0000, v7
    v_cvt_pk_bf16_f32 v7, v44, v45
    v_lshlrev_b32 v44, 16, v7
    v_and_b32 v45, 0xffff0000, v7
    v_cvt_pk_bf16_f32 v7, v46, v47
    v_lshlrev_b32 v46, 16, v7
    v_and_b32 v47, 0xffff0000, v7
    v_cvt_pk_bf16_f32 v7, v48, v49
    v_lshlrev_b32 v48, 16, v7
    v_and_b32 v49, 0xffff0000, v7
    v_cvt_pk_bf16_f32 v7, v50, v51
    v_lshlrev_b32 v50, 16, v7
    v_and_b32 v51, 0xffff0000, v7
    s_mov_b32 s96, -1
    s_mov_b32 s97, 0
    s_mov_b32 s98, 0x3acccccd
    s_mov_b32 s99, 0x3727c5ac
wk_ln2_loop:
    s_mul_i32 s31, s52, 40960
    s_add_u32 s41, s31, s57
    s_add_u32 s31, s31, s58
    s_add_u32 s40, s31, 61865984
    s_mul_i32 s36, s52, 327680
    s_add_u32 s36, s36, s56
    s_cmp_lg_u32 s29, 0
    s_cbranch_scc1 wk_ln2_dw
    s_lshl_b32 s39, s52, 7
    s_add_u32 s39, s39, 278528
    v_mov_b32 v2, 0
wk_ln2_sp:
    buffer_load_dword v3, v2, s[4:7], s39 offen sc1
    s_waitcnt vmcnt(0)
    v_readfirstlane_b32 s37, v3
    s_nop 0
    s_cmp_ge_u32 s37, 40
    s_cbranch_scc1 wk_ln2_dw
    s_sleep 6
    s_branch wk_ln2_sp
wk_ln2_dw:
    s_barrier
    s_add_u32 s33, s36, 0
    s_add_u32 s34, s36, 32768
    buffer_load_dwordx4 v[64:67], v14, s[4:7], s33 offen sc1
    buffer_load_dwordx4 v[68:71], v14, s[4:7], s34 offen sc1
    s_add_u32 s35, s36, 65536
    buffer_load_dwordx4 v[72:75], v15, s[4:7], s35 offen sc1
    s_add_u32 s33, s36, 81920
    s_add_u32 s34, s36, 114688
    buffer_load_dwordx4 v[76:79], v14, s[4:7], s33 offen sc1
    buffer_load_dwordx4 v[80:83], v14, s[4:7], s34 offen sc1
    s_add_u32 s33, s36, 163840
    s_add_u32 s34, s36, 196608
    buffer_load_dwordx4 v[88:91], v14, s[4:7], s33 offen sc1
    buffer_load_dwordx4 v[92:95], v14, s[4:7], s34 offen sc1
    s_add_u32 s35, s36, 229376
    buffer_load_dwordx4 v[96:99], v15, s[4:7], s35 offen sc1
    s_add_u32 s33, s36, 245760
    s_add_u32 s34, s36, 278528
    buffer_load_dwordx4 v[100:103], v14, s[4:7], s33 offen sc1
    buffer_load_dwordx4 v[104:107], v14, s[4:7], s34 offen sc1
    buffer_load_dwordx2 v[52:53], v12, s[76:79], s31 offen offset:0
    buffer_load_dwordx2 v[54:55], v12, s[76:79], s31 offen offset:512
    buffer_load_dwordx2 v[56:57], v13, s[76:79], s31 offen offset:1024
    s_add_u32 s42, s41, 16384
    s_add_u32 s43, s41, 32768
    s_waitcnt vmcnt(8)
    v_pk_add_f32 v[64:65], v[64:65], v[76:77]
    v_pk_add_f32 v[66:67], v[66:67], v[78:79]
    v_pk_add_f32 v[68:69], v[68:69], v[80:81]
    v_pk_add_f32 v[70:71], v[70:71], v[82:83]
    s_waitcnt vmcnt(5)
    v_pk_add_f32 v[64:65], v[64:65], v[88:89]
    v_pk_add_f32 v[66:67], v[66:67], v[90:91]
    v_pk_add_f32 v[68:69], v[68:69], v[92:93]
    v_pk_add_f32 v[70:71], v[70:71], v[94:95]
    v_pk_add_f32 v[72:73], v[72:73], v[96:97]
    v_pk_add_f32 v[74:75], v[74:75], v[98:99]
    s_waitcnt vmcnt(3)
    v_pk_add_f32 v[64:65], v[64:65], v[100:101]
    v_pk_add_f32 v[66:67], v[66:67], v[102:103]
    v_pk_add_f32 v[68:69], v[68:69], v[104:105]
    v_pk_add_f32 v[70:71], v[70:71], v[106:107]
    v_mov_b32 v84, v72
    v_mov_b32 v85, v73
    v_mov_b32 v86, v74
    v_mov_b32 v87, v75
    v_permlane32_swap_b32 v72, v84
    v_permlane32_swap_b32 v73, v85
    v_permlane32_swap_b32 v74, v86
    v_permlane32_swap_b32 v75, v87
    v_pk_add_f32 v[72:73], v[72:73], v[84:85]
    v_pk_add_f32 v[74:75], v[74:75], v[86:87]
    s_waitcnt vmcnt(0)
    v_cvt_pk_bf16_f32 v7, v64, v65
    v_lshlrev_b32 v64, 16, v7
    v_and_b32 v65, 0xffff0000, v7
    v_pk_mul_f32 v[64:65], v[64:65], v[16:17]
    v_cvt_pk_bf16_f32 v7, v64, v65
    v_lshlrev_b32 v64, 16, v7
    v_and_b32 v65, 0xffff0000, v7
    v_lshlrev_b32 v4, 16, v52
    v_and_b32 v5, 0xffff0000, v52
    v_pk_add_f32 v[64:65], v[64:65], v[4:5]
    v_cvt_pk_bf16_f32 v52, v64, v65
    v_lshlrev_b32 v64, 16, v52
    v_and_b32 v65, 0xffff0000, v52
    v_cvt_pk_bf16_f32 v7, v66, v67
    v_lshlrev_b32 v66, 16, v7
    v_and_b32 v67, 0xffff0000, v7
    v_pk_mul_f32 v[66:67], v[66:67], v[18:19]
    v_cvt_pk_bf16_f32 v7, v66, v67
    v_lshlrev_b32 v66, 16, v7
    v_and_b32 v67, 0xffff0000, v7
    v_lshlrev_b32 v4, 16, v53
    v_and_b32 v5, 0xffff0000, v53
    v_pk_add_f32 v[66:67], v[66:67], v[4:5]
    v_cvt_pk_bf16_f32 v53, v66, v67
    v_lshlrev_b32 v66, 16, v53
    v_and_b32 v67, 0xffff0000, v53
    buffer_store_dwordx2 v[52:53], v12, s[4:7], s40 offen offset:0 sc1
    v_cvt_pk_bf16_f32 v7, v68, v69
    v_lshlrev_b32 v68, 16, v7
    v_and_b32 v69, 0xffff0000, v7
    v_pk_mul_f32 v[68:69], v[68:69], v[20:21]
    v_cvt_pk_bf16_f32 v7, v68, v69
    v_lshlrev_b32 v68, 16, v7
    v_and_b32 v69, 0xffff0000, v7
    v_lshlrev_b32 v4, 16, v54
    v_and_b32 v5, 0xffff0000, v54
    v_pk_add_f32 v[68:69], v[68:69], v[4:5]
    v_cvt_pk_bf16_f32 v54, v68, v69
    v_lshlrev_b32 v68, 16, v54
    v_and_b32 v69, 0xffff0000, v54
    v_cvt_pk_bf16_f32 v7, v70, v71
    v_lshlrev_b32 v70, 16, v7
    v_and_b32 v71, 0xffff0000, v7
    v_pk_mul_f32 v[70:71], v[70:71], v[22:23]
    v_cvt_pk_bf16_f32 v7, v70, v71
    v_lshlrev_b32 v70, 16, v7
    v_and_b32 v71, 0xffff0000, v7
    v_lshlrev_b32 v4, 16, v55
    v_and_b32 v5, 0xffff0000, v55
    v_pk_add_f32 v[70:71], v[70:71], v[4:5]
    v_cvt_pk_bf16_f32 v55, v70, v71
    v_lshlrev_b32 v70, 16, v55
    v_and_b32 v71, 0xffff0000, v55
    buffer_store_dwordx2 v[54:55], v12, s[4:7], s40 offen offset:512 sc1
    v_cvt_pk_bf16_f32 v7, v72, v73
    v_lshlrev_b32 v72, 16, v7
    v_and_b32 v73, 0xffff0000, v7
    v_pk_mul_f32 v[72:73], v[72:73], v[24:25]
    v_cvt_pk_bf16_f32 v7, v72, v73
    v_lshlrev_b32 v72, 16, v7
    v_and_b32 v73, 0xffff0000, v7
    v_lshlrev_b32 v4, 16, v56
    v_and_b32 v5, 0xffff0000, v56
    v_pk_add_f32 v[72:73], v[72:73], v[4:5]
    v_cvt_pk_bf16_f32 v56, v72, v73
    v_lshlrev_b32 v72, 16, v56
    v_and_b32 v73, 0xffff0000, v56
    v_cvt_pk_bf16_f32 v7, v74, v75
    v_lshlrev_b32 v74, 16, v7
    v_and_b32 v75, 0xffff0000, v7
    v_pk_mul_f32 v[74:75], v[74:75], v[26:27]
    v_cvt_pk_bf16_f32 v7, v74, v75
    v_lshlrev_b32 v74, 16, v7
    v_and_b32 v75, 0xffff0000, v7
    v_lshlrev_b32 v4, 16, v57
    v_and_b32 v5, 0xffff0000, v57
    v_pk_add_f32 v[74:75], v[74:75], v[4:5]
    v_cvt_pk_bf16_f32 v57, v74, v75
    v_lshlrev_b32 v74, 16, v57
    v_and_b32 v75, 0xffff0000, v57
    buffer_store_dwordx2 v[56:57], v13, s[4:7], s40 offen offset:1024 sc1
    v_pk_add_f32 v[4:5], v[72:73], v[74:75]
    v_add_f32 v4, v4, v5
    v_cndmask_b32 v6, 0, v4, s[96:97]
    v_pk_add_f32 v[4:5], v[64:65], v[66:67]
    v_pk_add_f32 v[4:5], v[4:5], v[68:69]
    v_pk_add_f32 v[4:5], v[4:5], v[70:71]
    v_add_f32 v4, v4, v5
    v_add_f32 v6, v6, v4
    s_nop 1
    v_add_f32_dpp v6, v6, v6 quad_perm:[1,0,3,2] row_mask:0xf bank_mask:0xf
    s_nop 1
    v_add_f32_dpp v6, v6, v6 quad_perm:[2,3,0,1] row_mask:0xf bank_mask:0xf
    s_nop 1
    v_add_f32_dpp v6, v6, v6 row_half_mirror row_mask:0xf bank_mask:0xf
    s_nop 1
    v_add_f32_dpp v6, v6, v6 row_mirror row_mask:0xf bank_mask:0xf
    v_mov_b32 v5, v6
    s_nop 1
    v_permlane16_swap_b32 v6, v5
    v_add_f32 v6, v6, v5
    v_mov_b32 v5, v6
    s_nop 1
    v_permlane32_swap_b32 v6, v5
    v_add_f32 v6, v6, v5
    v_mul_f32 v6, s98, v6
    v_mov_b32 v2, 0
    v_sub_f32 v5, v72, v6
    v_fmac_f32 v2, v5, v5
    v_sub_f32 v5, v73, v6
    v_fmac_f32 v2, v5, v5
    v_sub_f32 v5, v74, v6
    v_fmac_f32 v2, v5, v5
    v_sub_f32 v5, v75, v6
    v_fmac_f32 v2, v5, v5
    v_cndmask_b32 v2, 0, v2, s[96:97]
    v_sub_f32 v5, v64, v6
    v_fmac_f32 v2, v5, v5
    v_sub_f32 v5, v65, v6
    v_fmac_f32 v2, v5, v5
    v_sub_f32 v5, v66, v6
    v_fmac_f32 v2, v5, v5
    v_sub_f32 v5, v67, v6
    v_fmac_f32 v2, v5, v5
    v_sub_f32 v5, v68, v6
    v_fmac_f32 v2, v5, v5
    v_sub_f32 v5, v69, v6
    v_fmac_f32 v2, v5, v5
    v_sub_f32 v5, v70, v6
    v_fmac_f32 v2, v5, v5
    v_sub_f32 v5, v71, v6
    v_fmac_f32 v2, v5, v5
    s_nop 1
    v_add_f32_dpp v2, v2, v2 quad_perm:[1,0,3,2] row_mask:0xf bank_mask:0xf
    s_nop 1
    v_add_f32_dpp v2, v2, v2 quad_perm:[2,3,0,1] row_mask:0xf bank_mask:0xf
    s_nop 1
    v_add_f32_dpp v2, v2, v2 row_half_mirror row_mask:0xf bank_mask:0xf
    s_nop 1
    v_add_f32_dpp v2, v2, v2 row_mirror row_mask:0xf bank_mask:0xf
    v_mov_b32 v5, v2
    s_nop 1
    v_permlane16_swap_b32 v2, v5
    v_add_f32 v2, v2, v5
    v_mov_b32 v5, v2
    s_nop 1
    v_permlane32_swap_b32 v2, v5
    v_add_f32 v2, v2, v5
    v_mul_f32 v2, s98, v2
    v_cvt_pk_bf16_f32 v7, v6, v2
    v_lshlrev_b32 v6, 16, v7
    v_and_b32 v2, 0xffff0000, v7
    v_add_f32 v2, s99, v2
    v_cvt_pk_bf16_f32 v7, v2, v5
    v_lshlrev_b32 v2, 16, v7
    v_and_b32 v5, 0xffff0000, v7
    v_sqrt_f32 v2, v2
    s_nop 0
    v_cvt_pk_bf16_f32 v7, v2, v5
    v_lshlrev_b32 v2, 16, v7
    v_and_b32 v5, 0xffff0000, v7
    v_rcp_f32 v2, v2
    v_sub_f32 v64, v64, v6
    v_sub_f32 v65, v65, v6
    v_cvt_pk_bf16_f32 v7, v64, v65
    v_lshlrev_b32 v64, 16, v7
    v_and_b32 v65, 0xffff0000, v7
    v_mul_f32 v64, v64, v2
    v_mul_f32 v65, v65, v2
    v_cvt_pk_bf16_f32 v7, v64, v65
    v_lshlrev_b32 v64, 16, v7
    v_and_b32 v65, 0xffff0000, v7
    v_pk_mul_f32 v[64:65], v[64:65], v[40:41]
    v_cvt_pk_bf16_f32 v7, v64, v65
    v_lshlrev_b32 v64, 16, v7
    v_and_b32 v65, 0xffff0000, v7
    v_pk_add_f32 v[64:65], v[64:65], v[28:29]
    v_cvt_pk_bf16_f32 v76, v64, v65
    v_sub_f32 v66, v66, v6
    v_sub_f32 v67, v67, v6
    v_cvt_pk_bf16_f32 v7, v66, v67
    v_lshlrev_b32 v66, 16, v7
    v_and_b32 v67, 0xffff0000, v7
    v_mul_f32 v66, v66, v2
    v_mul_f32 v67, v67, v2
    v_cvt_pk_bf16_f32 v7, v66, v67
    v_lshlrev_b32 v66, 16, v7
    v_and_b32 v67, 0xffff0000, v7
    v_pk_mul_f32 v[66:67], v[66:67], v[42:43]
    v_cvt_pk_bf16_f32 v7, v66, v67
    v_lshlrev_b32 v66, 16, v7
    v_and_b32 v67, 0xffff0000, v7
    v_pk_add_f32 v[66:67], v[66:67], v[30:31]
    v_cvt_pk_bf16_f32 v77, v66, v67
    buffer_store_dwordx2 v[76:77], v8, s[4:7], s41 offen sc1
    v_sub_f32 v68, v68, v6
    v_sub_f32 v69, v69, v6
    v_cvt_pk_bf16_f32 v7, v68, v69
    v_lshlrev_b32 v68, 16, v7
    v_and_b32 v69, 0xffff0000, v7
    v_mul_f32 v68, v68, v2
    v_mul_f32 v69, v69, v2
    v_cvt_pk_bf16_f32 v7, v68, v69
    v_lshlrev_b32 v68, 16, v7
    v_and_b32 v69, 0xffff0000, v7
    v_pk_mul_f32 v[68:69], v[68:69], v[44:45]
    v_cvt_pk_bf16_f32 v7, v68, v69
    v_lshlrev_b32 v68, 16, v7
    v_and_b32 v69, 0xffff0000, v7
    v_pk_add_f32 v[68:69], v[68:69], v[32:33]
    v_cvt_pk_bf16_f32 v78, v68, v69
    v_sub_f32 v70, v70, v6
    v_sub_f32 v71, v71, v6
    v_cvt_pk_bf16_f32 v7, v70, v71
    v_lshlrev_b32 v70, 16, v7
    v_and_b32 v71, 0xffff0000, v7
    v_mul_f32 v70, v70, v2
    v_mul_f32 v71, v71, v2
    v_cvt_pk_bf16_f32 v7, v70, v71
    v_lshlrev_b32 v70, 16, v7
    v_and_b32 v71, 0xffff0000, v7
    v_pk_mul_f32 v[70:71], v[70:71], v[46:47]
    v_cvt_pk_bf16_f32 v7, v70, v71
    v_lshlrev_b32 v70, 16, v7
    v_and_b32 v71, 0xffff0000, v7
    v_pk_add_f32 v[70:71], v[70:71], v[34:35]
    v_cvt_pk_bf16_f32 v79, v70, v71
    buffer_store_dwordx2 v[78:79], v8, s[4:7], s42 offen sc1
    v_sub_f32 v72, v72, v6
    v_sub_f32 v73, v73, v6
    v_cvt_pk_bf16_f32 v7, v72, v73
    v_lshlrev_b32 v72, 16, v7
    v_and_b32 v73, 0xffff0000, v7
    v_mul_f32 v72, v72, v2
    v_mul_f32 v73, v73, v2
    v_cvt_pk_bf16_f32 v7, v72, v73
    v_lshlrev_b32 v72, 16, v7
    v_and_b32 v73, 0xffff0000, v7
    v_pk_mul_f32 v[72:73], v[72:73], v[48:49]
    v_cvt_pk_bf16_f32 v7, v72, v73
    v_lshlrev_b32 v72, 16, v7
    v_and_b32 v73, 0xffff0000, v7
    v_pk_add_f32 v[72:73], v[72:73], v[36:37]
    v_cvt_pk_bf16_f32 v80, v72, v73
    v_sub_f32 v74, v74, v6
    v_sub_f32 v75, v75, v6
    v_cvt_pk_bf16_f32 v7, v74, v75
    v_lshlrev_b32 v74, 16, v7
    v_and_b32 v75, 0xffff0000, v7
    v_mul_f32 v74, v74, v2
    v_mul_f32 v75, v75, v2
    v_cvt_pk_bf16_f32 v7, v74, v75
    v_lshlrev_b32 v74, 16, v7
    v_and_b32 v75, 0xffff0000, v7
    v_pk_mul_f32 v[74:75], v[74:75], v[50:51]
    v_cvt_pk_bf16_f32 v7, v74, v75
    v_lshlrev_b32 v74, 16, v7
    v_and_b32 v75, 0xffff0000, v7
    v_pk_add_f32 v[74:75], v[74:75], v[38:39]
    v_cvt_pk_bf16_f32 v81, v74, v75
    buffer_store_dwordx2 v[80:81], v9, s[4:7], s43 offen sc1
    s_waitcnt vmcnt(0) lgkmcnt(0)
    s_barrier
    s_cmp_lg_u32 s29, 0
    s_cbranch_scc1 wk_ln2_sg
    s_lshl_b32 s38, s52, 7
    s_add_u32 s38, s38, 286720
    v_mov_b32 v2, 0
    v_mov_b32 v3, 1
    s_mov_b64 exec, 1
    buffer_atomic_add v3, v2, s[4:7], s38 offen
    s_mov_b64 exec, -1
wk_ln2_sg:
    s_cmp_lt_u32 s52, 16
    s_cselect_b32 s38, 1, 2
    s_add_u32 s52, s52, s38
    s_cmp_lt_u32 s52, 64
    s_cbranch_scc1 wk_ln2_loop
    s_endpgm
wk_up:
    s_lshl_b32 s58, s53, 7
    s_mov_b32 s59, s58
    v_lshrrev_b32 v2, 3, v1
    s_mov_b32 s43, 128
    v_mul_lo_u32 v2, v2, s43
    v_and_b32 v3, 7, v1
    v_lshrrev_b32 v4, 4, v1
    v_xor_b32 v5, v3, v4
    v_lshl_add_u32 v8, v5, 4, v2
    v_xor_b32 v5, 4, v5
    v_lshl_add_u32 v9, v5, 4, v2
    s_mov_b32 s43, 3456
    v_and_b32 v6, 1, v1
    v_lshlrev_b32 v6, 4, v6
    v_lshrrev_b32 v2, 3, v1
    v_mul_lo_u32 v2, v2, s43
    v_add_u32 v2, v2, v6
    v_bfe_u32 v5, v1, 1, 2
    v_xor_b32 v5, v5, v4
    v_lshl_add_u32 v10, v5, 5, v2
    v_mov_b32 v11, v10
    s_mov_b32 s43, 3456
    v_and_b32 v6, 1, v1
    v_lshlrev_b32 v6, 4, v6
    v_lshrrev_b32 v2, 3, v1
    v_mul_lo_u32 v2, v2, s43
    v_add_u32 v2, v2, v6
    v_bfe_u32 v5, v1, 1, 2
    v_xor_b32 v5, v5, v4
    v_lshl_add_u32 v12, v5, 5, v2
    v_mov_b32 v13, v12
    v_and_b32 v2, 15, v1
    v_lshrrev_b32 v3, 1, v2
    v_xor_b32 v3, v3, v4
    v_lshlrev_b32 v3, 4, v3
    v_lshl_add_u32 v3, v2, 7, v3
    s_lshr_b32 s43, s29, 1
    s_mul_i32 s43, s43, 2048
    s_add_u32 s43, s43, 0
    v_add_u32 v14, s43, v3
    v_xor_b32 v15, 64, v14
    v_bfe_u32 v2, v1, 2, 2
    v_lshl_add_u32 v2, v4, 2, v2
    v_and_b32 v3, 3, v1
    v_lshlrev_b32 v3, 3, v3
    s_and_b32 s43, s29, 1
    s_mul_i32 s43, s43, 2
    s_add_u32 s43, s43, 0
    v_bfe_u32 v5, v2, 1, 2
    v_xor_b32 v5, s43, v5
    v_lshl_add_u32 v5, v5, 5, v3
    v_lshl_add_u32 v5, v2, 7, v5
    v_add_u32 v16, 4096, v5
    s_and_b32 s43, s29, 1
    s_mul_i32 s43, s43, 2
    s_add_u32 s43, s43, 1
    v_bfe_u32 v5, v2, 1, 2
    v_xor_b32 v5, s43, v5
    v_lshl_add_u32 v5, v5, 5, v3
    v_lshl_add_u32 v5, v2, 7, v5
    v_add_u32 v17, 4096, v5
    s_and_b32 s43, s29, 1
    s_mul_i32 s43, s43, 2
    s_add_u32 s43, s43, 0
    v_bfe_u32 v5, v2, 1, 2
    v_xor_b32 v5, s43, v5
    v_lshl_add_u32 v5, v5, 5, v3
    v_lshl_add_u32 v5, v2, 7, v5
    v_add_u32 v18, 12288, v5
    s_and_b32 s43, s29, 1
    s_mul_i32 s43, s43, 2
    s_add_u32 s43, s43, 1
    v_bfe_u32 v5, v2, 1, 2
    v_xor_b32 v5, s43, v5
    v_lshl_add_u32 v5, v5, 5, v3
    v_lshl_add_u32 v5, v2, 7, v5
    v_add_u32 v19, 12288, v5
    s_mov_b32 s57, 0
    s_mul_i32 s43, s29, 1024
    s_add_u32 s40, s57, s43
    s_mul_i32 s45, s29, 1024
    s_mul_i32 s43, s29, 55296
    s_add_u32 s41, s58, s43
    s_mul_i32 s43, s29, 55296
    s_add_u32 s42, s59, s43
    s_mul_i32 s46, s29, 2048
    s_and_b32 s57, s29, 1
    s_cmp_eq_u32 s57, 1
    s_cselect_b64 vcc, -1, 0
    v_cndmask_b32 v20, v8, v9, vcc
    v_cndmask_b32 v21, v9, v8, vcc
    v_add_u32 v22, 0x10000, v14
    v_add_u32 v23, 0x10000, v15
    s_add_u32 m0, s46, 4096
    s_nop 0
    buffer_load_dwordx4 v10, s[64:67], s41 offen  lds
    s_add_u32 m0, s46, 5120
    s_add_u32 s43, s41, 27648
    buffer_load_dwordx4 v11, s[64:67], s43 offen  lds
    s_add_u32 s41, s41, 221184
    s_add_u32 m0, s46, 12288
    s_nop 0
    buffer_load_dwordx4 v12, s[68:71], s42 offen  lds
    s_add_u32 m0, s46, 13312
    s_add_u32 s43, s42, 27648
    buffer_load_dwordx4 v13, s[68:71], s43 offen  lds
    s_add_u32 s42, s42, 221184
    s_add_u32 m0, s46, 24576
    s_nop 0
    buffer_load_dwordx4 v10, s[64:67], s41 offen  lds
    s_add_u32 m0, s46, 25600
    s_add_u32 s43, s41, 27648
    buffer_load_dwordx4 v11, s[64:67], s43 offen  lds
    s_add_u32 s41, s41, 221184
    s_add_u32 m0, s46, 32768
    s_nop 0
    buffer_load_dwordx4 v12, s[68:71], s42 offen  lds
    s_add_u32 m0, s46, 33792
    s_add_u32 s43, s42, 27648
    buffer_load_dwordx4 v13, s[68:71], s43 offen  lds
    s_add_u32 s42, s42, 221184
    s_add_u32 m0, s46, 45056
    s_nop 0
    buffer_load_dwordx4 v10, s[64:67], s41 offen  lds
    s_add_u32 m0, s46, 46080
    s_add_u32 s43, s41, 27648
    buffer_load_dwordx4 v11, s[64:67], s43 offen  lds
    s_add_u32 s41, s41, 221184
    s_add_u32 m0, s46, 53248
    s_nop 0
    buffer_load_dwordx4 v12, s[68:71], s42 offen  lds
    s_add_u32 m0, s46, 54272
    s_add_u32 s43, s42, 27648
    buffer_load_dwordx4 v13, s[68:71], s43 offen  lds
    s_add_u32 s42, s42, 221184
    s_add_u32 m0, s46, 65536
    s_nop 0
    buffer_load_dwordx4 v10, s[64:67], s41 offen  lds
    s_add_u32 m0, s46, 66560
    s_add_u32 s43, s41, 27648
    buffer_load_dwordx4 v11, s[64:67], s43 offen  lds
    s_add_u32 s41, s41, 221184
    s_add_u32 m0, s46, 73728
    s_nop 0
    buffer_load_dwordx4 v12, s[68:71], s42 offen  lds
    s_add_u32 m0, s46, 74752
    s_add_u32 s43, s42, 27648
    buffer_load_dwordx4 v13, s[68:71], s43 offen  lds
    s_add_u32 s42, s42, 221184
    s_add_u32 m0, s46, 86016
    s_nop 0
    buffer_load_dwordx4 v10, s[64:67], s41 offen  lds
    s_add_u32 m0, s46, 87040
    s_add_u32 s43, s41, 27648
    buffer_load_dwordx4 v11, s[64:67], s43 offen  lds
    s_add_u32 s41, s41, 221184
    s_add_u32 m0, s46, 94208
    s_nop 0
    buffer_load_dwordx4 v12, s[68:71], s42 offen  lds
    s_add_u32 m0, s46, 95232
    s_add_u32 s43, s42, 27648
    buffer_load_dwordx4 v13, s[68:71], s43 offen  lds
    s_add_u32 s42, s42, 221184
    s_add_u32 m0, s46, 106496
    s_nop 0
    buffer_load_dwordx4 v10, s[64:67], s41 offen  lds
    s_add_u32 m0, s46, 107520
    s_add_u32 s43, s41, 27648
    buffer_load_dwordx4 v11, s[64:67], s43 offen  lds
    s_add_u32 s41, s41, 221184
    s_add_u32 m0, s46, 114688
    s_nop 0
    buffer_load_dwordx4 v12, s[68:71], s42 offen  lds
    s_add_u32 m0, s46, 115712
    s_add_u32 s43, s42, 27648
    buffer_load_dwordx4 v13, s[68:71], s43 offen  lds
    s_add_u32 s42, s42, 221184
    s_add_u32 m0, s46, 126976
    s_nop 0
    buffer_load_dwordx4 v10, s[64:67], s41 offen  lds
    s_add_u32 m0, s46, 128000
    s_add_u32 s43, s41, 27648
    buffer_load_dwordx4 v11, s[64:67], s43 offen  lds
    s_add_u32 s41, s41, 221184
    s_add_u32 m0, s46, 135168
    s_nop 0
    buffer_load_dwordx4 v12, s[68:71], s42 offen  lds
    s_add_u32 m0, s46, 136192
    s_add_u32 s43, s42, 27648
    buffer_load_dwordx4 v13, s[68:71], s43 offen  lds
    s_add_u32 s42, s42, 221184
    s_add_u32 m0, s46, 147456
    s_nop 0
    buffer_load_dwordx4 v10, s[64:67], s41 offen  lds
    s_add_u32 m0, s46, 148480
    s_add_u32 s43, s41, 27648
    buffer_load_dwordx4 v11, s[64:67], s43 offen  lds
    s_add_u32 s41, s41, 221184
    s_add_u32 m0, s46, 155648
    s_nop 0
    buffer_load_dwordx4 v12, s[68:71], s42 offen  lds
    s_add_u32 m0, s46, 156672
    s_add_u32 s43, s42, 27648
    buffer_load_dwordx4 v13, s[68:71], s43 offen  lds
    s_add_u32 s42, s42, 221184
    s_waitcnt vmcnt(28)
    s_barrier
    ds_read_b64_tr_b16 v[80:81], v16 offset:0
    ds_read_b64_tr_b16 v[82:83], v16 offset:2048
    ds_read_b64_tr_b16 v[84:85], v17 offset:0
    ds_read_b64_tr_b16 v[86:87], v17 offset:2048
    ds_read_b64_tr_b16 v[88:89], v18 offset:0
    ds_read_b64_tr_b16 v[90:91], v18 offset:2048
    ds_read_b64_tr_b16 v[92:93], v19 offset:0
    ds_read_b64_tr_b16 v[94:95], v19 offset:2048
    ds_read_b64_tr_b16 v[96:97], v16 offset:4096
    ds_read_b64_tr_b16 v[98:99], v16 offset:6144
    ds_read_b64_tr_b16 v[100:101], v17 offset:4096
    ds_read_b64_tr_b16 v[102:103], v17 offset:6144
    ds_read_b64_tr_b16 v[104:105], v18 offset:4096
    ds_read_b64_tr_b16 v[106:107], v18 offset:6144
    ds_read_b64_tr_b16 v[108:109], v19 offset:4096
    ds_read_b64_tr_b16 v[110:111], v19 offset:6144
    v_add_u32 v16, 20480, v16
    v_add_u32 v17, 20480, v17
    v_add_u32 v18, 20480, v18
    v_add_u32 v19, 20480, v19
    s_waitcnt lgkmcnt(0)
    s_waitcnt vmcnt(24)
    s_barrier
    s_add_u32 m0, s46, 4096
    s_nop 0
    buffer_load_dwordx4 v10, s[64:67], s41 offen  lds
    s_add_u32 m0, s46, 5120
    s_add_u32 s43, s41, 27648
    buffer_load_dwordx4 v11, s[64:67], s43 offen  lds
    s_add_u32 s41, s41, 221184
    s_add_u32 m0, s46, 12288
    s_nop 0
    buffer_load_dwordx4 v12, s[68:71], s42 offen  lds
    s_add_u32 m0, s46, 13312
    s_add_u32 s43, s42, 27648
    buffer_load_dwordx4 v13, s[68:71], s43 offen  lds
    s_add_u32 s42, s42, 221184
    ds_read_b64_tr_b16 v[112:113], v16 offset:0
    ds_read_b64_tr_b16 v[114:115], v16 offset:2048
    ds_read_b64_tr_b16 v[116:117], v17 offset:0
    ds_read_b64_tr_b16 v[118:119], v17 offset:2048
    ds_read_b64_tr_b16 v[120:121], v18 offset:0
    ds_read_b64_tr_b16 v[122:123], v18 offset:2048
    ds_read_b64_tr_b16 v[124:125], v19 offset:0
    ds_read_b64_tr_b16 v[126:127], v19 offset:2048
    ds_read_b64_tr_b16 v[128:129], v16 offset:4096
    ds_read_b64_tr_b16 v[130:131], v16 offset:6144
    ds_read_b64_tr_b16 v[132:133], v17 offset:4096
    ds_read_b64_tr_b16 v[134:135], v17 offset:6144
    ds_read_b64_tr_b16 v[136:137], v18 offset:4096
    ds_read_b64_tr_b16 v[138:139], v18 offset:6144
    ds_read_b64_tr_b16 v[140:141], v19 offset:4096
    ds_read_b64_tr_b16 v[142:143], v19 offset:6144
    v_add_u32 v16, 20480, v16
    v_add_u32 v17, 20480, v17
    v_add_u32 v18, 20480, v18
    v_add_u32 v19, 20480, v19
    s_waitcnt lgkmcnt(0)
    s_waitcnt vmcnt(24)
    s_barrier
    s_add_u32 m0, s46, 24576
    s_nop 0
    buffer_load_dwordx4 v10, s[64:67], s41 offen  lds
    s_add_u32 m0, s46, 25600
    s_add_u32 s43, s41, 27648
    buffer_load_dwordx4 v11, s[64:67], s43 offen  lds
    s_add_u32 s41, s41, 221184
    s_add_u32 m0, s46, 32768
    s_nop 0
    buffer_load_dwordx4 v12, s[68:71], s42 offen  lds
    s_add_u32 m0, s46, 33792
    s_add_u32 s43, s42, 27648
    buffer_load_dwordx4 v13, s[68:71], s43 offen  lds
    s_add_u32 s42, s42, 221184
    ds_read_b64_tr_b16 v[144:145], v16 offset:0
    ds_read_b64_tr_b16 v[146:147], v16 offset:2048
    ds_read_b64_tr_b16 v[148:149], v17 offset:0
    ds_read_b64_tr_b16 v[150:151], v17 offset:2048
    ds_read_b64_tr_b16 v[152:153], v18 offset:0
    ds_read_b64_tr_b16 v[154:155], v18 offset:2048
    ds_read_b64_tr_b16 v[156:157], v19 offset:0
    ds_read_b64_tr_b16 v[158:159], v19 offset:2048
    ds_read_b64_tr_b16 v[160:161], v16 offset:4096
    ds_read_b64_tr_b16 v[162:163], v16 offset:6144
    ds_read_b64_tr_b16 v[164:165], v17 offset:4096
    ds_read_b64_tr_b16 v[166:167], v17 offset:6144
    ds_read_b64_tr_b16 v[168:169], v18 offset:4096
    ds_read_b64_tr_b16 v[170:171], v18 offset:6144
    ds_read_b64_tr_b16 v[172:173], v19 offset:4096
    ds_read_b64_tr_b16 v[174:175], v19 offset:6144
    v_add_u32 v16, 20480, v16
    v_add_u32 v17, 20480, v17
    v_add_u32 v18, 20480, v18
    v_add_u32 v19, 20480, v19
    s_waitcnt lgkmcnt(0)
    s_waitcnt vmcnt(24)
    s_barrier
    ds_read_b64_tr_b16 v[176:177], v16 offset:0
    ds_read_b64_tr_b16 v[178:179], v16 offset:2048
    ds_read_b64_tr_b16 v[180:181], v17 offset:0
    ds_read_b64_tr_b16 v[182:183], v17 offset:2048
    ds_read_b64_tr_b16 v[184:185], v18 offset:0
    ds_read_b64_tr_b16 v[186:187], v18 offset:2048
    ds_read_b64_tr_b16 v[188:189], v19 offset:0
    ds_read_b64_tr_b16 v[190:191], v19 offset:2048
    ds_read_b64_tr_b16 v[192:193], v16 offset:4096
    ds_read_b64_tr_b16 v[194:195], v16 offset:6144
    ds_read_b64_tr_b16 v[196:197], v17 offset:4096
    ds_read_b64_tr_b16 v[198:199], v17 offset:6144
    ds_read_b64_tr_b16 v[200:201], v18 offset:4096
    ds_read_b64_tr_b16 v[202:203], v18 offset:6144
    ds_read_b64_tr_b16 v[204:205], v19 offset:4096
    ds_read_b64_tr_b16 v[206:207], v19 offset:6144
    v_add_u32 v16, 20480, v16
    v_add_u32 v17, 20480, v17
    v_add_u32 v18, 20480, v18
    v_add_u32 v19, 20480, v19
    s_waitcnt lgkmcnt(0)
    s_waitcnt vmcnt(20)
    s_barrier
    ds_read_b64_tr_b16 v[208:209], v16 offset:0
    ds_read_b64_tr_b16 v[210:211], v16 offset:2048
    ds_read_b64_tr_b16 v[212:213], v17 offset:0
    ds_read_b64_tr_b16 v[214:215], v17 offset:2048
    ds_read_b64_tr_b16 v[216:217], v18 offset:0
    ds_read_b64_tr_b16 v[218:219], v18 offset:2048
    ds_read_b64_tr_b16 v[220:221], v19 offset:0
    ds_read_b64_tr_b16 v[222:223], v19 offset:2048
    ds_read_b64_tr_b16 v[224:225], v16 offset:4096
    ds_read_b64_tr_b16 v[226:227], v16 offset:6144
    ds_read_b64_tr_b16 v[228:229], v17 offset:4096
    ds_read_b64_tr_b16 v[230:231], v17 offset:6144
    ds_read_b64_tr_b16 v[232:233], v18 offset:4096
    ds_read_b64_tr_b16 v[234:235], v18 offset:6144
    ds_read_b64_tr_b16 v[236:237], v19 offset:4096
    ds_read_b64_tr_b16 v[238:239], v19 offset:6144
    v_add_u32 v16, 20480, v16
    v_add_u32 v17, 20480, v17
    v_add_u32 v18, 20480, v18
    v_add_u32 v19, 20480, v19
    s_waitcnt lgkmcnt(0)
    s_waitcnt vmcnt(16)
    s_barrier
    ds_read_b64_tr_b16 v[240:241], v16 offset:0
    ds_read_b64_tr_b16 v[242:243], v16 offset:2048
    ds_read_b64_tr_b16 v[244:245], v17 offset:0
    ds_read_b64_tr_b16 v[246:247], v17 offset:2048
    ds_read_b64_tr_b16 v[248:249], v18 offset:0
    ds_read_b64_tr_b16 v[250:251], v18 offset:2048
    ds_read_b64_tr_b16 v[252:253], v19 offset:0
    ds_read_b64_tr_b16 v[254:255], v19 offset:2048
    ds_read_b64_tr_b16 a[0:1], v16 offset:4096
    ds_read_b64_tr_b16 a[2:3], v16 offset:6144
    ds_read_b64_tr_b16 a[4:5], v17 offset:4096
    ds_read_b64_tr_b16 a[6:7], v17 offset:6144
    ds_read_b64_tr_b16 a[8:9], v18 offset:4096
    ds_read_b64_tr_b16 a[10:11], v18 offset:6144
    ds_read_b64_tr_b16 a[12:13], v19 offset:4096
    ds_read_b64_tr_b16 a[14:15], v19 offset:6144
    v_add_u32 v16, 20480, v16
    v_add_u32 v17, 20480, v17
    v_add_u32 v18, 20480, v18
    v_add_u32 v19, 20480, v19
    s_waitcnt lgkmcnt(0)
    s_waitcnt vmcnt(12)
    s_barrier
    ds_read_b64_tr_b16 a[16:17], v16 offset:0
    ds_read_b64_tr_b16 a[18:19], v16 offset:2048
    ds_read_b64_tr_b16 a[20:21], v17 offset:0
    ds_read_b64_tr_b16 a[22:23], v17 offset:2048
    ds_read_b64_tr_b16 a[24:25], v18 offset:0
    ds_read_b64_tr_b16 a[26:27], v18 offset:2048
    ds_read_b64_tr_b16 a[28:29], v19 offset:0
    ds_read_b64_tr_b16 a[30:31], v19 offset:2048
    ds_read_b64_tr_b16 a[32:33], v16 offset:4096
    ds_read_b64_tr_b16 a[34:35], v16 offset:6144
    ds_read_b64_tr_b16 a[36:37], v17 offset:4096
    ds_read_b64_tr_b16 a[38:39], v17 offset:6144
    ds_read_b64_tr_b16 a[40:41], v18 offset:4096
    ds_read_b64_tr_b16 a[42:43], v18 offset:6144
    ds_read_b64_tr_b16 a[44:45], v19 offset:4096
    ds_read_b64_tr_b16 a[46:47], v19 offset:6144
    v_add_u32 v16, 20480, v16
    v_add_u32 v17, 20480, v17
    v_add_u32 v18, 20480, v18
    v_add_u32 v19, 20480, v19
    s_waitcnt lgkmcnt(0)
    s_waitcnt vmcnt(8)
    s_barrier
    ds_read_b64_tr_b16 a[48:49], v16 offset:0
    ds_read_b64_tr_b16 a[50:51], v16 offset:2048
    ds_read_b64_tr_b16 a[52:53], v17 offset:0
    ds_read_b64_tr_b16 a[54:55], v17 offset:2048
    ds_read_b64_tr_b16 a[56:57], v18 offset:0
    ds_read_b64_tr_b16 a[58:59], v18 offset:2048
    ds_read_b64_tr_b16 a[60:61], v19 offset:0
    ds_read_b64_tr_b16 a[62:63], v19 offset:2048
    ds_read_b64_tr_b16 a[64:65], v16 offset:4096
    ds_read_b64_tr_b16 a[66:67], v16 offset:6144
    ds_read_b64_tr_b16 a[68:69], v17 offset:4096
    ds_read_b64_tr_b16 a[70:71], v17 offset:6144
    ds_read_b64_tr_b16 a[72:73], v18 offset:4096
    ds_read_b64_tr_b16 a[74:75], v18 offset:6144
    ds_read_b64_tr_b16 a[76:77], v19 offset:4096
    ds_read_b64_tr_b16 a[78:79], v19 offset:6144
    v_subrev_u32 v16, 143360, v16
    v_subrev_u32 v17, 143360, v17
    v_subrev_u32 v18, 143360, v18
    v_subrev_u32 v19, 143360, v19
    s_waitcnt lgkmcnt(0)
    s_waitcnt vmcnt(4)
    s_barrier
    ds_read_b64_tr_b16 a[80:81], v16 offset:0
    ds_read_b64_tr_b16 a[82:83], v16 offset:2048
    ds_read_b64_tr_b16 a[84:85], v17 offset:0
    ds_read_b64_tr_b16 a[86:87], v17 offset:2048
    ds_read_b64_tr_b16 a[88:89], v18 offset:0
    ds_read_b64_tr_b16 a[90:91], v18 offset:2048
    ds_read_b64_tr_b16 a[92:93], v19 offset:0
    ds_read_b64_tr_b16 a[94:95], v19 offset:2048
    ds_read_b64_tr_b16 a[96:97], v16 offset:4096
    ds_read_b64_tr_b16 a[98:99], v16 offset:6144
    ds_read_b64_tr_b16 a[100:101], v17 offset:4096
    ds_read_b64_tr_b16 a[102:103], v17 offset:6144
    ds_read_b64_tr_b16 a[104:105], v18 offset:4096
    ds_read_b64_tr_b16 a[106:107], v18 offset:6144
    ds_read_b64_tr_b16 a[108:109], v19 offset:4096
    ds_read_b64_tr_b16 a[110:111], v19 offset:6144
    v_add_u32 v16, 20480, v16
    v_add_u32 v17, 20480, v17
    v_add_u32 v18, 20480, v18
    v_add_u32 v19, 20480, v19
    s_waitcnt lgkmcnt(0)
    s_waitcnt vmcnt(0)
    s_barrier
    ds_read_b64_tr_b16 a[112:113], v16 offset:0
    ds_read_b64_tr_b16 a[114:115], v16 offset:2048
    ds_read_b64_tr_b16 a[116:117], v17 offset:0
    ds_read_b64_tr_b16 a[118:119], v17 offset:2048
    ds_read_b64_tr_b16 a[120:121], v18 offset:0
    ds_read_b64_tr_b16 a[122:123], v18 offset:2048
    ds_read_b64_tr_b16 a[124:125], v19 offset:0
    ds_read_b64_tr_b16 a[126:127], v19 offset:2048
    ds_read_b64_tr_b16 a[128:129], v16 offset:4096
    ds_read_b64_tr_b16 a[130:131], v16 offset:6144
    ds_read_b64_tr_b16 a[132:133], v17 offset:4096
    ds_read_b64_tr_b16 a[134:135], v17 offset:6144
    ds_read_b64_tr_b16 a[136:137], v18 offset:4096
    ds_read_b64_tr_b16 a[138:139], v18 offset:6144
    ds_read_b64_tr_b16 a[140:141], v19 offset:4096
    ds_read_b64_tr_b16 a[142:143], v19 offset:6144
    v_add_u32 v16, 20480, v16
    v_add_u32 v17, 20480, v17
    v_add_u32 v18, 20480, v18
    v_add_u32 v19, 20480, v19
    s_waitcnt lgkmcnt(0)
    s_barrier
    v_and_b32 v4, 15, v1
    v_lshrrev_b32 v5, 4, v1
    v_lshlrev_b32 v5, 4, v5
    v_lshl_add_u32 v4, v4, 6, v5
    s_lshr_b32 s31, s29, 1
    s_mul_i32 s31, s31, 55296
    s_and_b32 s32, s29, 1
    s_lshl_b32 s32, s32, 10
    s_add_u32 s31, s31, s32
    s_lshl_b32 s59, s53, 11
    s_add_u32 s59, s59, s31
    s_add_u32 s59, s59, 84934656
    s_mov_b32 s36, 0xbfb8aa3b
wk_up_loop:
    s_mul_i32 s55, s52, 40960
    s_add_u32 s55, s55, 64487424
    s_mul_i32 s33, s52, 110592
    s_add_u32 s33, s33, s59
    s_cmp_lg_u32 s29, 0
    s_cbranch_scc1 wk_up_dw
    s_lshl_b32 s39, s52, 7
    s_add_u32 s39, s39, 286720
    v_mov_b32 v2, 0
wk_up_sp:
    buffer_load_dword v3, v2, s[4:7], s39 offen sc1
    s_waitcnt vmcnt(0)
    v_readfirstlane_b32 s37, v3
    s_nop 0
    s_cmp_ge_u32 s37, 8
    s_cbranch_scc1 wk_up_dw
    s_sleep 6
    s_branch wk_up_sp
wk_up_dw:
    s_barrier
    s_mul_i32 s57, s29, 4096
    s_mov_b32 m0, s57
    s_add_u32 s57, s57, s55
    buffer_load_dwordx4 v8, s[4:7], s57 offen offset:0 sc1 lds
    buffer_load_dwordx4 v9, s[4:7], s57 offen offset:1024 sc1 lds
    buffer_load_dwordx4 v8, s[4:7], s57 offen offset:2048 sc1 lds
    buffer_load_dwordx4 v9, s[4:7], s57 offen offset:3072 sc1 lds
    s_mul_i32 s57, s29, 4096
    s_add_u32 s57, s57, 16384
    s_mov_b32 m0, s57
    s_add_u32 s57, s57, s55
    buffer_load_dwordx4 v8, s[4:7], s57 offen offset:0 sc1 lds
    buffer_load_dwordx4 v9, s[4:7], s57 offen offset:1024 sc1 lds
    buffer_load_dwordx4 v8, s[4:7], s57 offen offset:2048 sc1 lds
    buffer_load_dwordx4 v9, s[4:7], s57 offen offset:3072 sc1 lds
    s_mul_i32 s57, s29, 2048
    s_add_u32 s57, s57, 32768
    s_mov_b32 m0, s57
    s_add_u32 s57, s57, s55
    buffer_load_dwordx4 v8, s[4:7], s57 offen offset:0 sc1 lds
    buffer_load_dwordx4 v9, s[4:7], s57 offen offset:1024 sc1 lds
    s_waitcnt vmcnt(6)
    s_barrier
    ds_read_b128 v[40:43], v14 offset:0
    ds_read_b128 v[44:47], v15 offset:0
    ds_read_b128 v[48:51], v14 offset:4096
    ds_read_b128 v[52:55], v15 offset:4096
    ds_read_b128 v[56:59], v14 offset:8192
    ds_read_b128 v[60:63], v15 offset:8192
    ds_read_b128 v[64:67], v14 offset:12288
    ds_read_b128 v[68:71], v15 offset:12288
    s_waitcnt lgkmcnt(7)
    v_mfma_f32_16x16x32_bf16 v[24:27], v[80:83], v[40:43], 0
    v_mfma_f32_16x16x32_bf16 v[28:31], v[84:87], v[40:43], 0
    v_mfma_f32_16x16x32_bf16 v[32:35], v[88:91], v[40:43], 0
    v_mfma_f32_16x16x32_bf16 v[36:39], v[92:95], v[40:43], 0
    s_waitcnt lgkmcnt(6)
    v_mfma_f32_16x16x32_bf16 v[24:27], v[96:99], v[44:47], v[24:27]
    v_mfma_f32_16x16x32_bf16 v[28:31], v[100:103], v[44:47], v[28:31]
    v_mfma_f32_16x16x32_bf16 v[32:35], v[104:107], v[44:47], v[32:35]
    v_mfma_f32_16x16x32_bf16 v[36:39], v[108:111], v[44:47], v[36:39]
    s_waitcnt lgkmcnt(5)
    v_mfma_f32_16x16x32_bf16 v[24:27], v[112:115], v[48:51], v[24:27]
    v_mfma_f32_16x16x32_bf16 v[28:31], v[116:119], v[48:51], v[28:31]
    v_mfma_f32_16x16x32_bf16 v[32:35], v[120:123], v[48:51], v[32:35]
    v_mfma_f32_16x16x32_bf16 v[36:39], v[124:127], v[48:51], v[36:39]
    s_waitcnt lgkmcnt(4)
    v_mfma_f32_16x16x32_bf16 v[24:27], v[128:131], v[52:55], v[24:27]
    v_mfma_f32_16x16x32_bf16 v[28:31], v[132:135], v[52:55], v[28:31]
    v_mfma_f32_16x16x32_bf16 v[32:35], v[136:139], v[52:55], v[32:35]
    v_mfma_f32_16x16x32_bf16 v[36:39], v[140:143], v[52:55], v[36:39]
    s_waitcnt vmcnt(2)
    s_barrier
    ds_read_b128 v[40:43], v14 offset:16384
    ds_read_b128 v[44:47], v15 offset:16384
    ds_read_b128 v[48:51], v14 offset:20480
    ds_read_b128 v[52:55], v15 offset:20480
    s_waitcnt lgkmcnt(7)
    v_mfma_f32_16x16x32_bf16 v[24:27], v[144:147], v[56:59], v[24:27]
    v_mfma_f32_16x16x32_bf16 v[28:31], v[148:151], v[56:59], v[28:31]
    v_mfma_f32_16x16x32_bf16 v[32:35], v[152:155], v[56:59], v[32:35]
    v_mfma_f32_16x16x32_bf16 v[36:39], v[156:159], v[56:59], v[36:39]
    s_waitcnt lgkmcnt(6)
    v_mfma_f32_16x16x32_bf16 v[24:27], v[160:163], v[60:63], v[24:27]
    v_mfma_f32_16x16x32_bf16 v[28:31], v[164:167], v[60:63], v[28:31]
    v_mfma_f32_16x16x32_bf16 v[32:35], v[168:171], v[60:63], v[32:35]
    v_mfma_f32_16x16x32_bf16 v[36:39], v[172:175], v[60:63], v[36:39]
    s_waitcnt lgkmcnt(5)
    v_mfma_f32_16x16x32_bf16 v[24:27], v[176:179], v[64:67], v[24:27]
    v_mfma_f32_16x16x32_bf16 v[28:31], v[180:183], v[64:67], v[28:31]
    v_mfma_f32_16x16x32_bf16 v[32:35], v[184:187], v[64:67], v[32:35]
    v_mfma_f32_16x16x32_bf16 v[36:39], v[188:191], v[64:67], v[36:39]
    s_waitcnt lgkmcnt(4)
    v_mfma_f32_16x16x32_bf16 v[24:27], v[192:195], v[68:71], v[24:27]
    v_mfma_f32_16x16x32_bf16 v[28:31], v[196:199], v[68:71], v[28:31]
    v_mfma_f32_16x16x32_bf16 v[32:35], v[200:203], v[68:71], v[32:35]
    v_mfma_f32_16x16x32_bf16 v[36:39], v[204:207], v[68:71], v[36:39]
    ds_read_b128 v[56:59], v14 offset:24576
    ds_read_b128 v[60:63], v15 offset:24576
    ds_read_b128 v[64:67], v14 offset:28672
    ds_read_b128 v[68:71], v15 offset:28672
    s_waitcnt lgkmcnt(7)
    v_mfma_f32_16x16x32_bf16 v[24:27], v[208:211], v[40:43], v[24:27]
    v_mfma_f32_16x16x32_bf16 v[28:31], v[212:215], v[40:43], v[28:31]
    v_mfma_f32_16x16x32_bf16 v[32:35], v[216:219], v[40:43], v[32:35]
    v_mfma_f32_16x16x32_bf16 v[36:39], v[220:223], v[40:43], v[36:39]
    s_waitcnt lgkmcnt(6)
    v_mfma_f32_16x16x32_bf16 v[24:27], v[224:227], v[44:47], v[24:27]
    v_mfma_f32_16x16x32_bf16 v[28:31], v[228:231], v[44:47], v[28:31]
    v_mfma_f32_16x16x32_bf16 v[32:35], v[232:235], v[44:47], v[32:35]
    v_mfma_f32_16x16x32_bf16 v[36:39], v[236:239], v[44:47], v[36:39]
    s_waitcnt lgkmcnt(5)
    v_mfma_f32_16x16x32_bf16 v[24:27], v[240:243], v[48:51], v[24:27]
    v_mfma_f32_16x16x32_bf16 v[28:31], v[244:247], v[48:51], v[28:31]
    v_mfma_f32_16x16x32_bf16 v[32:35], v[248:251], v[48:51], v[32:35]
    v_mfma_f32_16x16x32_bf16 v[36:39], v[252:255], v[48:51], v[36:39]
    s_waitcnt lgkmcnt(4)
    v_mfma_f32_16x16x32_bf16 v[24:27], a[0:3], v[52:55], v[24:27]
    v_mfma_f32_16x16x32_bf16 v[28:31], a[4:7], v[52:55], v[28:31]
    v_mfma_f32_16x16x32_bf16 v[32:35], a[8:11], v[52:55], v[32:35]
    v_mfma_f32_16x16x32_bf16 v[36:39], a[12:15], v[52:55], v[36:39]
    s_waitcnt vmcnt(0)
    s_barrier
    ds_read_b128 v[40:43], v14 offset:32768
    ds_read_b128 v[44:47], v15 offset:32768
    ds_read_b128 v[48:51], v14 offset:36864
    ds_read_b128 v[52:55], v15 offset:36864
    s_waitcnt lgkmcnt(7)
    v_mfma_f32_16x16x32_bf16 v[24:27], a[16:19], v[56:59], v[24:27]
    v_mfma_f32_16x16x32_bf16 v[28:31], a[20:23], v[56:59], v[28:31]
    v_mfma_f32_16x16x32_bf16 v[32:35], a[24:27], v[56:59], v[32:35]
    v_mfma_f32_16x16x32_bf16 v[36:39], a[28:31], v[56:59], v[36:39]
    s_waitcnt lgkmcnt(6)
    v_mfma_f32_16x16x32_bf16 v[24:27], a[32:35], v[60:63], v[24:27]
    v_mfma_f32_16x16x32_bf16 v[28:31], a[36:39], v[60:63], v[28:31]
    v_mfma_f32_16x16x32_bf16 v[32:35], a[40:43], v[60:63], v[32:35]
    v_mfma_f32_16x16x32_bf16 v[36:39], a[44:47], v[60:63], v[36:39]
    s_waitcnt lgkmcnt(5)
    v_mfma_f32_16x16x32_bf16 v[24:27], a[48:51], v[64:67], v[24:27]
    v_mfma_f32_16x16x32_bf16 v[28:31], a[52:55], v[64:67], v[28:31]
    v_mfma_f32_16x16x32_bf16 v[32:35], a[56:59], v[64:67], v[32:35]
    v_mfma_f32_16x16x32_bf16 v[36:39], a[60:63], v[64:67], v[36:39]
    s_waitcnt lgkmcnt(4)
    v_mfma_f32_16x16x32_bf16 v[24:27], a[64:67], v[68:71], v[24:27]
    v_mfma_f32_16x16x32_bf16 v[28:31], a[68:71], v[68:71], v[28:31]
    v_mfma_f32_16x16x32_bf16 v[32:35], a[72:75], v[68:71], v[32:35]
    v_mfma_f32_16x16x32_bf16 v[36:39], a[76:79], v[68:71], v[36:39]
    s_waitcnt lgkmcnt(3)
    v_mfma_f32_16x16x32_bf16 v[24:27], a[80:83], v[40:43], v[24:27]
    v_mfma_f32_16x16x32_bf16 v[28:31], a[84:87], v[40:43], v[28:31]
    v_mfma_f32_16x16x32_bf16 v[32:35], a[88:91], v[40:43], v[32:35]
    v_mfma_f32_16x16x32_bf16 v[36:39], a[92:95], v[40:43], v[36:39]
    s_waitcnt lgkmcnt(2)
    v_mfma_f32_16x16x32_bf16 v[24:27], a[96:99], v[44:47], v[24:27]
    v_mfma_f32_16x16x32_bf16 v[28:31], a[100:103], v[44:47], v[28:31]
    v_mfma_f32_16x16x32_bf16 v[32:35], a[104:107], v[44:47], v[32:35]
    v_mfma_f32_16x16x32_bf16 v[36:39], a[108:111], v[44:47], v[36:39]
    s_waitcnt lgkmcnt(1)
    v_mfma_f32_16x16x32_bf16 v[24:27], a[112:115], v[48:51], v[24:27]
    v_mfma_f32_16x16x32_bf16 v[28:31], a[116:119], v[48:51], v[28:31]
    v_mfma_f32_16x16x32_bf16 v[32:35], a[120:123], v[48:51], v[32:35]
    v_mfma_f32_16x16x32_bf16 v[36:39], a[124:127], v[48:51], v[36:39]
    s_waitcnt lgkmcnt(0)
    v_mfma_f32_16x16x32_bf16 v[24:27], a[128:131], v[52:55], v[24:27]
    v_mfma_f32_16x16x32_bf16 v[28:31], a[132:135], v[52:55], v[28:31]
    v_mfma_f32_16x16x32_bf16 v[32:35], a[136:139], v[52:55], v[32:35]
    v_mfma_f32_16x16x32_bf16 v[36:39], a[140:143], v[52:55], v[36:39]
    s_nop 4
    v_cvt_pk_bf16_f32 v6, v24, v25
    v_lshlrev_b32 v24, 16, v6
    v_and_b32 v25, 0xffff0000, v6
    v_cvt_pk_bf16_f32 v6, v32, v33
    v_lshlrev_b32 v32, 16, v6
    v_and_b32 v33, 0xffff0000, v6
    v_mul_f32 v6, s36, v24
    v_exp_f32 v6, v6
    s_nop 0
    v_add_f32 v6, 1.0, v6
    v_rcp_f32 v6, v6
    s_nop 0
    v_mul_f32 v24, v24, v6
    v_mul_f32 v7, s36, v25
    v_exp_f32 v7, v7
    s_nop 0
    v_add_f32 v7, 1.0, v7
    v_rcp_f32 v7, v7
    s_nop 0
    v_mul_f32 v25, v25, v7
    v_cvt_pk_bf16_f32 v6, v24, v25
    v_lshlrev_b32 v24, 16, v6
    v_and_b32 v25, 0xffff0000, v6
    v_mul_f32 v24, v24, v32
    v_mul_f32 v25, v25, v33
    v_cvt_pk_bf16_f32 v72, v24, v25
    v_cvt_pk_bf16_f32 v6, v26, v27
    v_lshlrev_b32 v26, 16, v6
    v_and_b32 v27, 0xffff0000, v6
    v_cvt_pk_bf16_f32 v6, v34, v35
    v_lshlrev_b32 v34, 16, v6
    v_and_b32 v35, 0xffff0000, v6
    v_mul_f32 v6, s36, v26
    v_exp_f32 v6, v6
    s_nop 0
    v_add_f32 v6, 1.0, v6
    v_rcp_f32 v6, v6
    s_nop 0
    v_mul_f32 v26, v26, v6
    v_mul_f32 v7, s36, v27
    v_exp_f32 v7, v7
    s_nop 0
    v_add_f32 v7, 1.0, v7
    v_rcp_f32 v7, v7
    s_nop 0
    v_mul_f32 v27, v27, v7
    v_cvt_pk_bf16_f32 v6, v26, v27
    v_lshlrev_b32 v26, 16, v6
    v_and_b32 v27, 0xffff0000, v6
    v_mul_f32 v26, v26, v34
    v_mul_f32 v27, v27, v35
    v_cvt_pk_bf16_f32 v73, v26, v27
    v_cvt_pk_bf16_f32 v6, v28, v29
    v_lshlrev_b32 v28, 16, v6
    v_and_b32 v29, 0xffff0000, v6
    v_cvt_pk_bf16_f32 v6, v36, v37
    v_lshlrev_b32 v36, 16, v6
    v_and_b32 v37, 0xffff0000, v6
    v_mul_f32 v6, s36, v28
    v_exp_f32 v6, v6
    s_nop 0
    v_add_f32 v6, 1.0, v6
    v_rcp_f32 v6, v6
    s_nop 0
    v_mul_f32 v28, v28, v6
    v_mul_f32 v7, s36, v29
    v_exp_f32 v7, v7
    s_nop 0
    v_add_f32 v7, 1.0, v7
    v_rcp_f32 v7, v7
    s_nop 0
    v_mul_f32 v29, v29, v7
    v_cvt_pk_bf16_f32 v6, v28, v29
    v_lshlrev_b32 v28, 16, v6
    v_and_b32 v29, 0xffff0000, v6
    v_mul_f32 v28, v28, v36
    v_mul_f32 v29, v29, v37
    v_cvt_pk_bf16_f32 v74, v28, v29
    v_cvt_pk_bf16_f32 v6, v30, v31
    v_lshlrev_b32 v30, 16, v6
    v_and_b32 v31, 0xffff0000, v6
    v_cvt_pk_bf16_f32 v6, v38, v39
    v_lshlrev_b32 v38, 16, v6
    v_and_b32 v39, 0xffff0000, v6
    v_mul_f32 v6, s36, v30
    v_exp_f32 v6, v6
    s_nop 0
    v_add_f32 v6, 1.0, v6
    v_rcp_f32 v6, v6
    s_nop 0
    v_mul_f32 v30, v30, v6
    v_mul_f32 v7, s36, v31
    v_exp_f32 v7, v7
    s_nop 0
    v_add_f32 v7, 1.0, v7
    v_rcp_f32 v7, v7
    s_nop 0
    v_mul_f32 v31, v31, v7
    v_cvt_pk_bf16_f32 v6, v30, v31
    v_lshlrev_b32 v30, 16, v6
    v_and_b32 v31, 0xffff0000, v6
    v_mul_f32 v30, v30, v38
    v_mul_f32 v31, v31, v39
    v_cvt_pk_bf16_f32 v75, v30, v31
    buffer_store_dwordx4 v[72:75], v4, s[4:7], s33 offen sc1
    s_waitcnt vmcnt(0) lgkmcnt(0)
    s_barrier
    s_cmp_lg_u32 s29, 0
    s_cbranch_scc1 wk_up_sg
    s_lshl_b32 s38, s52, 7
    s_add_u32 s38, s38, 294912
    v_mov_b32 v2, 0
    v_mov_b32 v3, 1
    s_mov_b64 exec, 1
    buffer_atomic_add v3, v2, s[4:7], s38 offen
    s_mov_b64 exec, -1
wk_up_sg:
    s_cmp_lt_u32 s52, 16
    s_cselect_b32 s38, 1, 2
    s_add_u32 s52, s52, s38
    s_cmp_lt_u32 s52, 64
    s_cbranch_scc1 wk_up_loop
    s_endpgm
wk_dn:
    s_lshr_b32 s58, s53, 1
    s_lshl_b32 s58, s58, 8
    v_lshrrev_b32 v2, 3, v1
    s_mov_b32 s42, 128
    v_mul_lo_u32 v2, v2, s42
    v_and_b32 v3, 7, v1
    v_lshrrev_b32 v4, 4, v1
    v_xor_b32 v5, v3, v4
    v_lshl_add_u32 v8, v5, 4, v2
    v_xor_b32 v5, 4, v5
    v_lshl_add_u32 v9, v5, 4, v2
    s_mov_b32 s42, 1280
    v_and_b32 v6, 1, v1
    v_lshlrev_b32 v6, 4, v6
    v_mul_lo_u32 v2, v4, s42
    v_add_u32 v2, v2, v6
    v_bfe_u32 v5, v1, 1, 3
    v_xor_b32 v5, v5, v4
    v_lshl_add_u32 v10, v5, 5, v2
    v_xor_b32 v5, 4, v5
    v_lshl_add_u32 v11, v5, 5, v2
    v_and_b32 v2, 15, v1
    v_lshrrev_b32 v3, 1, v2
    v_xor_b32 v3, v3, v4
    v_lshlrev_b32 v3, 4, v3
    v_lshl_add_u32 v3, v2, 7, v3
    s_lshr_b32 s42, s29, 2
    s_mul_i32 s42, s42, 2048
    s_add_u32 s42, s42, 0
    v_add_u32 v12, s42, v3
    v_xor_b32 v13, 64, v12
    v_bfe_u32 v2, v1, 2, 2
    v_lshl_add_u32 v2, v4, 2, v2
    v_and_b32 v3, 3, v1
    v_lshlrev_b32 v3, 3, v3
    s_and_b32 s42, s29, 3
    s_mul_i32 s42, s42, 2
    s_add_u32 s42, s42, 0
    v_and_b32 v5, 7, v2
    v_xor_b32 v5, s42, v5
    v_lshl_add_u32 v5, v5, 5, v3
    v_lshl_add_u32 v5, v2, 8, v5
    v_add_u32 v14, 2048, v5
    s_and_b32 s42, s29, 3
    s_mul_i32 s42, s42, 2
    s_add_u32 s42, s42, 1
    v_and_b32 v5, 7, v2
    v_xor_b32 v5, s42, v5
    v_lshl_add_u32 v5, v5, 5, v3
    v_lshl_add_u32 v5, v2, 8, v5
    v_add_u32 v15, 2048, v5
    s_mov_b32 s57, 0
    s_mul_i32 s42, s29, 0
    s_add_u32 s40, s57, s42
    s_mul_i32 s44, s29, 0
    s_mul_i32 s42, s29, 20480
    s_add_u32 s41, s58, s42
    s_mul_i32 s45, s29, 4096
    v_bfe_u32 v2, v8, 6, 1
    v_lshrrev_b32 v3, 7, v8
    v_and_b32 v8, 48, v8
    v_lshl_add_u32 v8, v2, 10, v8
    v_lshl_add_u32 v8, v3, 6, v8
    v_add_u32 v8, 512, v8
    v_bfe_u32 v2, v9, 6, 1
    v_lshrrev_b32 v3, 7, v9
    v_and_b32 v9, 48, v9
    v_lshl_add_u32 v9, v2, 10, v9
    v_lshl_add_u32 v9, v3, 6, v9
    s_and_b32 s57, s29, 1
    s_cmp_eq_u32 s57, 1
    s_cselect_b64 vcc, -1, 0
    v_cndmask_b32 v20, v8, v9, vcc
    v_cndmask_b32 v21, v9, v8, vcc
    v_add_u32 v22, 0x10000, v12
    v_add_u32 v23, 0x10000, v13
    s_add_u32 m0, s45, 2048
    s_nop 0
    buffer_load_dwordx4 v10, s[72:75], s41 offen  lds
    s_add_u32 m0, s45, 3072
    s_add_u32 s42, s41, 5120
    buffer_load_dwordx4 v11, s[72:75], s42 offen  lds
    s_add_u32 m0, s45, 4096
    s_add_u32 s42, s41, 10240
    buffer_load_dwordx4 v10, s[72:75], s42 offen  lds
    s_add_u32 m0, s45, 5120
    s_add_u32 s42, s41, 15360
    buffer_load_dwordx4 v11, s[72:75], s42 offen  lds
    s_add_u32 s41, s41, 81920
    s_add_u32 m0, s45, 20480
    s_nop 0
    buffer_load_dwordx4 v10, s[72:75], s41 offen  lds
    s_add_u32 m0, s45, 21504
    s_add_u32 s42, s41, 5120
    buffer_load_dwordx4 v11, s[72:75], s42 offen  lds
    s_add_u32 m0, s45, 22528
    s_add_u32 s42, s41, 10240
    buffer_load_dwordx4 v10, s[72:75], s42 offen  lds
    s_add_u32 m0, s45, 23552
    s_add_u32 s42, s41, 15360
    buffer_load_dwordx4 v11, s[72:75], s42 offen  lds
    s_add_u32 s41, s41, 81920
    s_add_u32 m0, s45, 38912
    s_nop 0
    buffer_load_dwordx4 v10, s[72:75], s41 offen  lds
    s_add_u32 m0, s45, 39936
    s_add_u32 s42, s41, 5120
    buffer_load_dwordx4 v11, s[72:75], s42 offen  lds
    s_add_u32 m0, s45, 40960
    s_add_u32 s42, s41, 10240
    buffer_load_dwordx4 v10, s[72:75], s42 offen  lds
    s_add_u32 m0, s45, 41984
    s_add_u32 s42, s41, 15360
    buffer_load_dwordx4 v11, s[72:75], s42 offen  lds
    s_add_u32 s41, s41, 81920
    s_add_u32 m0, s45, 57344
    s_nop 0
    buffer_load_dwordx4 v10, s[72:75], s41 offen  lds
    s_add_u32 m0, s45, 58368
    s_add_u32 s42, s41, 5120
    buffer_load_dwordx4 v11, s[72:75], s42 offen  lds
    s_add_u32 m0, s45, 59392
    s_add_u32 s42, s41, 10240
    buffer_load_dwordx4 v10, s[72:75], s42 offen  lds
    s_add_u32 m0, s45, 60416
    s_add_u32 s42, s41, 15360
    buffer_load_dwordx4 v11, s[72:75], s42 offen  lds
    s_add_u32 s41, s41, 81920
    s_add_u32 m0, s45, 75776
    s_nop 0
    buffer_load_dwordx4 v10, s[72:75], s41 offen  lds
    s_add_u32 m0, s45, 76800
    s_add_u32 s42, s41, 5120
    buffer_load_dwordx4 v11, s[72:75], s42 offen  lds
    s_add_u32 m0, s45, 77824
    s_add_u32 s42, s41, 10240
    buffer_load_dwordx4 v10, s[72:75], s42 offen  lds
    s_add_u32 m0, s45, 78848
    s_add_u32 s42, s41, 15360
    buffer_load_dwordx4 v11, s[72:75], s42 offen  lds
    s_add_u32 s41, s41, 81920
    s_add_u32 m0, s45, 94208
    s_nop 0
    buffer_load_dwordx4 v10, s[72:75], s41 offen  lds
    s_add_u32 m0, s45, 95232
    s_add_u32 s42, s41, 5120
    buffer_load_dwordx4 v11, s[72:75], s42 offen  lds
    s_add_u32 m0, s45, 96256
    s_add_u32 s42, s41, 10240
    buffer_load_dwordx4 v10, s[72:75], s42 offen  lds
    s_add_u32 m0, s45, 97280
    s_add_u32 s42, s41, 15360
    buffer_load_dwordx4 v11, s[72:75], s42 offen  lds
    s_add_u32 s41, s41, 81920
    s_add_u32 m0, s45, 112640
    s_nop 0
    buffer_load_dwordx4 v10, s[72:75], s41 offen  lds
    s_add_u32 m0, s45, 113664
    s_add_u32 s42, s41, 5120
    buffer_load_dwordx4 v11, s[72:75], s42 offen  lds
    s_add_u32 m0, s45, 114688
    s_add_u32 s42, s41, 10240
    buffer_load_dwordx4 v10, s[72:75], s42 offen  lds
    s_add_u32 m0, s45, 115712
    s_add_u32 s42, s41, 15360
    buffer_load_dwordx4 v11, s[72:75], s42 offen  lds
    s_add_u32 s41, s41, 81920
    s_add_u32 m0, s45, 131072
    s_nop 0
    buffer_load_dwordx4 v10, s[72:75], s41 offen  lds
    s_add_u32 m0, s45, 132096
    s_add_u32 s42, s41, 5120
    buffer_load_dwordx4 v11, s[72:75], s42 offen  lds
    s_add_u32 m0, s45, 133120
    s_add_u32 s42, s41, 10240
    buffer_load_dwordx4 v10, s[72:75], s42 offen  lds
    s_add_u32 m0, s45, 134144
    s_add_u32 s42, s41, 15360
    buffer_load_dwordx4 v11, s[72:75], s42 offen  lds
    s_add_u32 s41, s41, 81920
    s_waitcnt vmcnt(28)
    s_barrier
    ds_read_b64_tr_b16 v[80:81], v14 offset:0
    ds_read_b64_tr_b16 v[82:83], v14 offset:4096
    ds_read_b64_tr_b16 v[84:85], v15 offset:0
    ds_read_b64_tr_b16 v[86:87], v15 offset:4096
    ds_read_b64_tr_b16 v[88:89], v14 offset:8192
    ds_read_b64_tr_b16 v[90:91], v14 offset:12288
    ds_read_b64_tr_b16 v[92:93], v15 offset:8192
    ds_read_b64_tr_b16 v[94:95], v15 offset:12288
    v_add_u32 v14, 18432, v14
    v_add_u32 v15, 18432, v15
    s_waitcnt lgkmcnt(0)
    s_waitcnt vmcnt(24)
    s_barrier
    s_add_u32 m0, s45, 2048
    s_nop 0
    buffer_load_dwordx4 v10, s[72:75], s41 offen  lds
    s_add_u32 m0, s45, 3072
    s_add_u32 s42, s41, 5120
    buffer_load_dwordx4 v11, s[72:75], s42 offen  lds
    s_add_u32 m0, s45, 4096
    s_add_u32 s42, s41, 10240
    buffer_load_dwordx4 v10, s[72:75], s42 offen  lds
    s_add_u32 m0, s45, 5120
    s_add_u32 s42, s41, 15360
    buffer_load_dwordx4 v11, s[72:75], s42 offen  lds
    s_add_u32 s41, s41, 81920
    ds_read_b64_tr_b16 v[96:97], v14 offset:0
    ds_read_b64_tr_b16 v[98:99], v14 offset:4096
    ds_read_b64_tr_b16 v[100:101], v15 offset:0
    ds_read_b64_tr_b16 v[102:103], v15 offset:4096
    ds_read_b64_tr_b16 v[104:105], v14 offset:8192
    ds_read_b64_tr_b16 v[106:107], v14 offset:12288
    ds_read_b64_tr_b16 v[108:109], v15 offset:8192
    ds_read_b64_tr_b16 v[110:111], v15 offset:12288
    v_add_u32 v14, 18432, v14
    v_add_u32 v15, 18432, v15
    s_waitcnt lgkmcnt(0)
    s_waitcnt vmcnt(24)
    s_barrier
    s_add_u32 m0, s45, 20480
    s_nop 0
    buffer_load_dwordx4 v10, s[72:75], s41 offen  lds
    s_add_u32 m0, s45, 21504
    s_add_u32 s42, s41, 5120
    buffer_load_dwordx4 v11, s[72:75], s42 offen  lds
    s_add_u32 m0, s45, 22528
    s_add_u32 s42, s41, 10240
    buffer_load_dwordx4 v10, s[72:75], s42 offen  lds
    s_add_u32 m0, s45, 23552
    s_add_u32 s42, s41, 15360
    buffer_load_dwordx4 v11, s[72:75], s42 offen  lds
    s_add_u32 s41, s41, 81920
    ds_read_b64_tr_b16 v[112:113], v14 offset:0
    ds_read_b64_tr_b16 v[114:115], v14 offset:4096
    ds_read_b64_tr_b16 v[116:117], v15 offset:0
    ds_read_b64_tr_b16 v[118:119], v15 offset:4096
    ds_read_b64_tr_b16 v[120:121], v14 offset:8192
    ds_read_b64_tr_b16 v[122:123], v14 offset:12288
    ds_read_b64_tr_b16 v[124:125], v15 offset:8192
    ds_read_b64_tr_b16 v[126:127], v15 offset:12288
    v_add_u32 v14, 18432, v14
    v_add_u32 v15, 18432, v15
    s_waitcnt lgkmcnt(0)
    s_waitcnt vmcnt(24)
    s_barrier
    s_add_u32 m0, s45, 38912
    s_nop 0
    buffer_load_dwordx4 v10, s[72:75], s41 offen  lds
    s_add_u32 m0, s45, 39936
    s_add_u32 s42, s41, 5120
    buffer_load_dwordx4 v11, s[72:75], s42 offen  lds
    s_add_u32 m0, s45, 40960
    s_add_u32 s42, s41, 10240
    buffer_load_dwordx4 v10, s[72:75], s42 offen  lds
    s_add_u32 m0, s45, 41984
    s_add_u32 s42, s41, 15360
    buffer_load_dwordx4 v11, s[72:75], s42 offen  lds
    s_add_u32 s41, s41, 81920
    ds_read_b64_tr_b16 v[128:129], v14 offset:0
    ds_read_b64_tr_b16 v[130:131], v14 offset:4096
    ds_read_b64_tr_b16 v[132:133], v15 offset:0
    ds_read_b64_tr_b16 v[134:135], v15 offset:4096
    ds_read_b64_tr_b16 v[136:137], v14 offset:8192
    ds_read_b64_tr_b16 v[138:139], v14 offset:12288
    ds_read_b64_tr_b16 v[140:141], v15 offset:8192
    ds_read_b64_tr_b16 v[142:143], v15 offset:12288
    v_add_u32 v14, 18432, v14
    v_add_u32 v15, 18432, v15
    s_waitcnt lgkmcnt(0)
    s_waitcnt vmcnt(24)
    s_barrier
    s_add_u32 m0, s45, 57344
    s_nop 0
    buffer_load_dwordx4 v10, s[72:75], s41 offen  lds
    s_add_u32 m0, s45, 58368
    s_add_u32 s42, s41, 5120
    buffer_load_dwordx4 v11, s[72:75], s42 offen  lds
    s_add_u32 m0, s45, 59392
    s_add_u32 s42, s41, 10240
    buffer_load_dwordx4 v10, s[72:75], s42 offen  lds
    s_add_u32 m0, s45, 60416
    s_add_u32 s42, s41, 15360
    buffer_load_dwordx4 v11, s[72:75], s42 offen  lds
    s_add_u32 s41, s41, 81920
    ds_read_b64_tr_b16 v[144:145], v14 offset:0
    ds_read_b64_tr_b16 v[146:147], v14 offset:4096
    ds_read_b64_tr_b16 v[148:149], v15 offset:0
    ds_read_b64_tr_b16 v[150:151], v15 offset:4096
    ds_read_b64_tr_b16 v[152:153], v14 offset:8192
    ds_read_b64_tr_b16 v[154:155], v14 offset:12288
    ds_read_b64_tr_b16 v[156:157], v15 offset:8192
    ds_read_b64_tr_b16 v[158:159], v15 offset:12288
    v_add_u32 v14, 18432, v14
    v_add_u32 v15, 18432, v15
    s_waitcnt lgkmcnt(0)
    s_waitcnt vmcnt(24)
    s_barrier
    s_add_u32 m0, s45, 75776
    s_nop 0
    buffer_load_dwordx4 v10, s[72:75], s41 offen  lds
    s_add_u32 m0, s45, 76800
    s_add_u32 s42, s41, 5120
    buffer_load_dwordx4 v11, s[72:75], s42 offen  lds
    s_add_u32 m0, s45, 77824
    s_add_u32 s42, s41, 10240
    buffer_load_dwordx4 v10, s[72:75], s42 offen  lds
    s_add_u32 m0, s45, 78848
    s_add_u32 s42, s41, 15360
    buffer_load_dwordx4 v11, s[72:75], s42 offen  lds
    s_add_u32 s41, s41, 81920
    ds_read_b64_tr_b16 v[160:161], v14 offset:0
    ds_read_b64_tr_b16 v[162:163], v14 offset:4096
    ds_read_b64_tr_b16 v[164:165], v15 offset:0
    ds_read_b64_tr_b16 v[166:167], v15 offset:4096
    ds_read_b64_tr_b16 v[168:169], v14 offset:8192
    ds_read_b64_tr_b16 v[170:171], v14 offset:12288
    ds_read_b64_tr_b16 v[172:173], v15 offset:8192
    ds_read_b64_tr_b16 v[174:175], v15 offset:12288
    v_add_u32 v14, 18432, v14
    v_add_u32 v15, 18432, v15
    s_waitcnt lgkmcnt(0)
    s_waitcnt vmcnt(24)
    s_barrier
    s_add_u32 m0, s45, 94208
    s_nop 0
    buffer_load_dwordx4 v10, s[72:75], s41 offen  lds
    s_add_u32 m0, s45, 95232
    s_add_u32 s42, s41, 5120
    buffer_load_dwordx4 v11, s[72:75], s42 offen  lds
    s_add_u32 m0, s45, 96256
    s_add_u32 s42, s41, 10240
    buffer_load_dwordx4 v10, s[72:75], s42 offen  lds
    s_add_u32 m0, s45, 97280
    s_add_u32 s42, s41, 15360
    buffer_load_dwordx4 v11, s[72:75], s42 offen  lds
    s_add_u32 s41, s41, 81920
    ds_read_b64_tr_b16 v[176:177], v14 offset:0
    ds_read_b64_tr_b16 v[178:179], v14 offset:4096
    ds_read_b64_tr_b16 v[180:181], v15 offset:0
    ds_read_b64_tr_b16 v[182:183], v15 offset:4096
    ds_read_b64_tr_b16 v[184:185], v14 offset:8192
    ds_read_b64_tr_b16 v[186:187], v14 offset:12288
    ds_read_b64_tr_b16 v[188:189], v15 offset:8192
    ds_read_b64_tr_b16 v[190:191], v15 offset:12288
    v_add_u32 v14, 18432, v14
    v_add_u32 v15, 18432, v15
    s_waitcnt lgkmcnt(0)
    s_waitcnt vmcnt(24)
    s_barrier
    s_add_u32 m0, s45, 112640
    s_nop 0
    buffer_load_dwordx4 v10, s[72:75], s41 offen  lds
    s_add_u32 m0, s45, 113664
    s_add_u32 s42, s41, 5120
    buffer_load_dwordx4 v11, s[72:75], s42 offen  lds
    s_add_u32 m0, s45, 114688
    s_add_u32 s42, s41, 10240
    buffer_load_dwordx4 v10, s[72:75], s42 offen  lds
    s_add_u32 m0, s45, 115712
    s_add_u32 s42, s41, 15360
    buffer_load_dwordx4 v11, s[72:75], s42 offen  lds
    s_add_u32 s41, s41, 81920
    ds_read_b64_tr_b16 v[192:193], v14 offset:0
    ds_read_b64_tr_b16 v[194:195], v14 offset:4096
    ds_read_b64_tr_b16 v[196:197], v15 offset:0
    ds_read_b64_tr_b16 v[198:199], v15 offset:4096
    ds_read_b64_tr_b16 v[200:201], v14 offset:8192
    ds_read_b64_tr_b16 v[202:203], v14 offset:12288
    ds_read_b64_tr_b16 v[204:205], v15 offset:8192
    ds_read_b64_tr_b16 v[206:207], v15 offset:12288
    v_subrev_u32 v14, 129024, v14
    v_subrev_u32 v15, 129024, v15
    s_waitcnt lgkmcnt(0)
    s_waitcnt vmcnt(24)
    s_barrier
    s_add_u32 m0, s45, 131072
    s_nop 0
    buffer_load_dwordx4 v10, s[72:75], s41 offen  lds
    s_add_u32 m0, s45, 132096
    s_add_u32 s42, s41, 5120
    buffer_load_dwordx4 v11, s[72:75], s42 offen  lds
    s_add_u32 m0, s45, 133120
    s_add_u32 s42, s41, 10240
    buffer_load_dwordx4 v10, s[72:75], s42 offen  lds
    s_add_u32 m0, s45, 134144
    s_add_u32 s42, s41, 15360
    buffer_load_dwordx4 v11, s[72:75], s42 offen  lds
    s_add_u32 s41, s41, 81920
    ds_read_b64_tr_b16 v[208:209], v14 offset:0
    ds_read_b64_tr_b16 v[210:211], v14 offset:4096
    ds_read_b64_tr_b16 v[212:213], v15 offset:0
    ds_read_b64_tr_b16 v[214:215], v15 offset:4096
    ds_read_b64_tr_b16 v[216:217], v14 offset:8192
    ds_read_b64_tr_b16 v[218:219], v14 offset:12288
    ds_read_b64_tr_b16 v[220:221], v15 offset:8192
    ds_read_b64_tr_b16 v[222:223], v15 offset:12288
    v_add_u32 v14, 18432, v14
    v_add_u32 v15, 18432, v15
    s_waitcnt lgkmcnt(0)
    s_waitcnt vmcnt(24)
    s_barrier
    s_add_u32 m0, s45, 2048
    s_nop 0
    buffer_load_dwordx4 v10, s[72:75], s41 offen  lds
    s_add_u32 m0, s45, 3072
    s_add_u32 s42, s41, 5120
    buffer_load_dwordx4 v11, s[72:75], s42 offen  lds
    s_add_u32 m0, s45, 4096
    s_add_u32 s42, s41, 10240
    buffer_load_dwordx4 v10, s[72:75], s42 offen  lds
    s_add_u32 m0, s45, 5120
    s_add_u32 s42, s41, 15360
    buffer_load_dwordx4 v11, s[72:75], s42 offen  lds
    s_add_u32 s41, s41, 81920
    ds_read_b64_tr_b16 v[224:225], v14 offset:0
    ds_read_b64_tr_b16 v[226:227], v14 offset:4096
    ds_read_b64_tr_b16 v[228:229], v15 offset:0
    ds_read_b64_tr_b16 v[230:231], v15 offset:4096
    ds_read_b64_tr_b16 v[232:233], v14 offset:8192
    ds_read_b64_tr_b16 v[234:235], v14 offset:12288
    ds_read_b64_tr_b16 v[236:237], v15 offset:8192
    ds_read_b64_tr_b16 v[238:239], v15 offset:12288
    v_add_u32 v14, 18432, v14
    v_add_u32 v15, 18432, v15
    s_waitcnt lgkmcnt(0)
    s_waitcnt vmcnt(24)
    s_barrier
    s_add_u32 m0, s45, 20480
    s_nop 0
    buffer_load_dwordx4 v10, s[72:75], s41 offen  lds
    s_add_u32 m0, s45, 21504
    s_add_u32 s42, s41, 5120
    buffer_load_dwordx4 v11, s[72:75], s42 offen  lds
    s_add_u32 m0, s45, 22528
    s_add_u32 s42, s41, 10240
    buffer_load_dwordx4 v10, s[72:75], s42 offen  lds
    s_add_u32 m0, s45, 23552
    s_add_u32 s42, s41, 15360
    buffer_load_dwordx4 v11, s[72:75], s42 offen  lds
    s_add_u32 s41, s41, 81920
    ds_read_b64_tr_b16 v[240:241], v14 offset:0
    ds_read_b64_tr_b16 v[242:243], v14 offset:4096
    ds_read_b64_tr_b16 v[244:245], v15 offset:0
    ds_read_b64_tr_b16 v[246:247], v15 offset:4096
    ds_read_b64_tr_b16 v[248:249], v14 offset:8192
    ds_read_b64_tr_b16 v[250:251], v14 offset:12288
    ds_read_b64_tr_b16 v[252:253], v15 offset:8192
    ds_read_b64_tr_b16 v[254:255], v15 offset:12288
    v_add_u32 v14, 18432, v14
    v_add_u32 v15, 18432, v15
    s_waitcnt lgkmcnt(0)
    s_waitcnt vmcnt(24)
    s_barrier
    s_add_u32 m0, s45, 38912
    s_nop 0
    buffer_load_dwordx4 v10, s[72:75], s41 offen  lds
    s_add_u32 m0, s45, 39936
    s_add_u32 s42, s41, 5120
    buffer_load_dwordx4 v11, s[72:75], s42 offen  lds
    s_add_u32 m0, s45, 40960
    s_add_u32 s42, s41, 10240
    buffer_load_dwordx4 v10, s[72:75], s42 offen  lds
    s_add_u32 m0, s45, 41984
    s_add_u32 s42, s41, 15360
    buffer_load_dwordx4 v11, s[72:75], s42 offen  lds
    s_add_u32 s41, s41, 81920
    ds_read_b64_tr_b16 a[0:1], v14 offset:0
    ds_read_b64_tr_b16 a[2:3], v14 offset:4096
    ds_read_b64_tr_b16 a[4:5], v15 offset:0
    ds_read_b64_tr_b16 a[6:7], v15 offset:4096
    ds_read_b64_tr_b16 a[8:9], v14 offset:8192
    ds_read_b64_tr_b16 a[10:11], v14 offset:12288
    ds_read_b64_tr_b16 a[12:13], v15 offset:8192
    ds_read_b64_tr_b16 a[14:15], v15 offset:12288
    v_add_u32 v14, 18432, v14
    v_add_u32 v15, 18432, v15
    s_waitcnt lgkmcnt(0)
    s_waitcnt vmcnt(24)
    s_barrier
    s_add_u32 m0, s45, 57344
    s_nop 0
    buffer_load_dwordx4 v10, s[72:75], s41 offen  lds
    s_add_u32 m0, s45, 58368
    s_add_u32 s42, s41, 5120
    buffer_load_dwordx4 v11, s[72:75], s42 offen  lds
    s_add_u32 m0, s45, 59392
    s_add_u32 s42, s41, 10240
    buffer_load_dwordx4 v10, s[72:75], s42 offen  lds
    s_add_u32 m0, s45, 60416
    s_add_u32 s42, s41, 15360
    buffer_load_dwordx4 v11, s[72:75], s42 offen  lds
    s_add_u32 s41, s41, 81920
    ds_read_b64_tr_b16 a[16:17], v14 offset:0
    ds_read_b64_tr_b16 a[18:19], v14 offset:4096
    ds_read_b64_tr_b16 a[20:21], v15 offset:0
    ds_read_b64_tr_b16 a[22:23], v15 offset:4096
    ds_read_b64_tr_b16 a[24:25], v14 offset:8192
    ds_read_b64_tr_b16 a[26:27], v14 offset:12288
    ds_read_b64_tr_b16 a[28:29], v15 offset:8192
    ds_read_b64_tr_b16 a[30:31], v15 offset:12288
    v_add_u32 v14, 18432, v14
    v_add_u32 v15, 18432, v15
    s_waitcnt lgkmcnt(0)
    s_waitcnt vmcnt(24)
    s_barrier
    s_add_u32 m0, s45, 75776
    s_nop 0
    buffer_load_dwordx4 v10, s[72:75], s41 offen  lds
    s_add_u32 m0, s45, 76800
    s_add_u32 s42, s41, 5120
    buffer_load_dwordx4 v11, s[72:75], s42 offen  lds
    s_add_u32 m0, s45, 77824
    s_add_u32 s42, s41, 10240
    buffer_load_dwordx4 v10, s[72:75], s42 offen  lds
    s_add_u32 m0, s45, 78848
    s_add_u32 s42, s41, 15360
    buffer_load_dwordx4 v11, s[72:75], s42 offen  lds
    s_add_u32 s41, s41, 81920
    ds_read_b64_tr_b16 a[32:33], v14 offset:0
    ds_read_b64_tr_b16 a[34:35], v14 offset:4096
    ds_read_b64_tr_b16 a[36:37], v15 offset:0
    ds_read_b64_tr_b16 a[38:39], v15 offset:4096
    ds_read_b64_tr_b16 a[40:41], v14 offset:8192
    ds_read_b64_tr_b16 a[42:43], v14 offset:12288
    ds_read_b64_tr_b16 a[44:45], v15 offset:8192
    ds_read_b64_tr_b16 a[46:47], v15 offset:12288
    v_add_u32 v14, 18432, v14
    v_add_u32 v15, 18432, v15
    s_waitcnt lgkmcnt(0)
    s_waitcnt vmcnt(24)
    s_barrier
    s_add_u32 m0, s45, 94208
    s_nop 0
    buffer_load_dwordx4 v10, s[72:75], s41 offen  lds
    s_add_u32 m0, s45, 95232
    s_add_u32 s42, s41, 5120
    buffer_load_dwordx4 v11, s[72:75], s42 offen  lds
    s_add_u32 m0, s45, 96256
    s_add_u32 s42, s41, 10240
    buffer_load_dwordx4 v10, s[72:75], s42 offen  lds
    s_add_u32 m0, s45, 97280
    s_add_u32 s42, s41, 15360
    buffer_load_dwordx4 v11, s[72:75], s42 offen  lds
    s_add_u32 s41, s41, 81920
    ds_read_b64_tr_b16 a[48:49], v14 offset:0
    ds_read_b64_tr_b16 a[50:51], v14 offset:4096
    ds_read_b64_tr_b16 a[52:53], v15 offset:0
    ds_read_b64_tr_b16 a[54:55], v15 offset:4096
    ds_read_b64_tr_b16 a[56:57], v14 offset:8192
    ds_read_b64_tr_b16 a[58:59], v14 offset:12288
    ds_read_b64_tr_b16 a[60:61], v15 offset:8192
    ds_read_b64_tr_b16 a[62:63], v15 offset:12288
    v_add_u32 v14, 18432, v14
    v_add_u32 v15, 18432, v15
    s_waitcnt lgkmcnt(0)
    s_waitcnt vmcnt(24)
    s_barrier
    s_add_u32 m0, s45, 112640
    s_nop 0
    buffer_load_dwordx4 v10, s[72:75], s41 offen  lds
    s_add_u32 m0, s45, 113664
    s_add_u32 s42, s41, 5120
    buffer_load_dwordx4 v11, s[72:75], s42 offen  lds
    s_add_u32 m0, s45, 114688
    s_add_u32 s42, s41, 10240
    buffer_load_dwordx4 v10, s[72:75], s42 offen  lds
    s_add_u32 m0, s45, 115712
    s_add_u32 s42, s41, 15360
    buffer_load_dwordx4 v11, s[72:75], s42 offen  lds
    s_add_u32 s41, s41, 81920
    ds_read_b64_tr_b16 a[64:65], v14 offset:0
    ds_read_b64_tr_b16 a[66:67], v14 offset:4096
    ds_read_b64_tr_b16 a[68:69], v15 offset:0
    ds_read_b64_tr_b16 a[70:71], v15 offset:4096
    ds_read_b64_tr_b16 a[72:73], v14 offset:8192
    ds_read_b64_tr_b16 a[74:75], v14 offset:12288
    ds_read_b64_tr_b16 a[76:77], v15 offset:8192
    ds_read_b64_tr_b16 a[78:79], v15 offset:12288
    v_subrev_u32 v14, 129024, v14
    v_subrev_u32 v15, 129024, v15
    s_waitcnt lgkmcnt(0)
    s_waitcnt vmcnt(24)
    s_barrier
    s_add_u32 m0, s45, 131072
    s_nop 0
    buffer_load_dwordx4 v10, s[72:75], s41 offen  lds
    s_add_u32 m0, s45, 132096
    s_add_u32 s42, s41, 5120
    buffer_load_dwordx4 v11, s[72:75], s42 offen  lds
    s_add_u32 m0, s45, 133120
    s_add_u32 s42, s41, 10240
    buffer_load_dwordx4 v10, s[72:75], s42 offen  lds
    s_add_u32 m0, s45, 134144
    s_add_u32 s42, s41, 15360
    buffer_load_dwordx4 v11, s[72:75], s42 offen  lds
    s_add_u32 s41, s41, 81920
    ds_read_b64_tr_b16 a[80:81], v14 offset:0
    ds_read_b64_tr_b16 a[82:83], v14 offset:4096
    ds_read_b64_tr_b16 a[84:85], v15 offset:0
    ds_read_b64_tr_b16 a[86:87], v15 offset:4096
    ds_read_b64_tr_b16 a[88:89], v14 offset:8192
    ds_read_b64_tr_b16 a[90:91], v14 offset:12288
    ds_read_b64_tr_b16 a[92:93], v15 offset:8192
    ds_read_b64_tr_b16 a[94:95], v15 offset:12288
    v_add_u32 v14, 18432, v14
    v_add_u32 v15, 18432, v15
    s_waitcnt lgkmcnt(0)
    s_waitcnt vmcnt(24)
    s_barrier
    s_add_u32 m0, s45, 2048
    s_nop 0
    buffer_load_dwordx4 v10, s[72:75], s41 offen  lds
    s_add_u32 m0, s45, 3072
    s_add_u32 s42, s41, 5120
    buffer_load_dwordx4 v11, s[72:75], s42 offen  lds
    s_add_u32 m0, s45, 4096
    s_add_u32 s42, s41, 10240
    buffer_load_dwordx4 v10, s[72:75], s42 offen  lds
    s_add_u32 m0, s45, 5120
    s_add_u32 s42, s41, 15360
    buffer_load_dwordx4 v11, s[72:75], s42 offen  lds
    s_add_u32 s41, s41, 81920
    ds_read_b64_tr_b16 a[96:97], v14 offset:0
    ds_read_b64_tr_b16 a[98:99], v14 offset:4096
    ds_read_b64_tr_b16 a[100:101], v15 offset:0
    ds_read_b64_tr_b16 a[102:103], v15 offset:4096
    ds_read_b64_tr_b16 a[104:105], v14 offset:8192
    ds_read_b64_tr_b16 a[106:107], v14 offset:12288
    ds_read_b64_tr_b16 a[108:109], v15 offset:8192
    ds_read_b64_tr_b16 a[110:111], v15 offset:12288
    v_add_u32 v14, 18432, v14
    v_add_u32 v15, 18432, v15
    s_waitcnt lgkmcnt(0)
    s_waitcnt vmcnt(24)
    s_barrier
    s_add_u32 m0, s45, 20480
    s_nop 0
    buffer_load_dwordx4 v10, s[72:75], s41 offen  lds
    s_add_u32 m0, s45, 21504
    s_add_u32 s42, s41, 5120
    buffer_load_dwordx4 v11, s[72:75], s42 offen  lds
    s_add_u32 m0, s45, 22528
    s_add_u32 s42, s41, 10240
    buffer_load_dwordx4 v10, s[72:75], s42 offen  lds
    s_add_u32 m0, s45, 23552
    s_add_u32 s42, s41, 15360
    buffer_load_dwordx4 v11, s[72:75], s42 offen  lds
    s_add_u32 s41, s41, 81920
    ds_read_b64_tr_b16 a[112:113], v14 offset:0
    ds_read_b64_tr_b16 a[114:115], v14 offset:4096
    ds_read_b64_tr_b16 a[116:117], v15 offset:0
    ds_read_b64_tr_b16 a[118:119], v15 offset:4096
    ds_read_b64_tr_b16 a[120:121], v14 offset:8192
    ds_read_b64_tr_b16 a[122:123], v14 offset:12288
    ds_read_b64_tr_b16 a[124:125], v15 offset:8192
    ds_read_b64_tr_b16 a[126:127], v15 offset:12288
    v_add_u32 v14, 18432, v14
    v_add_u32 v15, 18432, v15
    s_waitcnt lgkmcnt(0)
    s_waitcnt vmcnt(24)
    s_barrier
    s_add_u32 m0, s45, 38912
    s_nop 0
    buffer_load_dwordx4 v10, s[72:75], s41 offen  lds
    s_add_u32 m0, s45, 39936
    s_add_u32 s42, s41, 5120
    buffer_load_dwordx4 v11, s[72:75], s42 offen  lds
    s_add_u32 m0, s45, 40960
    s_add_u32 s42, s41, 10240
    buffer_load_dwordx4 v10, s[72:75], s42 offen  lds
    s_add_u32 m0, s45, 41984
    s_add_u32 s42, s41, 15360
    buffer_load_dwordx4 v11, s[72:75], s42 offen  lds
    s_add_u32 s41, s41, 81920
    ds_read_b64_tr_b16 a[128:129], v14 offset:0
    ds_read_b64_tr_b16 a[130:131], v14 offset:4096
    ds_read_b64_tr_b16 a[132:133], v15 offset:0
    ds_read_b64_tr_b16 a[134:135], v15 offset:4096
    ds_read_b64_tr_b16 a[136:137], v14 offset:8192
    ds_read_b64_tr_b16 a[138:139], v14 offset:12288
    ds_read_b64_tr_b16 a[140:141], v15 offset:8192
    ds_read_b64_tr_b16 a[142:143], v15 offset:12288
    v_add_u32 v14, 18432, v14
    v_add_u32 v15, 18432, v15
    s_waitcnt lgkmcnt(0)
    s_waitcnt vmcnt(24)
    s_barrier
    ds_read_b64_tr_b16 a[144:145], v14 offset:0
    ds_read_b64_tr_b16 a[146:147], v14 offset:4096
    ds_read_b64_tr_b16 a[148:149], v15 offset:0
    ds_read_b64_tr_b16 a[150:151], v15 offset:4096
    ds_read_b64_tr_b16 a[152:153], v14 offset:8192
    ds_read_b64_tr_b16 a[154:155], v14 offset:12288
    ds_read_b64_tr_b16 a[156:157], v15 offset:8192
    ds_read_b64_tr_b16 a[158:159], v15 offset:12288
    v_add_u32 v14, 18432, v14
    v_add_u32 v15, 18432, v15
    s_waitcnt lgkmcnt(0)
    s_waitcnt vmcnt(20)
    s_barrier
    ds_read_b64_tr_b16 a[160:161], v14 offset:0
    ds_read_b64_tr_b16 a[162:163], v14 offset:4096
    ds_read_b64_tr_b16 a[164:165], v15 offset:0
    ds_read_b64_tr_b16 a[166:167], v15 offset:4096
    ds_read_b64_tr_b16 a[168:169], v14 offset:8192
    ds_read_b64_tr_b16 a[170:171], v14 offset:12288
    ds_read_b64_tr_b16 a[172:173], v15 offset:8192
    ds_read_b64_tr_b16 a[174:175], v15 offset:12288
    v_add_u32 v14, 18432, v14
    v_add_u32 v15, 18432, v15
    s_waitcnt lgkmcnt(0)
    s_waitcnt vmcnt(16)
    s_barrier
    ds_read_b64_tr_b16 a[176:177], v14 offset:0
    ds_read_b64_tr_b16 a[178:179], v14 offset:4096
    ds_read_b64_tr_b16 a[180:181], v15 offset:0
    ds_read_b64_tr_b16 a[182:183], v15 offset:4096
    ds_read_b64_tr_b16 a[184:185], v14 offset:8192
    ds_read_b64_tr_b16 a[186:187], v14 offset:12288
    ds_read_b64_tr_b16 a[188:189], v15 offset:8192
    ds_read_b64_tr_b16 a[190:191], v15 offset:12288
    v_add_u32 v14, 18432, v14
    v_add_u32 v15, 18432, v15
    s_waitcnt lgkmcnt(0)
    s_waitcnt vmcnt(12)
    s_barrier
    ds_read_b64_tr_b16 a[192:193], v14 offset:0
    ds_read_b64_tr_b16 a[194:195], v14 offset:4096
    ds_read_b64_tr_b16 a[196:197], v15 offset:0
    ds_read_b64_tr_b16 a[198:199], v15 offset:4096
    ds_read_b64_tr_b16 a[200:201], v14 offset:8192
    ds_read_b64_tr_b16 a[202:203], v14 offset:12288
    ds_read_b64_tr_b16 a[204:205], v15 offset:8192
    ds_read_b64_tr_b16 a[206:207], v15 offset:12288
    v_subrev_u32 v14, 129024, v14
    v_subrev_u32 v15, 129024, v15
    s_waitcnt lgkmcnt(0)
    s_waitcnt vmcnt(8)
    s_barrier
    ds_read_b64_tr_b16 a[208:209], v14 offset:0
    ds_read_b64_tr_b16 a[210:211], v14 offset:4096
    ds_read_b64_tr_b16 a[212:213], v15 offset:0
    ds_read_b64_tr_b16 a[214:215], v15 offset:4096
    ds_read_b64_tr_b16 a[216:217], v14 offset:8192
    ds_read_b64_tr_b16 a[218:219], v14 offset:12288
    ds_read_b64_tr_b16 a[220:221], v15 offset:8192
    ds_read_b64_tr_b16 a[222:223], v15 offset:12288
    v_add_u32 v14, 18432, v14
    v_add_u32 v15, 18432, v15
    s_waitcnt lgkmcnt(0)
    s_waitcnt vmcnt(4)
    s_barrier
    ds_read_b64_tr_b16 a[224:225], v14 offset:0
    ds_read_b64_tr_b16 a[226:227], v14 offset:4096
    ds_read_b64_tr_b16 a[228:229], v15 offset:0
    ds_read_b64_tr_b16 a[230:231], v15 offset:4096
    ds_read_b64_tr_b16 a[232:233], v14 offset:8192
    ds_read_b64_tr_b16 a[234:235], v14 offset:12288
    ds_read_b64_tr_b16 a[236:237], v15 offset:8192
    ds_read_b64_tr_b16 a[238:239], v15 offset:12288
    v_add_u32 v14, 18432, v14
    v_add_u32 v15, 18432, v15
    s_waitcnt lgkmcnt(0)
    s_waitcnt vmcnt(0)
    s_barrier
    ds_read_b64_tr_b16 a[240:241], v14 offset:0
    ds_read_b64_tr_b16 a[242:243], v14 offset:4096
    ds_read_b64_tr_b16 a[244:245], v15 offset:0
    ds_read_b64_tr_b16 a[246:247], v15 offset:4096
    ds_read_b64_tr_b16 a[248:249], v14 offset:8192
    ds_read_b64_tr_b16 a[250:251], v14 offset:12288
    ds_read_b64_tr_b16 a[252:253], v15 offset:8192
    ds_read_b64_tr_b16 a[254:255], v15 offset:12288
    v_add_u32 v14, 18432, v14
    v_add_u32 v15, 18432, v15
    s_waitcnt lgkmcnt(0)
    s_barrier
    s_cmp_lg_u32 s29, 0
    s_cbranch_scc1 wk_dn_mb_dw
    v_mov_b32 v2, 140
wk_dn_mb_sp:
    buffer_load_dword v3, v2, s[8:11], 0 offen sc1
    s_waitcnt vmcnt(0)
    v_readfirstlane_b32 s37, v3
    s_nop 0
    s_cmp_ge_u32 s37, 80
    s_cbranch_scc1 wk_dn_mb_dw
    s_sleep 4
    s_branch wk_dn_mb_sp
wk_dn_mb_dw:
    s_barrier
    v_and_b32 v4, 15, v1
    v_lshrrev_b32 v5, 4, v1
    v_mul_u32_u24 v4, 1280, v4
    v_lshl_add_u32 v4, v5, 3, v4
    v_lshlrev_b32 v5, 4, v5
    s_lshl_b32 s32, s29, 6
    s_add_u32 s58, s58, s32
    s_lshl_b32 s33, s58, 1
    s_add_u32 s33, s33, 12800
    buffer_load_dwordx4 v[72:75], v5, s[4:7], s33 offen sc1
    buffer_load_dwordx4 v[76:79], v5, s[4:7], s33 offen offset:64 sc1
    s_and_b32 s31, s53, 1
    s_mul_i32 s56, s31, 55296
    s_add_u32 s56, s56, 84934144
    s_mul_i32 s31, s31, 20480
    s_add_u32 s59, s58, s31
    s_waitcnt vmcnt(0)
wk_dn_loop:
    s_mul_i32 s55, s52, 110592
    s_add_u32 s55, s55, s56
    s_mul_i32 s33, s52, 40960
    s_add_u32 s33, s33, s59
    s_add_u32 s34, s33, 61865984
    s_cmp_lg_u32 s29, 0
    s_cbranch_scc1 wk_dn_dw
    s_lshl_b32 s39, s52, 7
    s_add_u32 s39, s39, 294912
    v_mov_b32 v2, 0
wk_dn_sp:
    buffer_load_dword v3, v2, s[4:7], s39 offen sc1
    s_waitcnt vmcnt(0)
    v_readfirstlane_b32 s37, v3
    s_nop 0
    s_cmp_ge_u32 s37, 27
    s_cbranch_scc1 wk_dn_dw
    s_sleep 6
    s_branch wk_dn_sp
wk_dn_dw:
    s_barrier
    s_mul_i32 s57, s29, 4096
    s_mov_b32 m0, s57
    s_add_u32 s57, s57, s55
    buffer_load_dwordx4 v8, s[4:7], s57 offen offset:0 sc1 lds
    buffer_load_dwordx4 v9, s[4:7], s57 offen offset:1024 sc1 lds
    buffer_load_dwordx4 v8, s[4:7], s57 offen offset:2048 sc1 lds
    buffer_load_dwordx4 v9, s[4:7], s57 offen offset:3072 sc1 lds
    s_mul_i32 s57, s29, 4096
    s_add_u32 s57, s57, 16384
    s_mov_b32 m0, s57
    s_add_u32 s57, s57, s55
    buffer_load_dwordx4 v8, s[4:7], s57 offen offset:0 sc1 lds
    buffer_load_dwordx4 v9, s[4:7], s57 offen offset:1024 sc1 lds
    buffer_load_dwordx4 v8, s[4:7], s57 offen offset:2048 sc1 lds
    buffer_load_dwordx4 v9, s[4:7], s57 offen offset:3072 sc1 lds
    s_mul_i32 s57, s29, 4096
    s_add_u32 s57, s57, 32768
    s_mov_b32 m0, s57
    s_add_u32 s57, s57, s55
    buffer_load_dwordx4 v8, s[4:7], s57 offen offset:0 sc1 lds
    buffer_load_dwordx4 v9, s[4:7], s57 offen offset:1024 sc1 lds
    buffer_load_dwordx4 v8, s[4:7], s57 offen offset:2048 sc1 lds
    buffer_load_dwordx4 v9, s[4:7], s57 offen offset:3072 sc1 lds
    s_mul_i32 s57, s29, 2048
    s_add_u32 s57, s57, 49152
    s_mov_b32 m0, s57
    s_add_u32 s57, s57, s55
    buffer_load_dwordx4 v8, s[4:7], s57 offen offset:0 sc1 lds
    buffer_load_dwordx4 v9, s[4:7], s57 offen offset:1024 sc1 lds
    buffer_load_dwordx2 v[16:17], v4, s[4:7], s34 offen sc1
    buffer_load_dwordx2 v[18:19], v4, s[4:7], s34 offen offset:32 sc1
    s_waitcnt vmcnt(12)
    s_barrier
    ds_read_b128 v[40:43], v12 offset:0
    ds_read_b128 v[44:47], v13 offset:0
    ds_read_b128 v[48:51], v12 offset:2048
    ds_read_b128 v[52:55], v13 offset:2048
    ds_read_b128 v[56:59], v12 offset:4096
    ds_read_b128 v[60:63], v13 offset:4096
    ds_read_b128 v[64:67], v12 offset:6144
    ds_read_b128 v[68:71], v13 offset:6144
    s_waitcnt lgkmcnt(7)
    v_mfma_f32_16x16x32_bf16 v[24:27], v[80:83], v[40:43], 0
    v_mfma_f32_16x16x32_bf16 v[28:31], v[84:87], v[40:43], 0
    s_waitcnt lgkmcnt(6)
    v_mfma_f32_16x16x32_bf16 v[32:35], v[88:91], v[44:47], 0
    v_mfma_f32_16x16x32_bf16 v[36:39], v[92:95], v[44:47], 0
    s_waitcnt lgkmcnt(5)
    v_mfma_f32_16x16x32_bf16 v[24:27], v[96:99], v[48:51], v[24:27]
    v_mfma_f32_16x16x32_bf16 v[28:31], v[100:103], v[48:51], v[28:31]
    s_waitcnt lgkmcnt(4)
    v_mfma_f32_16x16x32_bf16 v[32:35], v[104:107], v[52:55], v[32:35]
    v_mfma_f32_16x16x32_bf16 v[36:39], v[108:111], v[52:55], v[36:39]
    ds_read_b128 v[40:43], v12 offset:8192
    ds_read_b128 v[44:47], v13 offset:8192
    ds_read_b128 v[48:51], v12 offset:10240
    ds_read_b128 v[52:55], v13 offset:10240
    s_waitcnt lgkmcnt(7)
    v_mfma_f32_16x16x32_bf16 v[24:27], v[112:115], v[56:59], v[24:27]
    v_mfma_f32_16x16x32_bf16 v[28:31], v[116:119], v[56:59], v[28:31]
    s_waitcnt lgkmcnt(6)
    v_mfma_f32_16x16x32_bf16 v[32:35], v[120:123], v[60:63], v[32:35]
    v_mfma_f32_16x16x32_bf16 v[36:39], v[124:127], v[60:63], v[36:39]
    s_waitcnt lgkmcnt(5)
    v_mfma_f32_16x16x32_bf16 v[24:27], v[128:131], v[64:67], v[24:27]
    v_mfma_f32_16x16x32_bf16 v[28:31], v[132:135], v[64:67], v[28:31]
    s_waitcnt lgkmcnt(4)
    v_mfma_f32_16x16x32_bf16 v[32:35], v[136:139], v[68:71], v[32:35]
    v_mfma_f32_16x16x32_bf16 v[36:39], v[140:143], v[68:71], v[36:39]
    ds_read_b128 v[56:59], v12 offset:12288
    ds_read_b128 v[60:63], v13 offset:12288
    ds_read_b128 v[64:67], v12 offset:14336
    ds_read_b128 v[68:71], v13 offset:14336
    s_waitcnt lgkmcnt(7)
    v_mfma_f32_16x16x32_bf16 v[24:27], v[144:147], v[40:43], v[24:27]
    v_mfma_f32_16x16x32_bf16 v[28:31], v[148:151], v[40:43], v[28:31]
    s_waitcnt lgkmcnt(6)
    v_mfma_f32_16x16x32_bf16 v[32:35], v[152:155], v[44:47], v[32:35]
    v_mfma_f32_16x16x32_bf16 v[36:39], v[156:159], v[44:47], v[36:39]
    s_waitcnt lgkmcnt(5)
    v_mfma_f32_16x16x32_bf16 v[24:27], v[160:163], v[48:51], v[24:27]
    v_mfma_f32_16x16x32_bf16 v[28:31], v[164:167], v[48:51], v[28:31]
    s_waitcnt lgkmcnt(4)
    v_mfma_f32_16x16x32_bf16 v[32:35], v[168:171], v[52:55], v[32:35]
    v_mfma_f32_16x16x32_bf16 v[36:39], v[172:175], v[52:55], v[36:39]
    s_waitcnt vmcnt(8)
    s_barrier
    ds_read_b128 v[40:43], v12 offset:16384
    ds_read_b128 v[44:47], v13 offset:16384
    ds_read_b128 v[48:51], v12 offset:18432
    ds_read_b128 v[52:55], v13 offset:18432
    s_waitcnt lgkmcnt(7)
    v_mfma_f32_16x16x32_bf16 v[24:27], v[176:179], v[56:59], v[24:27]
    v_mfma_f32_16x16x32_bf16 v[28:31], v[180:183], v[56:59], v[28:31]
    s_waitcnt lgkmcnt(6)
    v_mfma_f32_16x16x32_bf16 v[32:35], v[184:187], v[60:63], v[32:35]
    v_mfma_f32_16x16x32_bf16 v[36:39], v[188:191], v[60:63], v[36:39]
    s_waitcnt lgkmcnt(5)
    v_mfma_f32_16x16x32_bf16 v[24:27], v[192:195], v[64:67], v[24:27]
    v_mfma_f32_16x16x32_bf16 v[28:31], v[196:199], v[64:67], v[28:31]
    s_waitcnt lgkmcnt(4)
    v_mfma_f32_16x16x32_bf16 v[32:35], v[200:203], v[68:71], v[32:35]
    v_mfma_f32_16x16x32_bf16 v[36:39], v[204:207], v[68:71], v[36:39]
    ds_read_b128 v[56:59], v12 offset:20480
    ds_read_b128 v[60:63], v13 offset:20480
    ds_read_b128 v[64:67], v12 offset:22528
    ds_read_b128 v[68:71], v13 offset:22528
    s_waitcnt lgkmcnt(7)
    v_mfma_f32_16x16x32_bf16 v[24:27], v[208:211], v[40:43], v[24:27]
    v_mfma_f32_16x16x32_bf16 v[28:31], v[212:215], v[40:43], v[28:31]
    s_waitcnt lgkmcnt(6)
    v_mfma_f32_16x16x32_bf16 v[32:35], v[216:219], v[44:47], v[32:35]
    v_mfma_f32_16x16x32_bf16 v[36:39], v[220:223], v[44:47], v[36:39]
    s_waitcnt lgkmcnt(5)
    v_mfma_f32_16x16x32_bf16 v[24:27], v[224:227], v[48:51], v[24:27]
    v_mfma_f32_16x16x32_bf16 v[28:31], v[228:231], v[48:51], v[28:31]
    s_waitcnt lgkmcnt(4)
    v_mfma_f32_16x16x32_bf16 v[32:35], v[232:235], v[52:55], v[32:35]
    v_mfma_f32_16x16x32_bf16 v[36:39], v[236:239], v[52:55], v[36:39]
    ds_read_b128 v[40:43], v12 offset:24576
    ds_read_b128 v[44:47], v13 offset:24576
    ds_read_b128 v[48:51], v12 offset:26624
    ds_read_b128 v[52:55], v13 offset:26624
    s_waitcnt lgkmcnt(7)
    v_mfma_f32_16x16x32_bf16 v[24:27], v[240:243], v[56:59], v[24:27]
    v_mfma_f32_16x16x32_bf16 v[28:31], v[244:247], v[56:59], v[28:31]
    s_waitcnt lgkmcnt(6)
    v_mfma_f32_16x16x32_bf16 v[32:35], v[248:251], v[60:63], v[32:35]
    v_mfma_f32_16x16x32_bf16 v[36:39], v[252:255], v[60:63], v[36:39]
    s_waitcnt lgkmcnt(5)
    v_mfma_f32_16x16x32_bf16 v[24:27], a[0:3], v[64:67], v[24:27]
    v_mfma_f32_16x16x32_bf16 v[28:31], a[4:7], v[64:67], v[28:31]
    s_waitcnt lgkmcnt(4)
    v_mfma_f32_16x16x32_bf16 v[32:35], a[8:11], v[68:71], v[32:35]
    v_mfma_f32_16x16x32_bf16 v[36:39], a[12:15], v[68:71], v[36:39]
    ds_read_b128 v[56:59], v12 offset:28672
    ds_read_b128 v[60:63], v13 offset:28672
    ds_read_b128 v[64:67], v12 offset:30720
    ds_read_b128 v[68:71], v13 offset:30720
    s_waitcnt lgkmcnt(7)
    v_mfma_f32_16x16x32_bf16 v[24:27], a[16:19], v[40:43], v[24:27]
    v_mfma_f32_16x16x32_bf16 v[28:31], a[20:23], v[40:43], v[28:31]
    s_waitcnt lgkmcnt(6)
    v_mfma_f32_16x16x32_bf16 v[32:35], a[24:27], v[44:47], v[32:35]
    v_mfma_f32_16x16x32_bf16 v[36:39], a[28:31], v[44:47], v[36:39]
    s_waitcnt lgkmcnt(5)
    v_mfma_f32_16x16x32_bf16 v[24:27], a[32:35], v[48:51], v[24:27]
    v_mfma_f32_16x16x32_bf16 v[28:31], a[36:39], v[48:51], v[28:31]
    s_waitcnt lgkmcnt(4)
    v_mfma_f32_16x16x32_bf16 v[32:35], a[40:43], v[52:55], v[32:35]
    v_mfma_f32_16x16x32_bf16 v[36:39], a[44:47], v[52:55], v[36:39]
    s_waitcnt vmcnt(4)
    s_barrier
    ds_read_b128 v[40:43], v12 offset:32768
    ds_read_b128 v[44:47], v13 offset:32768
    ds_read_b128 v[48:51], v12 offset:34816
    ds_read_b128 v[52:55], v13 offset:34816
    s_waitcnt lgkmcnt(7)
    v_mfma_f32_16x16x32_bf16 v[24:27], a[48:51], v[56:59], v[24:27]
    v_mfma_f32_16x16x32_bf16 v[28:31], a[52:55], v[56:59], v[28:31]
    s_waitcnt lgkmcnt(6)
    v_mfma_f32_16x16x32_bf16 v[32:35], a[56:59], v[60:63], v[32:35]
    v_mfma_f32_16x16x32_bf16 v[36:39], a[60:63], v[60:63], v[36:39]
    s_waitcnt lgkmcnt(5)
    v_mfma_f32_16x16x32_bf16 v[24:27], a[64:67], v[64:67], v[24:27]
    v_mfma_f32_16x16x32_bf16 v[28:31], a[68:71], v[64:67], v[28:31]
    s_waitcnt lgkmcnt(4)
    v_mfma_f32_16x16x32_bf16 v[32:35], a[72:75], v[68:71], v[32:35]
    v_mfma_f32_16x16x32_bf16 v[36:39], a[76:79], v[68:71], v[36:39]
    ds_read_b128 v[56:59], v12 offset:36864
    ds_read_b128 v[60:63], v13 offset:36864
    ds_read_b128 v[64:67], v12 offset:38912
    ds_read_b128 v[68:71], v13 offset:38912
    s_waitcnt lgkmcnt(7)
    v_mfma_f32_16x16x32_bf16 v[24:27], a[80:83], v[40:43], v[24:27]
    v_mfma_f32_16x16x32_bf16 v[28:31], a[84:87], v[40:43], v[28:31]
    s_waitcnt lgkmcnt(6)
    v_mfma_f32_16x16x32_bf16 v[32:35], a[88:91], v[44:47], v[32:35]
    v_mfma_f32_16x16x32_bf16 v[36:39], a[92:95], v[44:47], v[36:39]
    s_waitcnt lgkmcnt(5)
    v_mfma_f32_16x16x32_bf16 v[24:27], a[96:99], v[48:51], v[24:27]
    v_mfma_f32_16x16x32_bf16 v[28:31], a[100:103], v[48:51], v[28:31]
    s_waitcnt lgkmcnt(4)
    v_mfma_f32_16x16x32_bf16 v[32:35], a[104:107], v[52:55], v[32:35]
    v_mfma_f32_16x16x32_bf16 v[36:39], a[108:111], v[52:55], v[36:39]
    ds_read_b128 v[40:43], v12 offset:40960
    ds_read_b128 v[44:47], v13 offset:40960
    ds_read_b128 v[48:51], v12 offset:43008
    ds_read_b128 v[52:55], v13 offset:43008
    s_waitcnt lgkmcnt(7)
    v_mfma_f32_16x16x32_bf16 v[24:27], a[112:115], v[56:59], v[24:27]
    v_mfma_f32_16x16x32_bf16 v[28:31], a[116:119], v[56:59], v[28:31]
    s_waitcnt lgkmcnt(6)
    v_mfma_f32_16x16x32_bf16 v[32:35], a[120:123], v[60:63], v[32:35]
    v_mfma_f32_16x16x32_bf16 v[36:39], a[124:127], v[60:63], v[36:39]
    s_waitcnt lgkmcnt(5)
    v_mfma_f32_16x16x32_bf16 v[24:27], a[128:131], v[64:67], v[24:27]
    v_mfma_f32_16x16x32_bf16 v[28:31], a[132:135], v[64:67], v[28:31]
    s_waitcnt lgkmcnt(4)
    v_mfma_f32_16x16x32_bf16 v[32:35], a[136:139], v[68:71], v[32:35]
    v_mfma_f32_16x16x32_bf16 v[36:39], a[140:143], v[68:71], v[36:39]
    ds_read_b128 v[56:59], v12 offset:45056
    ds_read_b128 v[60:63], v13 offset:45056
    ds_read_b128 v[64:67], v12 offset:47104
    ds_read_b128 v[68:71], v13 offset:47104
    s_waitcnt lgkmcnt(7)
    v_mfma_f32_16x16x32_bf16 v[24:27], a[144:147], v[40:43], v[24:27]
    v_mfma_f32_16x16x32_bf16 v[28:31], a[148:151], v[40:43], v[28:31]
    s_waitcnt lgkmcnt(6)
    v_mfma_f32_16x16x32_bf16 v[32:35], a[152:155], v[44:47], v[32:35]
    v_mfma_f32_16x16x32_bf16 v[36:39], a[156:159], v[44:47], v[36:39]
    s_waitcnt lgkmcnt(5)
    v_mfma_f32_16x16x32_bf16 v[24:27], a[160:163], v[48:51], v[24:27]
    v_mfma_f32_16x16x32_bf16 v[28:31], a[164:167], v[48:51], v[28:31]
    s_waitcnt lgkmcnt(4)
    v_mfma_f32_16x16x32_bf16 v[32:35], a[168:171], v[52:55], v[32:35]
    v_mfma_f32_16x16x32_bf16 v[36:39], a[172:175], v[52:55], v[36:39]
    s_waitcnt vmcnt(2)
    s_barrier
    ds_read_b128 v[40:43], v12 offset:49152
    ds_read_b128 v[44:47], v13 offset:49152
    ds_read_b128 v[48:51], v12 offset:51200
    ds_read_b128 v[52:55], v13 offset:51200
    s_waitcnt lgkmcnt(7)
    v_mfma_f32_16x16x32_bf16 v[24:27], a[176:179], v[56:59], v[24:27]
    v_mfma_f32_16x16x32_bf16 v[28:31], a[180:183], v[56:59], v[28:31]
    s_waitcnt lgkmcnt(6)
    v_mfma_f32_16x16x32_bf16 v[32:35], a[184:187], v[60:63], v[32:35]
    v_mfma_f32_16x16x32_bf16 v[36:39], a[188:191], v[60:63], v[36:39]
    s_waitcnt lgkmcnt(5)
    v_mfma_f32_16x16x32_bf16 v[24:27], a[192:195], v[64:67], v[24:27]
    v_mfma_f32_16x16x32_bf16 v[28:31], a[196:199], v[64:67], v[28:31]
    s_waitcnt lgkmcnt(4)
    v_mfma_f32_16x16x32_bf16 v[32:35], a[200:203], v[68:71], v[32:35]
    v_mfma_f32_16x16x32_bf16 v[36:39], a[204:207], v[68:71], v[36:39]
    ds_read_b128 v[56:59], v12 offset:53248
    ds_read_b128 v[60:63], v13 offset:53248
    s_waitcnt lgkmcnt(5)
    v_mfma_f32_16x16x32_bf16 v[24:27], a[208:211], v[40:43], v[24:27]
    v_mfma_f32_16x16x32_bf16 v[28:31], a[212:215], v[40:43], v[28:31]
    s_waitcnt lgkmcnt(4)
    v_mfma_f32_16x16x32_bf16 v[32:35], a[216:219], v[44:47], v[32:35]
    v_mfma_f32_16x16x32_bf16 v[36:39], a[220:223], v[44:47], v[36:39]
    s_waitcnt lgkmcnt(3)
    v_mfma_f32_16x16x32_bf16 v[24:27], a[224:227], v[48:51], v[24:27]
    v_mfma_f32_16x16x32_bf16 v[28:31], a[228:231], v[48:51], v[28:31]
    s_waitcnt lgkmcnt(2)
    v_mfma_f32_16x16x32_bf16 v[32:35], a[232:235], v[52:55], v[32:35]
    v_mfma_f32_16x16x32_bf16 v[36:39], a[236:239], v[52:55], v[36:39]
    s_waitcnt lgkmcnt(1)
    v_mfma_f32_16x16x32_bf16 v[24:27], a[240:243], v[56:59], v[24:27]
    v_mfma_f32_16x16x32_bf16 v[28:31], a[244:247], v[56:59], v[28:31]
    s_waitcnt lgkmcnt(0)
    v_mfma_f32_16x16x32_bf16 v[32:35], a[248:251], v[60:63], v[32:35]
    v_mfma_f32_16x16x32_bf16 v[36:39], a[252:255], v[60:63], v[36:39]
    s_nop 6
    v_pk_add_f32 v[24:25], v[24:25], v[32:33]
    v_pk_add_f32 v[26:27], v[26:27], v[34:35]
    v_pk_add_f32 v[28:29], v[28:29], v[36:37]
    v_pk_add_f32 v[30:31], v[30:31], v[38:39]
    s_waitcnt vmcnt(0)
    v_cvt_pk_bf16_f32 v7, v24, v25
    v_lshlrev_b32 v24, 16, v7
    v_and_b32 v25, 0xffff0000, v7
    v_pk_mul_f32 v[24:25], v[24:25], v[72:73]
    v_cvt_pk_bf16_f32 v7, v24, v25
    v_lshlrev_b32 v24, 16, v7
    v_and_b32 v25, 0xffff0000, v7
    v_lshlrev_b32 v6, 16, v16
    v_and_b32 v7, 0xffff0000, v16
    v_pk_add_f32 v[24:25], v[24:25], v[6:7]
    v_cvt_pk_bf16_f32 v16, v24, v25
    v_cvt_pk_bf16_f32 v7, v26, v27
    v_lshlrev_b32 v26, 16, v7
    v_and_b32 v27, 0xffff0000, v7
    v_pk_mul_f32 v[26:27], v[26:27], v[74:75]
    v_cvt_pk_bf16_f32 v7, v26, v27
    v_lshlrev_b32 v26, 16, v7
    v_and_b32 v27, 0xffff0000, v7
    v_lshlrev_b32 v6, 16, v17
    v_and_b32 v7, 0xffff0000, v17
    v_pk_add_f32 v[26:27], v[26:27], v[6:7]
    v_cvt_pk_bf16_f32 v17, v26, v27
    buffer_store_dwordx2 v[16:17], v4, s[80:83], s33 offen offset:0
    v_cvt_pk_bf16_f32 v7, v28, v29
    v_lshlrev_b32 v28, 16, v7
    v_and_b32 v29, 0xffff0000, v7
    v_pk_mul_f32 v[28:29], v[28:29], v[76:77]
    v_cvt_pk_bf16_f32 v7, v28, v29
    v_lshlrev_b32 v28, 16, v7
    v_and_b32 v29, 0xffff0000, v7
    v_lshlrev_b32 v6, 16, v18
    v_and_b32 v7, 0xffff0000, v18
    v_pk_add_f32 v[28:29], v[28:29], v[6:7]
    v_cvt_pk_bf16_f32 v18, v28, v29
    v_cvt_pk_bf16_f32 v7, v30, v31
    v_lshlrev_b32 v30, 16, v7
    v_and_b32 v31, 0xffff0000, v7
    v_pk_mul_f32 v[30:31], v[30:31], v[78:79]
    v_cvt_pk_bf16_f32 v7, v30, v31
    v_lshlrev_b32 v30, 16, v7
    v_and_b32 v31, 0xffff0000, v7
    v_lshlrev_b32 v6, 16, v19
    v_and_b32 v7, 0xffff0000, v19
    v_pk_add_f32 v[30:31], v[30:31], v[6:7]
    v_cvt_pk_bf16_f32 v19, v30, v31
    buffer_store_dwordx2 v[18:19], v4, s[80:83], s33 offen offset:32
    s_waitcnt vmcnt(0) lgkmcnt(0)
    s_barrier
    s_cmp_lt_u32 s52, 16
    s_cselect_b32 s38, 1, 2
    s_add_u32 s52, s52, s38
    s_cmp_lt_u32 s52, 64
    s_cbranch_scc1 wk_dn_loop
    s_endpgm
wk_mod:
    s_load_dwordx2 s[96:97], s[0:1], 88
    s_load_dwordx2 s[98:99], s[0:1], 96
    s_waitcnt lgkmcnt(0)
    s_mov_b32 s88, s96
    s_and_b32 s89, s97, 0xffff
    s_mov_b32 s90, 1280
    s_mov_b32 s91, 0x20000
    s_mov_b32 s92, s98
    s_and_b32 s93, s99, 0xffff
    s_mov_b32 s94, 4915200
    s_mov_b32 s95, 0x20000
    s_lshl_b32 s30, s29, 6
    v_add_u32 v0, s30, v1
    s_cmp_ge_u32 s53, 40
    s_cbranch_scc1 wk_mod_nz
    v_mov_b32 v4, 0
    v_mov_b32 v5, 0
    v_lshlrev_b32 v2, 3, v0
    s_lshl_b32 s31, s53, 11
    s_add_u32 s31, s31, 262144
    buffer_store_dwordx2 v[4:5], v2, s[4:7], s31 offen sc1
    s_cmp_lg_u32 s53, 0
    s_cbranch_scc1 wk_mod_nz
    v_mov_b32 v4, 0
    v_mov_b32 v5, 0
    v_mov_b32 v6, 0
    v_mov_b32 v7, 0
    v_lshlrev_b32 v2, 4, v0
    s_mov_b32 s31, 32768
    buffer_store_dwordx4 v[4:7], v2, s[4:7], s31 offen sc1
    s_add_u32 s31, s31, 4096
    buffer_store_dwordx4 v[4:7], v2, s[4:7], s31 offen sc1
    s_add_u32 s31, s31, 4096
    buffer_store_dwordx4 v[4:7], v2, s[4:7], s31 offen sc1
    s_add_u32 s31, s31, 4096
    buffer_store_dwordx4 v[4:7], v2, s[4:7], s31 offen sc1
    s_add_u32 s31, s31, 4096
    buffer_store_dwordx4 v[4:7], v2, s[4:7], s31 offen sc1
    s_add_u32 s31, s31, 4096
wk_mod_nz:
    s_nop 1
    v_lshlrev_b32 v14, 1, v0
    v_lshlrev_b32 v2, 2, v0
    s_mov_b32 s30, 0xbfb8aa3b
    buffer_load_ushort v4, v14, s[88:91], 0 offen offset:0
    buffer_load_ushort v5, v14, s[88:91], 0 offen offset:512
    buffer_load_ushort v6, v14, s[88:91], 0 offen offset:1024
    v_and_b32 v8, 3, v0
    v_lshrrev_b32 v9, 2, v0
    v_mul_u32_u24 v10, 7680, v9
    v_lshl_add_u32 v10, v8, 4, v10
    s_lshl_b32 s31, s53, 6
    buffer_load_dwordx4 v[32:35], v10, s[92:95], s31 offen
    s_add_u32 s31, s31, 491520
    buffer_load_dwordx4 v[36:39], v10, s[92:95], s31 offen
    s_add_u32 s31, s31, 491520
    buffer_load_dwordx4 v[40:43], v10, s[92:95], s31 offen
    s_add_u32 s31, s31, 491520
    buffer_load_dwordx4 v[44:47], v10, s[92:95], s31 offen
    s_add_u32 s31, s31, 491520
    buffer_load_dwordx4 v[48:51], v10, s[92:95], s31 offen
    s_add_u32 s31, s31, 491520
    buffer_load_dwordx4 v[52:55], v10, s[92:95], s31 offen
    s_add_u32 s31, s31, 491520
    buffer_load_dwordx4 v[56:59], v10, s[92:95], s31 offen
    s_add_u32 s31, s31, 491520
    buffer_load_dwordx4 v[60:63], v10, s[92:95], s31 offen
    s_add_u32 s31, s31, 491520
    buffer_load_dwordx4 v[64:67], v10, s[92:95], s31 offen
    s_add_u32 s31, s31, 491520
    buffer_load_dwordx4 v[68:71], v10, s[92:95], s31 offen
    s_waitcnt vmcnt(10)
    v_lshlrev_b32 v4, 16, v4
    v_mul_f32 v7, s30, v4
    v_exp_f32 v7, v7
    s_nop 0
    v_add_f32 v7, 1.0, v7
    v_rcp_f32 v7, v7
    s_nop 0
    v_mul_f32 v4, v4, v7
    v_cvt_pk_bf16_f32 v4, v4, v4
    v_lshlrev_b32 v4, 16, v4
    ds_write_b32 v2, v4 offset:0
    v_lshlrev_b32 v5, 16, v5
    v_mul_f32 v7, s30, v5
    v_exp_f32 v7, v7
    s_nop 0
    v_add_f32 v7, 1.0, v7
    v_rcp_f32 v7, v7
    s_nop 0
    v_mul_f32 v5, v5, v7
    v_cvt_pk_bf16_f32 v5, v5, v5
    v_lshlrev_b32 v5, 16, v5
    ds_write_b32 v2, v5 offset:1024
    v_lshlrev_b32 v6, 16, v6
    v_mul_f32 v7, s30, v6
    v_exp_f32 v7, v7
    s_nop 0
    v_add_f32 v7, 1.0, v7
    v_rcp_f32 v7, v7
    s_nop 0
    v_mul_f32 v6, v6, v7
    v_cvt_pk_bf16_f32 v6, v6, v6
    v_lshlrev_b32 v6, 16, v6
    ds_write_b32 v2, v6 offset:2048
    s_waitcnt lgkmcnt(0)
    s_barrier
    v_lshlrev_b32 v11, 2, v9
    ds_read_b32 v112, v11 offset:0
    ds_read_b32 v113, v11 offset:256
    ds_read_b32 v114, v11 offset:512
    ds_read_b32 v115, v11 offset:768
    ds_read_b32 v116, v11 offset:1024
    ds_read_b32 v117, v11 offset:1280
    ds_read_b32 v118, v11 offset:1536
    ds_read_b32 v119, v11 offset:1792
    ds_read_b32 v120, v11 offset:2048
    ds_read_b32 v121, v11 offset:2304
    v_mov_b32 v16, 0
    v_mov_b32 v17, 0
    v_mov_b32 v18, 0
    v_mov_b32 v19, 0
    v_mov_b32 v20, 0
    v_mov_b32 v21, 0
    v_mov_b32 v22, 0
    v_mov_b32 v23, 0
    s_waitcnt lgkmcnt(0)
    s_waitcnt vmcnt(9)
    v_lshlrev_b32 v12, 16, v32
    v_and_b32 v13, 0xffff0000, v32
    v_fmac_f32 v16, v12, v112
    v_fmac_f32 v17, v13, v112
    v_lshlrev_b32 v12, 16, v33
    v_and_b32 v13, 0xffff0000, v33
    v_fmac_f32 v18, v12, v112
    v_fmac_f32 v19, v13, v112
    v_lshlrev_b32 v12, 16, v34
    v_and_b32 v13, 0xffff0000, v34
    v_fmac_f32 v20, v12, v112
    v_fmac_f32 v21, v13, v112
    v_lshlrev_b32 v12, 16, v35
    v_and_b32 v13, 0xffff0000, v35
    v_fmac_f32 v22, v12, v112
    v_fmac_f32 v23, v13, v112
    s_waitcnt vmcnt(8)
    v_lshlrev_b32 v12, 16, v36
    v_and_b32 v13, 0xffff0000, v36
    v_fmac_f32 v16, v12, v113
    v_fmac_f32 v17, v13, v113
    v_lshlrev_b32 v12, 16, v37
    v_and_b32 v13, 0xffff0000, v37
    v_fmac_f32 v18, v12, v113
    v_fmac_f32 v19, v13, v113
    v_lshlrev_b32 v12, 16, v38
    v_and_b32 v13, 0xffff0000, v38
    v_fmac_f32 v20, v12, v113
    v_fmac_f32 v21, v13, v113
    v_lshlrev_b32 v12, 16, v39
    v_and_b32 v13, 0xffff0000, v39
    v_fmac_f32 v22, v12, v113
    v_fmac_f32 v23, v13, v113
    s_waitcnt vmcnt(7)
    v_lshlrev_b32 v12, 16, v40
    v_and_b32 v13, 0xffff0000, v40
    v_fmac_f32 v16, v12, v114
    v_fmac_f32 v17, v13, v114
    v_lshlrev_b32 v12, 16, v41
    v_and_b32 v13, 0xffff0000, v41
    v_fmac_f32 v18, v12, v114
    v_fmac_f32 v19, v13, v114
    v_lshlrev_b32 v12, 16, v42
    v_and_b32 v13, 0xffff0000, v42
    v_fmac_f32 v20, v12, v114
    v_fmac_f32 v21, v13, v114
    v_lshlrev_b32 v12, 16, v43
    v_and_b32 v13, 0xffff0000, v43
    v_fmac_f32 v22, v12, v114
    v_fmac_f32 v23, v13, v114
    s_waitcnt vmcnt(6)
    v_lshlrev_b32 v12, 16, v44
    v_and_b32 v13, 0xffff0000, v44
    v_fmac_f32 v16, v12, v115
    v_fmac_f32 v17, v13, v115
    v_lshlrev_b32 v12, 16, v45
    v_and_b32 v13, 0xffff0000, v45
    v_fmac_f32 v18, v12, v115
    v_fmac_f32 v19, v13, v115
    v_lshlrev_b32 v12, 16, v46
    v_and_b32 v13, 0xffff0000, v46
    v_fmac_f32 v20, v12, v115
    v_fmac_f32 v21, v13, v115
    v_lshlrev_b32 v12, 16, v47
    v_and_b32 v13, 0xffff0000, v47
    v_fmac_f32 v22, v12, v115
    v_fmac_f32 v23, v13, v115
    s_waitcnt vmcnt(5)
    v_lshlrev_b32 v12, 16, v48
    v_and_b32 v13, 0xffff0000, v48
    v_fmac_f32 v16, v12, v116
    v_fmac_f32 v17, v13, v116
    v_lshlrev_b32 v12, 16, v49
    v_and_b32 v13, 0xffff0000, v49
    v_fmac_f32 v18, v12, v116
    v_fmac_f32 v19, v13, v116
    v_lshlrev_b32 v12, 16, v50
    v_and_b32 v13, 0xffff0000, v50
    v_fmac_f32 v20, v12, v116
    v_fmac_f32 v21, v13, v116
    v_lshlrev_b32 v12, 16, v51
    v_and_b32 v13, 0xffff0000, v51
    v_fmac_f32 v22, v12, v116
    v_fmac_f32 v23, v13, v116
    s_waitcnt vmcnt(4)
    v_lshlrev_b32 v12, 16, v52
    v_and_b32 v13, 0xffff0000, v52
    v_fmac_f32 v16, v12, v117
    v_fmac_f32 v17, v13, v117
    v_lshlrev_b32 v12, 16, v53
    v_and_b32 v13, 0xffff0000, v53
    v_fmac_f32 v18, v12, v117
    v_fmac_f32 v19, v13, v117
    v_lshlrev_b32 v12, 16, v54
    v_and_b32 v13, 0xffff0000, v54
    v_fmac_f32 v20, v12, v117
    v_fmac_f32 v21, v13, v117
    v_lshlrev_b32 v12, 16, v55
    v_and_b32 v13, 0xffff0000, v55
    v_fmac_f32 v22, v12, v117
    v_fmac_f32 v23, v13, v117
    s_waitcnt vmcnt(3)
    v_lshlrev_b32 v12, 16, v56
    v_and_b32 v13, 0xffff0000, v56
    v_fmac_f32 v16, v12, v118
    v_fmac_f32 v17, v13, v118
    v_lshlrev_b32 v12, 16, v57
    v_and_b32 v13, 0xffff0000, v57
    v_fmac_f32 v18, v12, v118
    v_fmac_f32 v19, v13, v118
    v_lshlrev_b32 v12, 16, v58
    v_and_b32 v13, 0xffff0000, v58
    v_fmac_f32 v20, v12, v118
    v_fmac_f32 v21, v13, v118
    v_lshlrev_b32 v12, 16, v59
    v_and_b32 v13, 0xffff0000, v59
    v_fmac_f32 v22, v12, v118
    v_fmac_f32 v23, v13, v118
    s_waitcnt vmcnt(2)
    v_lshlrev_b32 v12, 16, v60
    v_and_b32 v13, 0xffff0000, v60
    v_fmac_f32 v16, v12, v119
    v_fmac_f32 v17, v13, v119
    v_lshlrev_b32 v12, 16, v61
    v_and_b32 v13, 0xffff0000, v61
    v_fmac_f32 v18, v12, v119
    v_fmac_f32 v19, v13, v119
    v_lshlrev_b32 v12, 16, v62
    v_and_b32 v13, 0xffff0000, v62
    v_fmac_f32 v20, v12, v119
    v_fmac_f32 v21, v13, v119
    v_lshlrev_b32 v12, 16, v63
    v_and_b32 v13, 0xffff0000, v63
    v_fmac_f32 v22, v12, v119
    v_fmac_f32 v23, v13, v119
    s_waitcnt vmcnt(1)
    v_lshlrev_b32 v12, 16, v64
    v_and_b32 v13, 0xffff0000, v64
    v_fmac_f32 v16, v12, v120
    v_fmac_f32 v17, v13, v120
    v_lshlrev_b32 v12, 16, v65
    v_and_b32 v13, 0xffff0000, v65
    v_fmac_f32 v18, v12, v120
    v_fmac_f32 v19, v13, v120
    v_lshlrev_b32 v12, 16, v66
    v_and_b32 v13, 0xffff0000, v66
    v_fmac_f32 v20, v12, v120
    v_fmac_f32 v21, v13, v120
    v_lshlrev_b32 v12, 16, v67
    v_and_b32 v13, 0xffff0000, v67
    v_fmac_f32 v22, v12, v120
    v_fmac_f32 v23, v13, v120
    s_waitcnt vmcnt(0)
    v_lshlrev_b32 v12, 16, v68
    v_and_b32 v13, 0xffff0000, v68
    v_fmac_f32 v16, v12, v121
    v_fmac_f32 v17, v13, v121
    v_lshlrev_b32 v12, 16, v69
    v_and_b32 v13, 0xffff0000, v69
    v_fmac_f32 v18, v12, v121
    v_fmac_f32 v19, v13, v121
    v_lshlrev_b32 v12, 16, v70
    v_and_b32 v13, 0xffff0000, v70
    v_fmac_f32 v20, v12, v121
    v_fmac_f32 v21, v13, v121
    v_lshlrev_b32 v12, 16, v71
    v_and_b32 v13, 0xffff0000, v71
    v_fmac_f32 v22, v12, v121
    v_fmac_f32 v23, v13, v121
    v_lshlrev_b32 v12, 7, v9
    v_lshl_add_u32 v12, v8, 5, v12
    ds_write_b128 v12, v[16:19] offset:4096
    ds_write_b128 v12, v[20:23] offset:4112
    s_waitcnt lgkmcnt(0)
    s_barrier
    s_cmp_lg_u32 s29, 0
    s_cbranch_scc1 wk_mod_done
    v_and_b32 v12, 31, v1
    v_lshrrev_b32 v13, 5, v1
    v_lshlrev_b32 v12, 2, v12
    v_lshl_add_u32 v13, v13, 12, v12
    ds_read_b32 v32, v13 offset:4096
    ds_read_b32 v33, v13 offset:4224
    ds_read_b32 v34, v13 offset:4352
    ds_read_b32 v35, v13 offset:4480
    ds_read_b32 v36, v13 offset:4608
    ds_read_b32 v37, v13 offset:4736
    ds_read_b32 v38, v13 offset:4864
    ds_read_b32 v39, v13 offset:4992
    ds_read_b32 v40, v13 offset:5120
    ds_read_b32 v41, v13 offset:5248
    ds_read_b32 v42, v13 offset:5376
    ds_read_b32 v43, v13 offset:5504
    ds_read_b32 v44, v13 offset:5632
    ds_read_b32 v45, v13 offset:5760
    ds_read_b32 v46, v13 offset:5888
    ds_read_b32 v47, v13 offset:6016
    ds_read_b32 v48, v13 offset:6144
    ds_read_b32 v49, v13 offset:6272
    ds_read_b32 v50, v13 offset:6400
    ds_read_b32 v51, v13 offset:6528
    ds_read_b32 v52, v13 offset:6656
    ds_read_b32 v53, v13 offset:6784
    ds_read_b32 v54, v13 offset:6912
    ds_read_b32 v55, v13 offset:7040
    ds_read_b32 v56, v13 offset:7168
    ds_read_b32 v57, v13 offset:7296
    ds_read_b32 v58, v13 offset:7424
    ds_read_b32 v59, v13 offset:7552
    ds_read_b32 v60, v13 offset:7680
    ds_read_b32 v61, v13 offset:7808
    ds_read_b32 v62, v13 offset:7936
    ds_read_b32 v63, v13 offset:8064
    s_waitcnt lgkmcnt(0)
    v_add_f32 v32, v32, v33
    v_add_f32 v32, v32, v34
    v_add_f32 v32, v32, v35
    v_add_f32 v32, v32, v36
    v_add_f32 v32, v32, v37
    v_add_f32 v32, v32, v38
    v_add_f32 v32, v32, v39
    v_add_f32 v32, v32, v40
    v_add_f32 v32, v32, v41
    v_add_f32 v32, v32, v42
    v_add_f32 v32, v32, v43
    v_add_f32 v32, v32, v44
    v_add_f32 v32, v32, v45
    v_add_f32 v32, v32, v46
    v_add_f32 v32, v32, v47
    v_add_f32 v32, v32, v48
    v_add_f32 v32, v32, v49
    v_add_f32 v32, v32, v50
    v_add_f32 v32, v32, v51
    v_add_f32 v32, v32, v52
    v_add_f32 v32, v32, v53
    v_add_f32 v32, v32, v54
    v_add_f32 v32, v32, v55
    v_add_f32 v32, v32, v56
    v_add_f32 v32, v32, v57
    v_add_f32 v32, v32, v58
    v_add_f32 v32, v32, v59
    v_add_f32 v32, v32, v60
    v_add_f32 v32, v32, v61
    v_add_f32 v32, v32, v62
    v_add_f32 v32, v32, v63
    v_mov_b32 v33, v32
    s_nop 1
    v_permlane32_swap_b32 v32, v33
    v_add_f32 v32, v32, v33
    v_cvt_pk_bf16_f32 v32, v32, v32
    v_lshlrev_b32 v32, 16, v32
    s_lshl_b32 s31, s53, 7
    s_add_u32 s31, s31, 0
    buffer_store_dword v32, v12, s[4:7], s31 offen sc1
wk_mod_done:
    s_cmp_lt_u32 s53, 40
    s_cbranch_scc1 wk_mod_a
    s_waitcnt vmcnt(0) lgkmcnt(0)
    s_barrier
    s_cmp_lg_u32 s29, 0
    s_cbranch_scc1 wk_mod_sg
    v_mov_b32 v2, 140
    v_mov_b32 v3, 1
    s_mov_b64 exec, 1
    buffer_atomic_add v3, v2, s[8:11], 0 offen
    s_mov_b64 exec, -1
wk_mod_sg:
    s_getpc_b64 s[44:45]
Lbj3:
    s_add_u32 s44, s44, wk_loop-Lbj3
    s_addc_u32 s45, s45, -1
    s_setpc_b64 s[44:45]
wk_mod_a:
    s_waitcnt vmcnt(0) lgkmcnt(0)
    s_barrier
    s_cmp_lg_u32 s29, 0
    s_cbranch_scc1 wk_mod_a2
    v_mov_b32 v2, 152
    v_mov_b32 v3, 1
    v_mov_b32 v4, 1
    s_mov_b64 exec, 1
    buffer_atomic_add v3, v2, s[8:11], 0 offen sc0
    s_mov_b64 exec, -1
    s_waitcnt vmcnt(0)
    v_readfirstlane_b32 s36, v3
    s_nop 0
    s_cmp_lg_u32 s36, 39
    s_cbranch_scc1 wk_mod_a2
    v_mov_b32 v2, 0
    buffer_store_dword v4, v2, s[8:11], 0 offen sc1
wk_mod_a2:
    s_waitcnt vmcnt(0) lgkmcnt(0)
    s_barrier
    s_getpc_b64 s[44:45]
Lbj4:
    s_add_u32 s44, s44, wk_loop-Lbj4
    s_addc_u32 s45, s45, -1
    s_setpc_b64 s[44:45]
.section .rodata,"a"
.p2align 6
.amdhsa_kernel adaLN_cond__memory_aug_recurrent_mem_tr__glu_gated_swiglu__prompt_kernel
  .amdhsa_next_free_vgpr 512
  .amdhsa_next_free_sgpr 102
  .amdhsa_accum_offset 256
  .amdhsa_group_segment_fixed_size 0
  .amdhsa_kernarg_size 128
  .amdhsa_user_sgpr_count 2
  .amdhsa_user_sgpr_kernarg_segment_ptr 1
  .amdhsa_system_sgpr_workgroup_id_x 1
.end_amdhsa_kernel
.text
```
